```python
import torch

def _softmax(x, axis=-1):
    return torch.softmax(x, dim=axis)
def _gelu(x):
    return torch.nn.functional.gelu(x, approximate="tanh")
def _silu(x):
    return torch.nn.functional.silu(x)
def _sigmoid(x):
    return torch.sigmoid(x)
def _layernorm(x, axis=-1, eps=1e-5):
    m = x.mean(dim=axis, keepdim=True)
    v = x.var(dim=axis, keepdim=True, unbiased=False)
    return (x - m) / torch.sqrt(v + eps)
def _scatter_add(tgt, idx, src, axis=0):
    return tgt.clone().index_add_(axis, idx, src)
def _segment_sum(src, seg, n):
    out = torch.zeros((n,) + src.shape[1:], dtype=src.dtype)
    return out.index_add_(0, seg, src)
def _pad(x, pw):
    flat = tuple(v for pair in reversed(pw) for v in pair)
    return torch.nn.functional.pad(x, flat)

kernel_name = 'parallel_sum__sliding_local_dilated__mixer_s_mlp__prompt'

def setup_inputs():

    _w = (lambda a: (lambda t: t.to(torch.bfloat16) if t.is_floating_point() else t)(torch.as_tensor(a)))
    def _A_setup():
        B, S, D = 1, 2048, 1024
        return {
            "x": _w((lambda *s: torch.randn(*s, dtype=torch.bfloat16) * 0.05)(B, S, D)),
            "wqkv": _w((lambda *s: torch.randn(*s, dtype=torch.bfloat16) * 0.05)(D, 3 * D)),
            "wo": _w((lambda *s: torch.randn(*s, dtype=torch.bfloat16) * 0.05)(D, D)),
        }
    _A_in = _A_setup()

    def _B_setup():
        B, S, D, F = 1, 2048, 1024, 3584
        return {
            "x":  _w((lambda *s: torch.randn(*s, dtype=torch.bfloat16) * 0.05)(B, S, D)),
            "w1": _w((lambda *s: torch.randn(*s, dtype=torch.bfloat16) * 3.2)(D, D) * (D ** -0.5)),
            "w2": _w((lambda *s: torch.randn(*s, dtype=torch.bfloat16) * 3.2)(D, D) * (D ** -0.5)),
            "w3": _w((lambda *s: torch.randn(*s, dtype=torch.bfloat16) * 3.2)(D, F) * (D ** -0.5)),
            "w4": _w((lambda *s: torch.randn(*s, dtype=torch.bfloat16) * 1.6)(F, D) * (F ** -0.5)),
        }
    _B_in = _B_setup()

    return {
        "A_x": _A_in["x"],
        "A_wqkv": _A_in["wqkv"],
        "A_wo": _A_in["wo"],
        "B_x": _B_in["x"],
        "B_w1": _B_in["w1"],
        "B_w2": _B_in["w2"],
        "B_w3": _B_in["w3"],
        "B_w4": _B_in["w4"],
    }

def reference(A_x, A_wqkv, A_wo, B_x, B_w1, B_w2, B_w3, B_w4):
    def _A_ref(x, wqkv, wo):
        B, S, D = x.shape
        H = 32; Dh = D // H
        W, dil = 8, 2
        qkv = (lambda x, *d: x.permute(*d))((x @ wqkv).reshape(B, S, 3, H, Dh), 2, 0, 3, 1, 4)
        q, k, v = qkv[0], qkv[1], qkv[2]
        scale = Dh ** -0.5
        pos = torch.arange(S)
        off = torch.arange(W) * dil
        idx = pos[:, None] - off[None, :]
        mask = idx >= 0
        idx_c = torch.where(mask, idx, 0).reshape(-1)
        kg = k[:, :, idx_c, :].reshape(B, H, S, W, Dh)
        vg = v[:, :, idx_c, :].reshape(B, H, S, W, Dh)
        logits = torch.einsum("bhsd,bhswd->bhsw", q, kg) * scale
        logits = torch.where(mask[None, None, :, :], logits, -1e9)
        attn = _softmax(logits, axis=-1)
        o = torch.einsum("bhsw,bhswd->bhsd", attn, vg)
        return (lambda x, *d: x.permute(*d))(o, 0, 2, 1, 3).reshape(B, S, D) @ wo

    def _B_ref(x, w1, w2, w3, w4):
        B, S, D = x.shape
        h = _gelu(_layernorm(x, axis=-1) @ w1)
        c = D // 4
        g0 = _pad(h[:, :, 0*c:1*c], ((0, 0), (1, 0), (0, 0)))[:, :S, :]
        g1 = _pad(h[:, :, 1*c:2*c], ((0, 0), (0, 1), (0, 0)))[:, 1:, :]
        g2 = _pad(h[:, :, 2*c:3*c], ((0, 0), (2, 0), (0, 0)))[:, :S, :]
        g3 = _pad(h[:, :, 3*c:   ], ((0, 0), (0, 2), (0, 0)))[:, 2:, :]
        hs = torch.concatenate([g0, g1, g2, g3], axis=-1) @ w2
        x1 = x + hs
        h2 = _gelu(_layernorm(x1, axis=-1) @ w3) @ w4
        return x1 + h2

    x = A_x
    xn = _layernorm(x, axis=-1)
    return x + _A_ref(xn, A_wqkv, A_wo) + _B_ref(xn, B_w1, B_w2, B_w3, B_w4)
```

```asm
; @launch grid=(256,1,1) block=(512,1,1) lds=163840
.amdgcn_target "amdgcn-amd-amdhsa--gfx950"
.text
.globl parallel_sum__sliding_local_dilated__mixer_s_mlp__prompt_kernel
.p2align 8
.type parallel_sum__sliding_local_dilated__mixer_s_mlp__prompt_kernel,@function
parallel_sum__sliding_local_dilated__mixer_s_mlp__prompt_kernel:
s_cmp_ge_u32 s2, 256
s_cbranch_scc1 END
s_load_dwordx16 s[64:79], s[0:1], 0
s_load_dwordx2 s[4:5], s[0:1], 80
s_load_dwordx2 s[52:53], s[0:1], 72
s_load_dwordx2 s[56:57], s[0:1], 64
v_lshrrev_b32 v1, 6, v0
v_and_b32 v0, 63, v0
v_readfirstlane_b32 s16, v1
s_and_b32 s17, s2, 3
s_lshl_b32 s17, s17, 2
s_bfe_u32 s19, s2, 131075
s_add_u32 s17, s17, s19
s_lshr_b32 s19, s2, 5
s_and_b32 s18, s2, 7
s_lshr_b32 s18, s18, 2
s_lshl_b32 s18, s18, 3
s_add_u32 s18, s18, s19
s_lshl_b32 s3, s17, 4
s_add_u32 s3, s3, s18
s_mov_b32 s6, 55574528
s_mov_b32 s7, 0x20000
s_cmp_lt_u32 s16, 4
s_cbranch_scc1 CONS
s_setprio 1
s_sub_u32 s16, s16, 4
s_lshl_b32 s26, s16, 10
s_lshl_b32 s27, s16, 11
s_lshl_b32 s28, s16, 8
v_lshrrev_b32 v6, 3, v0
v_and_b32 v8, 7, v0
v_lshrrev_b32 v7, 4, v0
v_xor_b32 v26, v7, v8
v_lshlrev_b32 v26, 4, v26
v_lshl_add_u32 v26, v6, 11, v26
s_lshl_b32 s19, s16, 16
v_add_u32 v26, s19, v26
v_xor_b32 v27, 64, v26
v_add_u32 v27, 15360, v27
v_add_u32 v28, 30720, v26
v_add_u32 v29, 30720, v27
s_lshl_b32 s19, s16, 1
v_add_u32 v5, s19, v7
v_xor_b32 v5, v5, v8
v_and_b32 v5, 7, v5
v_lshlrev_b32 v5, 4, v5
v_lshl_add_u32 v5, v6, 11, v5
s_lshl_b32 s19, s16, 13
v_add_u32 v5, s19, v5
s_cmp_eq_u32 s16, 3
s_movk_i32 s34, 6144
s_cmov_b32 s34, 2048
v_lshlrev_b32 v20, 4, v8
v_mad_u32_u24 v25, v6, s34, v20
v_mul_u32_u24 v17, 7168, v6
v_add_u32 v17, v17, v20
v_lshlrev_b32 v19, 4, v7
v_lshl_add_u32 v19, v8, 5, v19
s_lshl_b32 s19, s16, 3
v_add_u32 v6, s19, v6
v_and_b32 v20, 1, v7
s_and_b32 s19, s16, 1
s_lshl_b32 s19, s19, 2
v_lshl_add_u32 v20, v20, 1, s19
v_xor_b32 v20, v20, v8
v_lshlrev_b32 v20, 4, v20
s_lshl_b32 s44, s18, 7
s_lshr_b32 s81, s17, 2
s_mul_i32 s81, s81, 4
s_lshr_b32 s19, s18, 3
s_mul_i32 s19, s19, 1
s_add_u32 s81, s81, s19
s_mul_i32 s19, s18, 2
s_add_u32 s81, s81, s19
s_add_u32 s81, s81, 0
s_and_b32 s81, s81, 15
s_lshl_b32 s45, s81, 7
v_lshlrev_b32 v7, 1, v7
v_xor_b32 v7, v7, v8
v_lshlrev_b32 v7, 4, v7
s_mov_b32 s19, 6144
v_mad_u32_u24 v2, v6, s19, v20
s_mov_b32 s19, 2048
v_mad_u32_u24 v24, v6, s19, v20
s_mov_b32 s19, 2048
v_mad_u32_u24 v3, v6, s19, v7
s_mov_b32 s19, 7168
v_mad_u32_u24 v9, v6, s19, v7
v_lshlrev_b32 v6, 4, v0
v_add_u32 v4, s27, v6
v_add_u32 v30, s26, v6
v_mov_b32 v18, 0
s_add_u32 s29, s27, 16384
s_mul_i32 s31, s16, 1536
s_sub_u32 s31, 32768, s31
s_mov_b32 s20, s26
s_mov_b32 s50, s27
s_mov_b32 s51, 37781504
s_mov_b32 s49, 100000
s_lshl_b32 s33, s3, 3
s_lshl_b32 s19, s16, 1
s_add_u32 s33, s33, s19
s_lshl_b32 s35, s33, 11
s_lshl_b32 s33, s33, 2
s_waitcnt lgkmcnt(0)
s_mov_b32 s54, 256
s_mov_b32 s55, 0x20000
s_mov_b32 s36, s64
s_mov_b32 s37, s65
s_mov_b32 s38, 4194304
s_mov_b32 s39, 0x20000
s_lshl_b32 s23, s17, 18
s_sub_u32 s30, s23, 32768
s_max_i32 s30, s30, 0
s_add_u32 m0, s50, s29
s_add_u32 s25, s23, s45
buffer_load_dwordx4 v26, s[36:39], s25 offen offset:0  lds
buffer_load_dwordx4 v27, s[36:39], s25 offen offset:1024  lds
buffer_load_dwordx4 v28, s[36:39], s25 offen offset:2048  lds
buffer_load_dwordx4 v29, s[36:39], s25 offen offset:3072  lds
s_add_u32 m0, s50, s31
s_add_u32 s25, s30, s45
s_mov_b32 exec_hi, 0
buffer_load_dwordx4 v5, s[36:39], s25 offen  lds
s_mov_b32 exec_hi, -1
s_add_u32 s45, s45, 128
s_and_b32 s45, s45, 2047
s_add_u32 s50, s50, 51200
s_cmp_ge_u32 s50, 143360
s_cselect_b32 s50, s27, s50
s_mul_i32 s21, s81, 393216
s_add_u32 s21, s21, s44
s_lshl_b32 s22, s81, 17
s_add_u32 s22, s22, s44
s_xor_b32 s22, s22, 512
s_mov_b32 s8, s66
s_mov_b32 s9, s67
s_mov_b32 s10, 6291456
s_mov_b32 s11, 0x20000
s_mov_b32 s12, s72
s_mov_b32 s13, s73
s_mov_b32 s14, 2097152
s_mov_b32 s15, 0x20000
s_add_u32 m0, s20, 0
s_nop 0
buffer_load_dwordx4 v2, s[8:11], s21 offen  lds
s_add_u32 m0, s20, 4096
s_add_u32 s25, s21, 2048
buffer_load_dwordx4 v2, s[8:11], s25 offen  lds
s_add_u32 m0, s20, 8192
s_add_u32 s25, s21, 4096
buffer_load_dwordx4 v2, s[8:11], s25 offen  lds
s_add_u32 m0, s20, 12288
s_nop 0
buffer_load_dwordx4 v24, s[12:15], s22 offen  lds
s_add_u32 s21, s21, 196608
s_add_u32 s22, s22, 65536
s_add_u32 s20, s20, 34816
s_cmp_ge_u32 s20, 143360
s_cselect_b32 s20, s26, s20
s_add_u32 m0, s20, 0
s_nop 0
buffer_load_dwordx4 v2, s[8:11], s21 offen  lds
s_add_u32 m0, s20, 4096
s_add_u32 s25, s21, 2048
buffer_load_dwordx4 v2, s[8:11], s25 offen  lds
s_add_u32 m0, s20, 8192
s_add_u32 s25, s21, 4096
buffer_load_dwordx4 v2, s[8:11], s25 offen  lds
s_add_u32 m0, s20, 12288
s_nop 0
buffer_load_dwordx4 v24, s[12:15], s22 offen  lds
s_add_u32 s21, s21, 196608
s_add_u32 s22, s22, 65536
s_and_b32 s22, s22, 2097151
s_sub_u32 s25, s21, 6291456
s_cselect_b32 s21, s21, s25
s_add_u32 s20, s20, 16384
s_cmp_ge_u32 s20, 143360
s_cselect_b32 s20, s26, s20
s_add_u32 m0, s50, s29
s_add_u32 s25, s23, s45
buffer_load_dwordx4 v26, s[36:39], s25 offen offset:0  lds
buffer_load_dwordx4 v27, s[36:39], s25 offen offset:1024  lds
buffer_load_dwordx4 v28, s[36:39], s25 offen offset:2048  lds
buffer_load_dwordx4 v29, s[36:39], s25 offen offset:3072  lds
s_add_u32 m0, s50, s31
s_add_u32 s25, s30, s45
s_mov_b32 exec_hi, 0
buffer_load_dwordx4 v5, s[36:39], s25 offen  lds
s_mov_b32 exec_hi, -1
s_add_u32 s45, s45, 128
s_and_b32 s45, s45, 2047
s_add_u32 s50, s50, 51200
s_cmp_ge_u32 s50, 143360
s_cselect_b32 s50, s27, s50
s_add_u32 m0, s20, 0
s_nop 0
buffer_load_dwordx4 v2, s[8:11], s21 offen  lds
s_add_u32 m0, s20, 4096
s_add_u32 s25, s21, 2048
buffer_load_dwordx4 v2, s[8:11], s25 offen  lds
s_add_u32 m0, s20, 8192
s_add_u32 s25, s21, 4096
buffer_load_dwordx4 v2, s[8:11], s25 offen  lds
s_add_u32 m0, s20, 12288
s_nop 0
buffer_load_dwordx4 v24, s[12:15], s22 offen  lds
s_add_u32 s21, s21, 196608
s_add_u32 s22, s22, 65536
s_add_u32 s20, s20, 34816
s_cmp_ge_u32 s20, 143360
s_cselect_b32 s20, s26, s20
s_cmp_eq_u32 s16, 3
s_cselect_b32 s60, s72, s66
s_cselect_b32 s61, s73, s67
s_cselect_b32 s62, s14, s10
s_mov_b32 s63, 0x20000
s_cselect_b32 s19, 512, s27
s_xor_b32 s19, s19, s44
s_lshl_b32 s34, s34, 3
s_and_b32 s25, s17, 3
s_add_u32 s25, s25, 0
s_add_u32 s25, s25, s81
s_and_b32 s25, s25, 15
s_mul_i32 s25, s25, s34
s_lshl_b32 s25, s25, 3
s_add_u32 s48, s19, s25
s_lshl_b32 s19, s17, 4
v_min_u32 v10, 17, v0
v_add_u32 v10, s19, v10
v_add_u32 v10, -2, v10
v_max_i32 v10, 0, v10
v_lshlrev_b32 v10, 7, v10
v_min_u32 v11, 47, v0
v_add_u32 v11, s19, v11
v_add_u32 v11, -16, v11
v_and_b32 v11, 255, v11
v_lshlrev_b32 v11, 7, v11
v_and_b32 v12, 15, v0
v_lshl_add_u32 v13, v12, 4, s18
v_lshlrev_b32 v13, 7, v13
v_add_u32 v12, s19, v12
v_lshlrev_b32 v12, 7, v12
s_lshl_b32 s19, s3, 7
v_mov_b32 v15, s19
v_cmp_gt_u32 vcc, 32, v0
s_nop 1
v_cndmask_b32 v10, v13, v10, vcc
s_lshl_b32 s32, s18, 14
s_lshl_b32 s19, s17, 10
s_add_u32 s32, s32, s19
s_add_u32 s32, s32, s28
v_lshl_add_u32 v20, v0, 2, s28
s_waitcnt vmcnt(13)
s_barrier
s_add_u32 m0, s20, 0
s_nop 0
buffer_load_dwordx4 v2, s[8:11], s21 offen  lds
s_add_u32 m0, s20, 4096
s_add_u32 s25, s21, 2048
buffer_load_dwordx4 v2, s[8:11], s25 offen  lds
s_add_u32 m0, s20, 8192
s_add_u32 s25, s21, 4096
buffer_load_dwordx4 v2, s[8:11], s25 offen  lds
s_add_u32 m0, s20, 12288
s_nop 0
buffer_load_dwordx4 v24, s[12:15], s22 offen  lds
s_add_u32 s21, s21, 196608
s_add_u32 s22, s22, 65536
s_and_b32 s22, s22, 2097151
s_sub_u32 s25, s21, 6291456
s_cselect_b32 s21, s21, s25
s_add_u32 s20, s20, 16384
s_cmp_ge_u32 s20, 143360
s_cselect_b32 s20, s26, s20
s_add_u32 m0, s20, 0
s_nop 0
buffer_load_dwordx4 v2, s[8:11], s21 offen  lds
s_add_u32 m0, s20, 4096
s_add_u32 s25, s21, 2048
buffer_load_dwordx4 v2, s[8:11], s25 offen  lds
s_add_u32 m0, s20, 8192
s_add_u32 s25, s21, 4096
buffer_load_dwordx4 v2, s[8:11], s25 offen  lds
s_add_u32 m0, s20, 12288
s_nop 0
buffer_load_dwordx4 v24, s[12:15], s22 offen  lds
s_add_u32 s21, s21, 196608
s_add_u32 s22, s22, 65536
s_add_u32 s20, s20, 34816
s_cmp_ge_u32 s20, 143360
s_cselect_b32 s20, s26, s20
s_waitcnt vmcnt(17)
s_barrier
s_add_u32 m0, s50, s29
s_add_u32 s25, s23, s45
buffer_load_dwordx4 v26, s[36:39], s25 offen offset:0  lds
buffer_load_dwordx4 v27, s[36:39], s25 offen offset:1024  lds
buffer_load_dwordx4 v28, s[36:39], s25 offen offset:2048  lds
buffer_load_dwordx4 v29, s[36:39], s25 offen offset:3072  lds
s_add_u32 m0, s50, s31
s_add_u32 s25, s30, s45
s_mov_b32 exec_hi, 0
buffer_load_dwordx4 v5, s[36:39], s25 offen  lds
s_mov_b32 exec_hi, -1
s_add_u32 s45, s45, 128
s_and_b32 s45, s45, 2047
s_add_u32 s50, s50, 51200
s_cmp_ge_u32 s50, 143360
s_cselect_b32 s50, s27, s50
s_add_u32 m0, s20, 0
s_nop 0
buffer_load_dwordx4 v2, s[8:11], s21 offen  lds
s_add_u32 m0, s20, 4096
s_add_u32 s25, s21, 2048
buffer_load_dwordx4 v2, s[8:11], s25 offen  lds
s_add_u32 m0, s20, 8192
s_add_u32 s25, s21, 4096
buffer_load_dwordx4 v2, s[8:11], s25 offen  lds
s_add_u32 m0, s20, 12288
s_nop 0
buffer_load_dwordx4 v24, s[12:15], s22 offen  lds
s_add_u32 s21, s21, 196608
s_add_u32 s22, s22, 65536
s_and_b32 s22, s22, 2097151
s_sub_u32 s25, s21, 6291456
s_cselect_b32 s21, s21, s25
s_add_u32 s20, s20, 16384
s_cmp_ge_u32 s20, 143360
s_cselect_b32 s20, s26, s20
s_waitcnt vmcnt(17)
s_barrier
s_add_u32 m0, s20, 0
s_nop 0
buffer_load_dwordx4 v2, s[8:11], s21 offen  lds
s_add_u32 m0, s20, 4096
s_add_u32 s25, s21, 2048
buffer_load_dwordx4 v2, s[8:11], s25 offen  lds
s_add_u32 m0, s20, 8192
s_add_u32 s25, s21, 4096
buffer_load_dwordx4 v2, s[8:11], s25 offen  lds
s_add_u32 m0, s20, 12288
s_nop 0
buffer_load_dwordx4 v24, s[12:15], s22 offen  lds
s_add_u32 s21, s21, 196608
s_add_u32 s22, s22, 65536
s_add_u32 s20, s20, 34816
s_cmp_ge_u32 s20, 143360
s_cselect_b32 s20, s26, s20
s_waitcnt vmcnt(17)
s_barrier
s_add_u32 m0, s50, s29
s_add_u32 s25, s23, s45
buffer_load_dwordx4 v26, s[36:39], s25 offen offset:0  lds
buffer_load_dwordx4 v27, s[36:39], s25 offen offset:1024  lds
buffer_load_dwordx4 v28, s[36:39], s25 offen offset:2048  lds
buffer_load_dwordx4 v29, s[36:39], s25 offen offset:3072  lds
s_add_u32 m0, s50, s31
s_add_u32 s25, s30, s45
s_mov_b32 exec_hi, 0
buffer_load_dwordx4 v5, s[36:39], s25 offen  lds
s_mov_b32 exec_hi, -1
s_add_u32 s45, s45, 128
s_and_b32 s45, s45, 2047
s_add_u32 s50, s50, 51200
s_cmp_ge_u32 s50, 143360
s_cselect_b32 s50, s27, s50
s_add_u32 m0, s20, 0
s_nop 0
buffer_load_dwordx4 v2, s[8:11], s21 offen  lds
s_add_u32 m0, s20, 4096
s_add_u32 s25, s21, 2048
buffer_load_dwordx4 v2, s[8:11], s25 offen  lds
s_add_u32 m0, s20, 8192
s_add_u32 s25, s21, 4096
buffer_load_dwordx4 v2, s[8:11], s25 offen  lds
s_add_u32 m0, s20, 12288
s_nop 0
buffer_load_dwordx4 v24, s[12:15], s22 offen  lds
s_add_u32 s21, s21, 196608
s_add_u32 s22, s22, 65536
s_and_b32 s22, s22, 2097151
s_sub_u32 s25, s21, 6291456
s_cselect_b32 s21, s21, s25
s_add_u32 s20, s20, 16384
s_cmp_ge_u32 s20, 143360
s_cselect_b32 s20, s26, s20
s_waitcnt vmcnt(17)
s_barrier
s_add_u32 m0, s20, 0
s_nop 0
buffer_load_dwordx4 v2, s[8:11], s21 offen  lds
s_add_u32 m0, s20, 4096
s_add_u32 s25, s21, 2048
buffer_load_dwordx4 v2, s[8:11], s25 offen  lds
s_add_u32 m0, s20, 8192
s_add_u32 s25, s21, 4096
buffer_load_dwordx4 v2, s[8:11], s25 offen  lds
s_add_u32 m0, s20, 12288
s_nop 0
buffer_load_dwordx4 v24, s[12:15], s22 offen  lds
s_add_u32 s21, s21, 196608
s_add_u32 s22, s22, 65536
s_add_u32 s20, s20, 34816
s_cmp_ge_u32 s20, 143360
s_cselect_b32 s20, s26, s20
s_waitcnt vmcnt(17)
s_barrier
s_add_u32 m0, s50, s29
s_add_u32 s25, s23, s45
buffer_load_dwordx4 v26, s[36:39], s25 offen offset:0  lds
buffer_load_dwordx4 v27, s[36:39], s25 offen offset:1024  lds
buffer_load_dwordx4 v28, s[36:39], s25 offen offset:2048  lds
buffer_load_dwordx4 v29, s[36:39], s25 offen offset:3072  lds
s_add_u32 m0, s50, s31
s_add_u32 s25, s30, s45
s_mov_b32 exec_hi, 0
buffer_load_dwordx4 v5, s[36:39], s25 offen  lds
s_mov_b32 exec_hi, -1
s_add_u32 s45, s45, 128
s_and_b32 s45, s45, 2047
s_add_u32 s50, s50, 51200
s_cmp_ge_u32 s50, 143360
s_cselect_b32 s50, s27, s50
buffer_load_dwordx4 v[128:131], v6, s[36:39], s35 offen offset:0
buffer_load_dwordx4 v[132:135], v6, s[36:39], s35 offen offset:1024
s_waitcnt vmcnt(15)
s_barrier
s_add_u32 m0, s20, 0
s_nop 0
buffer_load_dwordx4 v2, s[8:11], s21 offen  lds
s_add_u32 m0, s20, 4096
s_add_u32 s25, s21, 2048
buffer_load_dwordx4 v2, s[8:11], s25 offen  lds
s_add_u32 m0, s20, 8192
s_add_u32 s25, s21, 4096
buffer_load_dwordx4 v2, s[8:11], s25 offen  lds
s_add_u32 m0, s20, 12288
s_nop 0
buffer_load_dwordx4 v24, s[12:15], s22 offen  lds
s_add_u32 s21, s21, 196608
s_add_u32 s22, s22, 65536
s_and_b32 s22, s22, 2097151
s_sub_u32 s25, s21, 6291456
s_cselect_b32 s21, s21, s25
s_add_u32 s20, s20, 16384
s_cmp_ge_u32 s20, 143360
s_cselect_b32 s20, s26, s20
buffer_load_dwordx4 v[136:139], v6, s[36:39], s35 offen offset:2048
buffer_load_dwordx4 v[140:143], v6, s[36:39], s35 offen offset:3072
s_waitcnt vmcnt(17)
s_barrier
buffer_load_dword v16, v18, s[52:55], 0 offen sc1
s_add_u32 m0, s50, s29
s_add_u32 s25, s23, s45
buffer_load_dwordx4 v26, s[36:39], s25 offen offset:0  lds
buffer_load_dwordx4 v27, s[36:39], s25 offen offset:1024  lds
buffer_load_dwordx4 v28, s[36:39], s25 offen offset:2048  lds
buffer_load_dwordx4 v29, s[36:39], s25 offen offset:3072  lds
s_add_u32 m0, s50, s31
s_add_u32 s25, s30, s45
s_mov_b32 exec_hi, 0
buffer_load_dwordx4 v5, s[36:39], s25 offen  lds
s_mov_b32 exec_hi, -1
s_add_u32 s45, s45, 128
s_and_b32 s45, s45, 2047
s_add_u32 s50, s50, 51200
s_cmp_ge_u32 s50, 143360
s_cselect_b32 s50, s27, s50
s_add_u32 m0, s20, 0
s_nop 0
buffer_load_dwordx4 v2, s[8:11], s21 offen  lds
s_add_u32 m0, s20, 4096
s_add_u32 s25, s21, 2048
buffer_load_dwordx4 v2, s[8:11], s25 offen  lds
s_add_u32 m0, s20, 8192
s_add_u32 s25, s21, 4096
buffer_load_dwordx4 v2, s[8:11], s25 offen  lds
s_add_u32 m0, s20, 12288
s_nop 0
buffer_load_dwordx4 v24, s[12:15], s22 offen  lds
s_add_u32 s21, s21, 196608
s_add_u32 s22, s22, 65536
s_add_u32 s20, s20, 34816
s_cmp_ge_u32 s20, 143360
s_cselect_b32 s20, s26, s20
buffer_load_dwordx4 v[32:35], v25, s[60:63], s48 offen
s_add_u32 s48, s48, s34
buffer_load_dwordx4 v[36:39], v25, s[60:63], s48 offen
s_add_u32 s48, s48, s34
s_waitcnt vmcnt(20)
s_barrier
s_add_u32 m0, s20, 0
s_nop 0
buffer_load_dwordx4 v2, s[8:11], s21 offen  lds
s_add_u32 m0, s20, 4096
s_add_u32 s25, s21, 2048
buffer_load_dwordx4 v2, s[8:11], s25 offen  lds
s_add_u32 m0, s20, 8192
s_add_u32 s25, s21, 4096
buffer_load_dwordx4 v2, s[8:11], s25 offen  lds
s_add_u32 m0, s20, 12288
s_nop 0
buffer_load_dwordx4 v24, s[12:15], s22 offen  lds
s_add_u32 s21, s21, 196608
s_add_u32 s22, s22, 65536
s_and_b32 s22, s22, 2097151
s_sub_u32 s25, s21, 6291456
s_cselect_b32 s21, s21, s25
s_add_u32 s20, s20, 16384
s_cmp_ge_u32 s20, 143360
s_cselect_b32 s20, s26, s20
buffer_load_dwordx4 v[40:43], v25, s[60:63], s48 offen
s_add_u32 s48, s48, s34
buffer_load_dwordx4 v[44:47], v25, s[60:63], s48 offen
s_add_u32 s48, s48, s34
s_waitcnt vmcnt(18)
v_and_b32 v145, 0xffff0000, v128
v_lshlrev_b32 v144, 16, v128
v_and_b32 v147, 0xffff0000, v129
v_lshlrev_b32 v146, 16, v129
v_and_b32 v149, 0xffff0000, v130
v_lshlrev_b32 v148, 16, v130
v_and_b32 v151, 0xffff0000, v131
v_lshlrev_b32 v150, 16, v131
v_and_b32 v153, 0xffff0000, v132
v_lshlrev_b32 v152, 16, v132
v_and_b32 v155, 0xffff0000, v133
v_lshlrev_b32 v154, 16, v133
v_and_b32 v157, 0xffff0000, v134
v_lshlrev_b32 v156, 16, v134
v_and_b32 v159, 0xffff0000, v135
v_lshlrev_b32 v158, 16, v135
v_and_b32 v161, 0xffff0000, v136
v_lshlrev_b32 v160, 16, v136
v_and_b32 v163, 0xffff0000, v137
v_lshlrev_b32 v162, 16, v137
v_and_b32 v165, 0xffff0000, v138
v_lshlrev_b32 v164, 16, v138
v_and_b32 v167, 0xffff0000, v139
v_lshlrev_b32 v166, 16, v139
v_and_b32 v169, 0xffff0000, v140
v_lshlrev_b32 v168, 16, v140
v_and_b32 v171, 0xffff0000, v141
v_lshlrev_b32 v170, 16, v141
v_and_b32 v173, 0xffff0000, v142
v_lshlrev_b32 v172, 16, v142
v_and_b32 v175, 0xffff0000, v143
v_lshlrev_b32 v174, 16, v143
v_pk_add_f32 v[176:177], v[144:145], v[146:147]
v_pk_add_f32 v[178:179], v[160:161], v[162:163]
v_pk_add_f32 v[176:177], v[176:177], v[148:149]
s_barrier
s_add_u32 m0, s50, s29
s_add_u32 s25, s23, s45
buffer_load_dwordx4 v26, s[36:39], s25 offen offset:0  lds
buffer_load_dwordx4 v27, s[36:39], s25 offen offset:1024  lds
buffer_load_dwordx4 v28, s[36:39], s25 offen offset:2048  lds
buffer_load_dwordx4 v29, s[36:39], s25 offen offset:3072  lds
s_add_u32 m0, s50, s31
s_add_u32 s25, s30, s45
s_mov_b32 exec_hi, 0
buffer_load_dwordx4 v5, s[36:39], s25 offen  lds
s_mov_b32 exec_hi, -1
s_add_u32 s45, s45, 128
s_and_b32 s45, s45, 2047
s_add_u32 s50, s50, 51200
s_cmp_ge_u32 s50, 143360
s_cselect_b32 s50, s27, s50
s_add_u32 m0, s20, 0
s_nop 0
buffer_load_dwordx4 v2, s[8:11], s21 offen  lds
s_add_u32 m0, s20, 4096
s_add_u32 s25, s21, 2048
buffer_load_dwordx4 v2, s[8:11], s25 offen  lds
s_add_u32 m0, s20, 8192
s_add_u32 s25, s21, 4096
buffer_load_dwordx4 v2, s[8:11], s25 offen  lds
s_add_u32 m0, s20, 12288
s_nop 0
buffer_load_dwordx4 v24, s[12:15], s22 offen  lds
s_add_u32 s21, s21, 196608
s_add_u32 s22, s22, 65536
s_add_u32 s20, s20, 34816
s_cmp_ge_u32 s20, 143360
s_cselect_b32 s20, s26, s20
buffer_load_dwordx4 v[48:51], v25, s[60:63], s48 offen
s_add_u32 s48, s48, s34
buffer_load_dwordx4 v[52:55], v25, s[60:63], s48 offen
s_add_u32 s48, s48, s34
v_pk_add_f32 v[178:179], v[178:179], v[164:165]
v_pk_add_f32 v[176:177], v[176:177], v[150:151]
v_pk_add_f32 v[178:179], v[178:179], v[166:167]
v_pk_add_f32 v[176:177], v[176:177], v[152:153]
v_pk_add_f32 v[178:179], v[178:179], v[168:169]
v_pk_add_f32 v[176:177], v[176:177], v[154:155]
v_pk_add_f32 v[178:179], v[178:179], v[170:171]
v_pk_add_f32 v[176:177], v[176:177], v[156:157]
v_pk_add_f32 v[178:179], v[178:179], v[172:173]
v_pk_add_f32 v[176:177], v[176:177], v[158:159]
v_pk_add_f32 v[178:179], v[178:179], v[174:175]
v_add_f32 v176, v176, v177
v_add_f32 v178, v178, v179
s_nop 0
v_add_f32_dpp v176, v176, v176 row_ror:8 row_mask:0xf bank_mask:0xf
v_add_f32_dpp v178, v178, v178 row_ror:8 row_mask:0xf bank_mask:0xf
s_nop 0
v_add_f32_dpp v176, v176, v176 row_ror:4 row_mask:0xf bank_mask:0xf
v_add_f32_dpp v178, v178, v178 row_ror:4 row_mask:0xf bank_mask:0xf
s_nop 0
v_add_f32_dpp v176, v176, v176 row_ror:2 row_mask:0xf bank_mask:0xf
v_add_f32_dpp v178, v178, v178 row_ror:2 row_mask:0xf bank_mask:0xf
s_nop 0
v_add_f32_dpp v176, v176, v176 row_ror:1 row_mask:0xf bank_mask:0xf
v_add_f32_dpp v178, v178, v178 row_ror:1 row_mask:0xf bank_mask:0xf
v_mov_b32 v180, v176
v_mov_b32 v181, v178
s_nop 0
v_permlane16_swap_b32 v176, v180
v_permlane16_swap_b32 v178, v181
v_add_f32 v176, v176, v180
v_add_f32 v178, v178, v181
v_mov_b32 v180, v176
v_mov_b32 v181, v178
s_nop 0
v_permlane32_swap_b32 v176, v180
v_permlane32_swap_b32 v178, v181
v_add_f32 v176, v176, v180
v_add_f32 v178, v178, v181
v_mul_f32 v184, 0xba800000, v176
v_mul_f32 v185, 0xba800000, v178
v_pk_add_f32 v[144:145], v[144:145], v[184:185] op_sel:[0,0] op_sel_hi:[1,0]
s_waitcnt vmcnt(19)
s_barrier
s_add_u32 m0, s20, 0
s_nop 0
buffer_load_dwordx4 v2, s[8:11], s21 offen  lds
s_add_u32 m0, s20, 4096
s_add_u32 s25, s21, 2048
buffer_load_dwordx4 v2, s[8:11], s25 offen  lds
s_add_u32 m0, s20, 8192
s_add_u32 s25, s21, 4096
buffer_load_dwordx4 v2, s[8:11], s25 offen  lds
s_add_u32 m0, s20, 12288
s_nop 0
buffer_load_dwordx4 v24, s[12:15], s22 offen  lds
s_add_u32 s21, s21, 196608
s_add_u32 s22, s22, 65536
s_and_b32 s22, s22, 2097151
s_sub_u32 s25, s21, 6291456
s_cselect_b32 s21, s21, s25
s_add_u32 s20, s20, 16384
s_cmp_ge_u32 s20, 143360
s_cselect_b32 s20, s26, s20
buffer_load_dwordx4 v[56:59], v25, s[60:63], s48 offen
s_add_u32 s48, s48, s34
buffer_load_dwordx4 v[60:63], v25, s[60:63], s48 offen
s_add_u32 s48, s48, s34
v_pk_add_f32 v[160:161], v[160:161], v[184:185] op_sel:[0,1] op_sel_hi:[1,1]
v_pk_add_f32 v[146:147], v[146:147], v[184:185] op_sel:[0,0] op_sel_hi:[1,0]
v_pk_add_f32 v[162:163], v[162:163], v[184:185] op_sel:[0,1] op_sel_hi:[1,1]
v_pk_add_f32 v[148:149], v[148:149], v[184:185] op_sel:[0,0] op_sel_hi:[1,0]
v_pk_add_f32 v[164:165], v[164:165], v[184:185] op_sel:[0,1] op_sel_hi:[1,1]
v_pk_add_f32 v[150:151], v[150:151], v[184:185] op_sel:[0,0] op_sel_hi:[1,0]
v_pk_add_f32 v[166:167], v[166:167], v[184:185] op_sel:[0,1] op_sel_hi:[1,1]
v_pk_add_f32 v[152:153], v[152:153], v[184:185] op_sel:[0,0] op_sel_hi:[1,0]
v_pk_add_f32 v[168:169], v[168:169], v[184:185] op_sel:[0,1] op_sel_hi:[1,1]
v_pk_add_f32 v[154:155], v[154:155], v[184:185] op_sel:[0,0] op_sel_hi:[1,0]
v_pk_add_f32 v[170:171], v[170:171], v[184:185] op_sel:[0,1] op_sel_hi:[1,1]
v_pk_add_f32 v[156:157], v[156:157], v[184:185] op_sel:[0,0] op_sel_hi:[1,0]
v_pk_add_f32 v[172:173], v[172:173], v[184:185] op_sel:[0,1] op_sel_hi:[1,1]
v_pk_add_f32 v[158:159], v[158:159], v[184:185] op_sel:[0,0] op_sel_hi:[1,0]
v_pk_add_f32 v[174:175], v[174:175], v[184:185] op_sel:[0,1] op_sel_hi:[1,1]
v_pk_mul_f32 v[176:177], v[144:145], v[144:145]
v_pk_mul_f32 v[178:179], v[160:161], v[160:161]
v_pk_fma_f32 v[176:177], v[146:147], v[146:147], v[176:177]
v_pk_fma_f32 v[178:179], v[162:163], v[162:163], v[178:179]
v_pk_fma_f32 v[176:177], v[148:149], v[148:149], v[176:177]
v_pk_fma_f32 v[178:179], v[164:165], v[164:165], v[178:179]
v_pk_fma_f32 v[176:177], v[150:151], v[150:151], v[176:177]
v_pk_fma_f32 v[178:179], v[166:167], v[166:167], v[178:179]
v_pk_fma_f32 v[176:177], v[152:153], v[152:153], v[176:177]
v_pk_fma_f32 v[178:179], v[168:169], v[168:169], v[178:179]
v_pk_fma_f32 v[176:177], v[154:155], v[154:155], v[176:177]
v_pk_fma_f32 v[178:179], v[170:171], v[170:171], v[178:179]
v_pk_fma_f32 v[176:177], v[156:157], v[156:157], v[176:177]
v_pk_fma_f32 v[178:179], v[172:173], v[172:173], v[178:179]
v_pk_fma_f32 v[176:177], v[158:159], v[158:159], v[176:177]
v_pk_fma_f32 v[178:179], v[174:175], v[174:175], v[178:179]
v_add_f32 v176, v176, v177
v_add_f32 v178, v178, v179
s_nop 0
v_add_f32_dpp v176, v176, v176 row_ror:8 row_mask:0xf bank_mask:0xf
v_add_f32_dpp v178, v178, v178 row_ror:8 row_mask:0xf bank_mask:0xf
s_nop 0
v_add_f32_dpp v176, v176, v176 row_ror:4 row_mask:0xf bank_mask:0xf
s_waitcnt vmcnt(19)
s_barrier
s_lshl_b32 s46, s17, 17
s_lshl_b32 s19, s18, 7
s_add_u32 s46, s46, s19
s_mov_b32 s40, s74
s_mov_b32 s41, s75
s_mov_b32 s42, 2097152
s_mov_b32 s43, 0x20000
s_add_u32 m0, s50, s29
s_add_u32 s25, s23, s45
buffer_load_dwordx4 v26, s[36:39], s25 offen offset:0  lds
buffer_load_dwordx4 v27, s[36:39], s25 offen offset:1024  lds
buffer_load_dwordx4 v28, s[36:39], s25 offen offset:2048  lds
buffer_load_dwordx4 v29, s[36:39], s25 offen offset:3072  lds
s_add_u32 m0, s50, s31
s_add_u32 s25, s30, s45
s_mov_b32 exec_hi, 0
buffer_load_dwordx4 v5, s[36:39], s25 offen  lds
s_mov_b32 exec_hi, -1
s_add_u32 s45, s45, 128
s_and_b32 s45, s45, 2047
s_add_u32 s50, s50, 51200
s_cmp_ge_u32 s50, 143360
s_cselect_b32 s50, s27, s50
s_add_u32 m0, s20, 0
s_nop 0
buffer_load_dwordx4 v2, s[8:11], s21 offen  lds
s_add_u32 m0, s20, 4096
s_add_u32 s25, s21, 2048
buffer_load_dwordx4 v2, s[8:11], s25 offen  lds
s_add_u32 m0, s20, 8192
s_add_u32 s25, s21, 4096
buffer_load_dwordx4 v2, s[8:11], s25 offen  lds
s_add_u32 m0, s20, 12288
s_nop 0
buffer_load_dwordx4 v24, s[12:15], s22 offen  lds
s_add_u32 s21, s21, 196608
s_add_u32 s22, s22, 65536
s_add_u32 s20, s20, 34816
s_cmp_ge_u32 s20, 143360
s_cselect_b32 s20, s26, s20
buffer_load_dwordx4 v[192:195], v3, s[40:43], s46 offen
s_add_u32 s46, s46, 65536
buffer_load_dwordx4 v[196:199], v3, s[40:43], s46 offen
s_add_u32 s46, s46, 65536
v_add_f32_dpp v178, v178, v178 row_ror:4 row_mask:0xf bank_mask:0xf
v_add_f32_dpp v176, v176, v176 row_ror:2 row_mask:0xf bank_mask:0xf
s_nop 0
v_add_f32_dpp v178, v178, v178 row_ror:2 row_mask:0xf bank_mask:0xf
v_add_f32_dpp v176, v176, v176 row_ror:1 row_mask:0xf bank_mask:0xf
s_nop 0
v_add_f32_dpp v178, v178, v178 row_ror:1 row_mask:0xf bank_mask:0xf
v_mov_b32 v180, v176
v_mov_b32 v181, v178
s_nop 0
v_permlane16_swap_b32 v176, v180
v_permlane16_swap_b32 v178, v181
v_add_f32 v176, v176, v180
v_add_f32 v178, v178, v181
v_mov_b32 v180, v176
v_mov_b32 v181, v178
s_nop 0
v_permlane32_swap_b32 v176, v180
v_permlane32_swap_b32 v178, v181
v_add_f32 v176, v176, v180
v_add_f32 v178, v178, v181
v_mul_f32 v176, 0x3a800000, v176
v_add_f32 v182, 0x3727c5ac, v176
v_rsq_f32 v182, v182
v_mul_f32 v178, 0x3a800000, v178
v_add_f32 v183, 0x3727c5ac, v178
v_rsq_f32 v183, v183
v_mul_f32 v176, v176, v182
v_mul_f32 v176, v176, v182
v_add_f32 v176, 0x3727c5ac, v176
v_rsq_f32 v176, v176
s_nop 0
v_mul_f32 v186, v176, v182
v_mul_f32 v178, v178, v183
v_mul_f32 v178, v178, v183
v_add_f32 v178, 0x3727c5ac, v178
v_rsq_f32 v178, v178
s_nop 0
v_mul_f32 v187, v178, v183
s_add_u32 s19, s33, 37748736
s_mov_b64 exec, 1
buffer_store_dwordx2 v[182:183], v18, s[4:7], s19 offen sc1
s_mov_b64 exec, -1
s_add_u32 s19, s33, 37756928
s_mov_b64 exec, 1
buffer_store_dwordx2 v[184:185], v18, s[4:7], s19 offen sc1
s_mov_b64 exec, -1
s_add_u32 s19, s33, 37765120
s_mov_b64 exec, 1
buffer_store_dwordx2 v[186:187], v18, s[4:7], s19 offen sc1
s_mov_b64 exec, -1
s_waitcnt vmcnt(22)
s_barrier
s_lshl_b32 s46, s17, 17
s_lshl_b32 s19, s18, 7
s_add_u32 s46, s46, s19
s_mov_b32 s40, s68
s_mov_b32 s41, s69
s_mov_b32 s42, 2097152
s_mov_b32 s43, 0x20000
s_add_u32 m0, s20, 0
s_nop 0
buffer_load_dwordx4 v2, s[8:11], s21 offen  lds
s_add_u32 m0, s20, 4096
s_add_u32 s25, s21, 2048
buffer_load_dwordx4 v2, s[8:11], s25 offen  lds
s_add_u32 m0, s20, 8192
s_add_u32 s25, s21, 4096
buffer_load_dwordx4 v2, s[8:11], s25 offen  lds
s_add_u32 m0, s20, 12288
s_nop 0
buffer_load_dwordx4 v24, s[12:15], s22 offen  lds
s_add_u32 s21, s21, 196608
s_add_u32 s22, s22, 65536
s_and_b32 s22, s22, 2097151
s_sub_u32 s25, s21, 6291456
s_cselect_b32 s21, s21, s25
s_add_u32 s20, s20, 16384
s_cmp_ge_u32 s20, 143360
s_cselect_b32 s20, s26, s20
buffer_load_dwordx4 v[200:203], v3, s[40:43], s46 offen
s_add_u32 s46, s46, 65536
buffer_load_dwordx4 v[204:207], v3, s[40:43], s46 offen
s_add_u32 s46, s46, 65536
s_waitcnt vmcnt(20)
v_and_b32 v65, 0xffff0000, v32
v_lshlrev_b32 v64, 16, v32
v_and_b32 v67, 0xffff0000, v33
v_lshlrev_b32 v66, 16, v33
v_and_b32 v69, 0xffff0000, v34
v_lshlrev_b32 v68, 16, v34
v_and_b32 v71, 0xffff0000, v35
v_lshlrev_b32 v70, 16, v35
v_and_b32 v73, 0xffff0000, v36
v_lshlrev_b32 v72, 16, v36
v_and_b32 v75, 0xffff0000, v37
v_lshlrev_b32 v74, 16, v37
v_and_b32 v77, 0xffff0000, v38
v_lshlrev_b32 v76, 16, v38
v_and_b32 v79, 0xffff0000, v39
v_lshlrev_b32 v78, 16, v39
v_pk_add_f32 v[64:65], v[64:65], v[72:73]
v_pk_add_f32 v[66:67], v[66:67], v[74:75]
v_pk_add_f32 v[68:69], v[68:69], v[76:77]
v_pk_add_f32 v[70:71], v[70:71], v[78:79]
v_and_b32 v73, 0xffff0000, v40
v_lshlrev_b32 v72, 16, v40
v_and_b32 v75, 0xffff0000, v41
v_lshlrev_b32 v74, 16, v41
v_and_b32 v77, 0xffff0000, v42
v_lshlrev_b32 v76, 16, v42
v_and_b32 v79, 0xffff0000, v43
v_lshlrev_b32 v78, 16, v43
v_pk_add_f32 v[64:65], v[64:65], v[72:73]
v_pk_add_f32 v[66:67], v[66:67], v[74:75]
v_pk_add_f32 v[68:69], v[68:69], v[76:77]
v_pk_add_f32 v[70:71], v[70:71], v[78:79]
v_and_b32 v73, 0xffff0000, v44
v_lshlrev_b32 v72, 16, v44
v_and_b32 v75, 0xffff0000, v45
v_lshlrev_b32 v74, 16, v45
v_and_b32 v77, 0xffff0000, v46
v_lshlrev_b32 v76, 16, v46
v_and_b32 v79, 0xffff0000, v47
v_lshlrev_b32 v78, 16, v47
s_barrier
s_add_u32 m0, s50, s29
s_add_u32 s25, s23, s45
buffer_load_dwordx4 v26, s[36:39], s25 offen offset:0  lds
buffer_load_dwordx4 v27, s[36:39], s25 offen offset:1024  lds
buffer_load_dwordx4 v28, s[36:39], s25 offen offset:2048  lds
buffer_load_dwordx4 v29, s[36:39], s25 offen offset:3072  lds
s_add_u32 m0, s50, s31
s_add_u32 s25, s30, s45
s_mov_b32 exec_hi, 0
buffer_load_dwordx4 v5, s[36:39], s25 offen  lds
s_mov_b32 exec_hi, -1
s_add_u32 s45, s45, 128
s_and_b32 s45, s45, 2047
s_add_u32 s50, s50, 51200
s_cmp_ge_u32 s50, 143360
s_cselect_b32 s50, s27, s50
s_add_u32 m0, s20, 0
s_nop 0
buffer_load_dwordx4 v2, s[8:11], s21 offen  lds
s_add_u32 m0, s20, 4096
s_add_u32 s25, s21, 2048
buffer_load_dwordx4 v2, s[8:11], s25 offen  lds
s_add_u32 m0, s20, 8192
s_add_u32 s25, s21, 4096
buffer_load_dwordx4 v2, s[8:11], s25 offen  lds
s_add_u32 m0, s20, 12288
s_nop 0
buffer_load_dwordx4 v24, s[12:15], s22 offen  lds
s_add_u32 s21, s21, 196608
s_add_u32 s22, s22, 65536
s_add_u32 s20, s20, 34816
s_cmp_ge_u32 s20, 143360
s_cselect_b32 s20, s26, s20
v_pk_add_f32 v[64:65], v[64:65], v[72:73]
v_pk_add_f32 v[66:67], v[66:67], v[74:75]
v_pk_add_f32 v[68:69], v[68:69], v[76:77]
v_pk_add_f32 v[70:71], v[70:71], v[78:79]
v_and_b32 v73, 0xffff0000, v48
v_lshlrev_b32 v72, 16, v48
v_and_b32 v75, 0xffff0000, v49
v_lshlrev_b32 v74, 16, v49
v_and_b32 v77, 0xffff0000, v50
v_lshlrev_b32 v76, 16, v50
v_and_b32 v79, 0xffff0000, v51
v_lshlrev_b32 v78, 16, v51
v_pk_add_f32 v[64:65], v[64:65], v[72:73]
v_pk_add_f32 v[66:67], v[66:67], v[74:75]
v_pk_add_f32 v[68:69], v[68:69], v[76:77]
v_pk_add_f32 v[70:71], v[70:71], v[78:79]
v_and_b32 v73, 0xffff0000, v52
v_lshlrev_b32 v72, 16, v52
v_and_b32 v75, 0xffff0000, v53
v_lshlrev_b32 v74, 16, v53
v_and_b32 v77, 0xffff0000, v54
v_lshlrev_b32 v76, 16, v54
v_and_b32 v79, 0xffff0000, v55
v_lshlrev_b32 v78, 16, v55
v_pk_add_f32 v[64:65], v[64:65], v[72:73]
v_pk_add_f32 v[66:67], v[66:67], v[74:75]
v_pk_add_f32 v[68:69], v[68:69], v[76:77]
v_pk_add_f32 v[70:71], v[70:71], v[78:79]
v_and_b32 v73, 0xffff0000, v56
v_lshlrev_b32 v72, 16, v56
v_and_b32 v75, 0xffff0000, v57
v_lshlrev_b32 v74, 16, v57
v_and_b32 v77, 0xffff0000, v58
v_lshlrev_b32 v76, 16, v58
v_and_b32 v79, 0xffff0000, v59
v_lshlrev_b32 v78, 16, v59
v_pk_add_f32 v[64:65], v[64:65], v[72:73]
v_pk_add_f32 v[66:67], v[66:67], v[74:75]
v_pk_add_f32 v[68:69], v[68:69], v[76:77]
v_pk_add_f32 v[70:71], v[70:71], v[78:79]
s_waitcnt vmcnt(20)
s_barrier
s_waitcnt vmcnt(18)
s_lshl_b32 s47, s18, 17
s_lshl_b32 s19, s17, 13
s_add_u32 s47, s47, s19
s_add_u32 s47, s47, 0
s_add_u32 m0, s20, 0
s_nop 0
buffer_load_dwordx4 v2, s[8:11], s21 offen  lds
s_add_u32 m0, s20, 4096
s_add_u32 s25, s21, 2048
buffer_load_dwordx4 v2, s[8:11], s25 offen  lds
s_add_u32 m0, s20, 8192
s_add_u32 s25, s21, 4096
buffer_load_dwordx4 v2, s[8:11], s25 offen  lds
s_add_u32 m0, s20, 12288
s_nop 0
buffer_load_dwordx4 v24, s[12:15], s22 offen  lds
s_add_u32 s21, s21, 196608
s_add_u32 s22, s22, 65536
s_and_b32 s22, s22, 2097151
s_sub_u32 s25, s21, 6291456
s_cselect_b32 s21, s21, s25
s_add_u32 s20, s20, 16384
s_cmp_ge_u32 s20, 143360
s_cselect_b32 s20, s26, s20
buffer_store_dwordx4 v[192:195], v30, s[4:7], s47 offen sc1
s_add_u32 s47, s47, 4096
buffer_store_dwordx4 v[196:199], v30, s[4:7], s47 offen sc1
s_add_u32 s47, s47, 4096
v_and_b32 v73, 0xffff0000, v60
v_lshlrev_b32 v72, 16, v60
v_and_b32 v75, 0xffff0000, v61
v_lshlrev_b32 v74, 16, v61
v_and_b32 v77, 0xffff0000, v62
v_lshlrev_b32 v76, 16, v62
v_and_b32 v79, 0xffff0000, v63
v_lshlrev_b32 v78, 16, v63
v_pk_add_f32 v[64:65], v[64:65], v[72:73]
v_pk_add_f32 v[66:67], v[66:67], v[74:75]
v_pk_add_f32 v[68:69], v[68:69], v[76:77]
v_pk_add_f32 v[70:71], v[70:71], v[78:79]
v_add_f32_dpp v64, v64, v64 row_ror:8 row_mask:0xf bank_mask:0xf
v_add_f32_dpp v65, v65, v65 row_ror:8 row_mask:0xf bank_mask:0xf
v_add_f32_dpp v66, v66, v66 row_ror:8 row_mask:0xf bank_mask:0xf
v_add_f32_dpp v67, v67, v67 row_ror:8 row_mask:0xf bank_mask:0xf
v_add_f32_dpp v68, v68, v68 row_ror:8 row_mask:0xf bank_mask:0xf
v_add_f32_dpp v69, v69, v69 row_ror:8 row_mask:0xf bank_mask:0xf
v_add_f32_dpp v70, v70, v70 row_ror:8 row_mask:0xf bank_mask:0xf
v_add_f32_dpp v71, v71, v71 row_ror:8 row_mask:0xf bank_mask:0xf
v_permlane16_swap_b32 v64, v68
v_permlane16_swap_b32 v65, v69
v_permlane16_swap_b32 v66, v70
v_permlane16_swap_b32 v67, v71
v_add_f32 v64, v64, v68
v_mov_b32 v68, v64
v_add_f32 v65, v65, v69
v_mov_b32 v69, v65
v_add_f32 v66, v66, v70
v_mov_b32 v70, v66
v_add_f32 v67, v67, v71
v_mov_b32 v71, v67
v_permlane32_swap_b32 v64, v68
v_permlane32_swap_b32 v65, v69
v_permlane32_swap_b32 v66, v70
v_permlane32_swap_b32 v67, v71
v_add_f32 v64, v64, v68
v_add_f32 v65, v65, v69
v_add_f32 v66, v66, v70
v_add_f32 v67, v67, v71
s_add_u32 s19, s32, 38076416
s_mov_b64 exec, 0xff00ff
buffer_store_dwordx4 v[64:67], v19, s[4:7], s19 offen sc1
s_mov_b64 exec, -1
s_waitcnt vmcnt(18)
s_barrier
s_waitcnt vmcnt(16)
s_lshl_b32 s47, s18, 17
s_lshl_b32 s19, s17, 13
s_add_u32 s47, s47, s19
s_add_u32 s47, s47, 2097152
s_add_u32 m0, s50, s29
s_add_u32 s25, s23, s45
buffer_load_dwordx4 v26, s[36:39], s25 offen offset:0  lds
buffer_load_dwordx4 v27, s[36:39], s25 offen offset:1024  lds
buffer_load_dwordx4 v28, s[36:39], s25 offen offset:2048  lds
buffer_load_dwordx4 v29, s[36:39], s25 offen offset:3072  lds
s_add_u32 m0, s50, s31
s_add_u32 s25, s30, s45
s_mov_b32 exec_hi, 0
buffer_load_dwordx4 v5, s[36:39], s25 offen  lds
s_mov_b32 exec_hi, -1
s_add_u32 s45, s45, 128
s_and_b32 s45, s45, 2047
s_add_u32 s50, s50, 51200
s_cmp_ge_u32 s50, 143360
s_cselect_b32 s50, s27, s50
s_add_u32 m0, s20, 0
s_nop 0
buffer_load_dwordx4 v2, s[8:11], s21 offen  lds
s_add_u32 m0, s20, 4096
s_add_u32 s25, s21, 2048
buffer_load_dwordx4 v2, s[8:11], s25 offen  lds
s_add_u32 m0, s20, 8192
s_add_u32 s25, s21, 4096
buffer_load_dwordx4 v2, s[8:11], s25 offen  lds
s_add_u32 m0, s20, 12288
s_nop 0
buffer_load_dwordx4 v24, s[12:15], s22 offen  lds
s_add_u32 s21, s21, 196608
s_add_u32 s22, s22, 65536
s_add_u32 s20, s20, 34816
s_cmp_ge_u32 s20, 143360
s_cselect_b32 s20, s26, s20
buffer_store_dwordx4 v[200:203], v30, s[4:7], s47 offen sc1
s_add_u32 s47, s47, 4096
buffer_store_dwordx4 v[204:207], v30, s[4:7], s47 offen sc1
s_add_u32 s47, s47, 4096
s_waitcnt vmcnt(18)
s_barrier
s_add_u32 m0, s20, 0
s_nop 0
buffer_load_dwordx4 v2, s[8:11], s21 offen  lds
s_add_u32 m0, s20, 4096
s_add_u32 s25, s21, 2048
buffer_load_dwordx4 v2, s[8:11], s25 offen  lds
s_add_u32 m0, s20, 8192
s_add_u32 s25, s21, 4096
buffer_load_dwordx4 v2, s[8:11], s25 offen  lds
s_add_u32 m0, s20, 12288
s_nop 0
buffer_load_dwordx4 v24, s[12:15], s22 offen  lds
s_add_u32 s21, s21, 196608
s_add_u32 s22, s22, 65536
s_and_b32 s22, s22, 2097151
s_sub_u32 s25, s21, 6291456
s_cselect_b32 s21, s21, s25
s_add_u32 s20, s20, 16384
s_cmp_ge_u32 s20, 143360
s_cselect_b32 s20, s26, s20
s_add_u32 m0, s20, 0
s_nop 0
buffer_load_dwordx4 v2, s[8:11], s21 offen  lds
s_add_u32 m0, s20, 4096
s_add_u32 s25, s21, 2048
buffer_load_dwordx4 v2, s[8:11], s25 offen  lds
s_add_u32 m0, s20, 8192
s_add_u32 s25, s21, 4096
buffer_load_dwordx4 v2, s[8:11], s25 offen  lds
s_add_u32 m0, s20, 12288
s_nop 0
buffer_load_dwordx4 v24, s[12:15], s22 offen  lds
s_add_u32 s21, s21, 196608
s_add_u32 s22, s22, 65536
s_add_u32 s20, s20, 34816
s_cmp_ge_u32 s20, 143360
s_cselect_b32 s20, s26, s20
s_waitcnt vmcnt(8)
s_branch PC1
PL1:
buffer_load_dword v16, v18, s[52:55], 0 offen sc1
s_waitcnt vmcnt(0)
PC1:
v_cmp_gt_u32 vcc, 1, v16
s_nop 1
s_cmp_eq_u64 vcc, 0
s_cbranch_scc1 PD1
s_sub_u32 s49, s49, 1
s_cbranch_scc0 PL1
s_mov_b32 s49, 0
PD1:
s_barrier
s_cmp_lg_u32 s16, 0
s_cbranch_scc1 NF2
v_mov_b32 v14, 1
s_mov_b64 exec, 1
buffer_store_dword v14, v15, s[4:7], s51 offen sc1
s_mov_b64 exec, -1
NF2:
s_add_u32 m0, s50, s29
s_add_u32 s25, s23, s45
buffer_load_dwordx4 v26, s[36:39], s25 offen offset:0  lds
buffer_load_dwordx4 v27, s[36:39], s25 offen offset:1024  lds
buffer_load_dwordx4 v28, s[36:39], s25 offen offset:2048  lds
buffer_load_dwordx4 v29, s[36:39], s25 offen offset:3072  lds
s_add_u32 m0, s50, s31
s_add_u32 s25, s30, s45
s_mov_b32 exec_hi, 0
buffer_load_dwordx4 v5, s[36:39], s25 offen  lds
s_mov_b32 exec_hi, -1
s_add_u32 s45, s45, 128
s_and_b32 s45, s45, 2047
s_add_u32 s50, s50, 51200
s_cmp_ge_u32 s50, 143360
s_cselect_b32 s50, s27, s50
s_add_u32 m0, s20, 0
s_nop 0
buffer_load_dwordx4 v2, s[8:11], s21 offen  lds
s_add_u32 m0, s20, 4096
s_add_u32 s25, s21, 2048
buffer_load_dwordx4 v2, s[8:11], s25 offen  lds
s_add_u32 m0, s20, 8192
s_add_u32 s25, s21, 4096
buffer_load_dwordx4 v2, s[8:11], s25 offen  lds
s_add_u32 m0, s20, 12288
s_nop 0
buffer_load_dwordx4 v24, s[12:15], s22 offen  lds
s_add_u32 s21, s21, 196608
s_add_u32 s22, s22, 65536
s_and_b32 s22, s22, 2097151
s_sub_u32 s25, s21, 6291456
s_cselect_b32 s21, s21, s25
s_add_u32 s20, s20, 16384
s_cmp_ge_u32 s20, 143360
s_cselect_b32 s20, s26, s20
s_barrier
s_add_u32 m0, s20, 0
s_nop 0
buffer_load_dwordx4 v2, s[8:11], s21 offen  lds
s_add_u32 m0, s20, 4096
s_add_u32 s25, s21, 2048
buffer_load_dwordx4 v2, s[8:11], s25 offen  lds
s_add_u32 m0, s20, 8192
s_add_u32 s25, s21, 4096
buffer_load_dwordx4 v2, s[8:11], s25 offen  lds
s_add_u32 m0, s20, 12288
s_nop 0
buffer_load_dwordx4 v24, s[12:15], s22 offen  lds
s_add_u32 s21, s21, 196608
s_add_u32 s22, s22, 65536
s_add_u32 s20, s20, 34816
s_cmp_ge_u32 s20, 143360
s_cselect_b32 s20, s26, s20
s_waitcnt vmcnt(17)
s_barrier
s_add_u32 m0, s50, s29
s_add_u32 s25, s23, s45
buffer_load_dwordx4 v26, s[36:39], s25 offen offset:0  lds
buffer_load_dwordx4 v27, s[36:39], s25 offen offset:1024  lds
buffer_load_dwordx4 v28, s[36:39], s25 offen offset:2048  lds
buffer_load_dwordx4 v29, s[36:39], s25 offen offset:3072  lds
s_add_u32 m0, s50, s31
s_add_u32 s25, s30, s45
s_mov_b32 exec_hi, 0
buffer_load_dwordx4 v5, s[36:39], s25 offen  lds
s_mov_b32 exec_hi, -1
s_add_u32 s45, s45, 128
s_and_b32 s45, s45, 2047
s_add_u32 s50, s50, 51200
s_cmp_ge_u32 s50, 143360
s_cselect_b32 s50, s27, s50
s_add_u32 m0, s20, 0
s_nop 0
buffer_load_dwordx4 v2, s[8:11], s21 offen  lds
s_add_u32 m0, s20, 4096
s_add_u32 s25, s21, 2048
buffer_load_dwordx4 v2, s[8:11], s25 offen  lds
s_add_u32 m0, s20, 8192
s_add_u32 s25, s21, 4096
buffer_load_dwordx4 v2, s[8:11], s25 offen  lds
s_add_u32 m0, s20, 12288
s_nop 0
buffer_load_dwordx4 v24, s[12:15], s22 offen  lds
s_add_u32 s21, s21, 196608
s_add_u32 s22, s22, 65536
s_and_b32 s22, s22, 2097151
s_sub_u32 s25, s21, 6291456
s_cselect_b32 s21, s21, s25
s_add_u32 s20, s20, 16384
s_cmp_ge_u32 s20, 143360
s_cselect_b32 s20, s26, s20
s_waitcnt vmcnt(17)
s_barrier
s_add_u32 m0, s20, 0
s_nop 0
buffer_load_dwordx4 v2, s[8:11], s21 offen  lds
s_add_u32 m0, s20, 4096
s_add_u32 s25, s21, 2048
buffer_load_dwordx4 v2, s[8:11], s25 offen  lds
s_add_u32 m0, s20, 8192
s_add_u32 s25, s21, 4096
buffer_load_dwordx4 v2, s[8:11], s25 offen  lds
s_add_u32 m0, s20, 12288
s_nop 0
buffer_load_dwordx4 v24, s[12:15], s22 offen  lds
s_add_u32 s21, s21, 196608
s_add_u32 s22, s22, 65536
s_add_u32 s20, s20, 34816
s_cmp_ge_u32 s20, 143360
s_cselect_b32 s20, s26, s20
s_waitcnt vmcnt(17)
s_barrier
s_add_u32 m0, s50, s29
s_add_u32 s25, s23, s45
buffer_load_dwordx4 v26, s[36:39], s25 offen offset:0  lds
buffer_load_dwordx4 v27, s[36:39], s25 offen offset:1024  lds
buffer_load_dwordx4 v28, s[36:39], s25 offen offset:2048  lds
buffer_load_dwordx4 v29, s[36:39], s25 offen offset:3072  lds
s_add_u32 m0, s50, s31
s_add_u32 s25, s30, s45
s_mov_b32 exec_hi, 0
buffer_load_dwordx4 v5, s[36:39], s25 offen  lds
s_mov_b32 exec_hi, -1
s_add_u32 s45, s45, 128
s_and_b32 s45, s45, 2047
s_add_u32 s50, s50, 51200
s_cmp_ge_u32 s50, 143360
s_cselect_b32 s50, s27, s50
s_add_u32 m0, s20, 0
s_nop 0
buffer_load_dwordx4 v2, s[8:11], s21 offen  lds
s_add_u32 m0, s20, 4096
s_add_u32 s25, s21, 2048
buffer_load_dwordx4 v2, s[8:11], s25 offen  lds
s_add_u32 m0, s20, 8192
s_add_u32 s25, s21, 4096
buffer_load_dwordx4 v2, s[8:11], s25 offen  lds
s_add_u32 m0, s20, 12288
s_nop 0
buffer_load_dwordx4 v24, s[12:15], s22 offen  lds
s_add_u32 s21, s21, 196608
s_add_u32 s22, s22, 65536
s_and_b32 s22, s22, 2097151
s_sub_u32 s25, s21, 6291456
s_cselect_b32 s21, s21, s25
s_add_u32 s20, s20, 16384
s_cmp_ge_u32 s20, 143360
s_cselect_b32 s20, s26, s20
buffer_load_dword v16, v10, s[4:7], s51 offen sc1
s_waitcnt vmcnt(18)
s_barrier
s_add_u32 m0, s20, 0
s_nop 0
buffer_load_dwordx4 v2, s[8:11], s21 offen  lds
s_add_u32 m0, s20, 4096
s_add_u32 s25, s21, 2048
buffer_load_dwordx4 v2, s[8:11], s25 offen  lds
s_add_u32 m0, s20, 8192
s_add_u32 s25, s21, 4096
buffer_load_dwordx4 v2, s[8:11], s25 offen  lds
s_add_u32 m0, s20, 12288
s_nop 0
buffer_load_dwordx4 v24, s[12:15], s22 offen  lds
s_add_u32 s21, s21, 196608
s_add_u32 s22, s22, 65536
s_add_u32 s20, s20, 34816
s_cmp_ge_u32 s20, 143360
s_cselect_b32 s20, s26, s20
s_waitcnt vmcnt(18)
s_barrier
s_add_u32 m0, s50, s29
s_add_u32 s25, s23, s45
buffer_load_dwordx4 v26, s[36:39], s25 offen offset:0  lds
buffer_load_dwordx4 v27, s[36:39], s25 offen offset:1024  lds
buffer_load_dwordx4 v28, s[36:39], s25 offen offset:2048  lds
buffer_load_dwordx4 v29, s[36:39], s25 offen offset:3072  lds
s_add_u32 m0, s50, s31
s_add_u32 s25, s30, s45
s_mov_b32 exec_hi, 0
buffer_load_dwordx4 v5, s[36:39], s25 offen  lds
s_mov_b32 exec_hi, -1
s_add_u32 s45, s45, 128
s_and_b32 s45, s45, 2047
s_add_u32 s50, s50, 51200
s_cmp_ge_u32 s50, 143360
s_cselect_b32 s50, s27, s50
s_add_u32 m0, s20, 0
s_nop 0
buffer_load_dwordx4 v2, s[8:11], s21 offen  lds
s_add_u32 m0, s20, 4096
s_add_u32 s25, s21, 2048
buffer_load_dwordx4 v2, s[8:11], s25 offen  lds
s_add_u32 m0, s20, 8192
s_add_u32 s25, s21, 4096
buffer_load_dwordx4 v2, s[8:11], s25 offen  lds
s_add_u32 m0, s20, 12288
s_nop 0
buffer_load_dwordx4 v24, s[12:15], s22 offen  lds
s_add_u32 s21, s21, 196608
s_add_u32 s22, s22, 65536
s_and_b32 s22, s22, 2097151
s_sub_u32 s25, s21, 6291456
s_cselect_b32 s21, s21, s25
s_add_u32 s20, s20, 16384
s_cmp_ge_u32 s20, 143360
s_cselect_b32 s20, s26, s20
s_waitcnt vmcnt(13)
s_branch PC3
PL3:
buffer_load_dword v16, v10, s[4:7], s51 offen sc1
s_waitcnt vmcnt(0)
PC3:
v_cmp_gt_u32 vcc, 1, v16
s_nop 1
s_cmp_eq_u64 vcc, 0
s_cbranch_scc1 PD3
s_sub_u32 s49, s49, 1
s_cbranch_scc0 PL3
s_mov_b32 s49, 0
PD3:
s_lshl_b32 s19, s18, 14
s_add_u32 s19, s19, 38076416
buffer_load_dword v32, v20, s[4:7], s19 offen offset:0 sc1
buffer_load_dword v33, v20, s[4:7], s19 offen offset:1024 sc1
buffer_load_dword v34, v20, s[4:7], s19 offen offset:2048 sc1
buffer_load_dword v35, v20, s[4:7], s19 offen offset:3072 sc1
s_add_u32 s19, s19, 4096
buffer_load_dword v36, v20, s[4:7], s19 offen offset:0 sc1
buffer_load_dword v37, v20, s[4:7], s19 offen offset:1024 sc1
buffer_load_dword v38, v20, s[4:7], s19 offen offset:2048 sc1
buffer_load_dword v39, v20, s[4:7], s19 offen offset:3072 sc1
s_add_u32 s19, s19, 4096
buffer_load_dword v40, v20, s[4:7], s19 offen offset:0 sc1
buffer_load_dword v41, v20, s[4:7], s19 offen offset:1024 sc1
buffer_load_dword v42, v20, s[4:7], s19 offen offset:2048 sc1
buffer_load_dword v43, v20, s[4:7], s19 offen offset:3072 sc1
s_add_u32 s19, s19, 4096
buffer_load_dword v44, v20, s[4:7], s19 offen offset:0 sc1
buffer_load_dword v45, v20, s[4:7], s19 offen offset:1024 sc1
buffer_load_dword v46, v20, s[4:7], s19 offen offset:2048 sc1
buffer_load_dword v47, v20, s[4:7], s19 offen offset:3072 sc1
s_add_u32 s19, s19, 4096
v_min_u32 v21, 35, v0
v_lshlrev_b32 v21, 4, v21
s_mul_i32 s19, s16, 576
s_add_u32 s19, s19, 160768
v_add_u32 v22, s19, v21
s_lshl_b32 s19, s17, 9
s_sub_u32 s19, s19, 64
v_add_u32 v21, s19, v21
v_max_i32 v21, 0, v21
s_lshl_b32 s19, s16, 13
s_add_u32 s19, s19, 37748736
buffer_load_dwordx4 v[48:51], v21, s[4:7], s19 offen sc1
s_barrier
s_add_u32 m0, s20, 0
s_nop 0
buffer_load_dwordx4 v2, s[8:11], s21 offen  lds
s_add_u32 m0, s20, 4096
s_add_u32 s25, s21, 2048
buffer_load_dwordx4 v2, s[8:11], s25 offen  lds
s_add_u32 m0, s20, 8192
s_add_u32 s25, s21, 4096
buffer_load_dwordx4 v2, s[8:11], s25 offen  lds
s_add_u32 m0, s20, 12288
s_nop 0
buffer_load_dwordx4 v24, s[12:15], s22 offen  lds
s_add_u32 s21, s21, 196608
s_add_u32 s22, s22, 65536
s_add_u32 s20, s20, 34816
s_cmp_ge_u32 s20, 143360
s_cselect_b32 s20, s26, s20
s_barrier
s_add_u32 m0, s50, s29
s_add_u32 s25, s23, s45
buffer_load_dwordx4 v26, s[36:39], s25 offen offset:0  lds
buffer_load_dwordx4 v27, s[36:39], s25 offen offset:1024  lds
buffer_load_dwordx4 v28, s[36:39], s25 offen offset:2048  lds
buffer_load_dwordx4 v29, s[36:39], s25 offen offset:3072  lds
s_add_u32 m0, s50, s31
s_add_u32 s25, s30, s45
s_mov_b32 exec_hi, 0
buffer_load_dwordx4 v5, s[36:39], s25 offen  lds
s_mov_b32 exec_hi, -1
s_add_u32 s45, s45, 128
s_and_b32 s45, s45, 2047
s_add_u32 s50, s50, 51200
s_cmp_ge_u32 s50, 143360
s_cselect_b32 s50, s27, s50
s_add_u32 m0, s20, 0
s_nop 0
buffer_load_dwordx4 v2, s[8:11], s21 offen  lds
s_add_u32 m0, s20, 4096
s_add_u32 s25, s21, 2048
buffer_load_dwordx4 v2, s[8:11], s25 offen  lds
s_add_u32 m0, s20, 8192
s_add_u32 s25, s21, 4096
buffer_load_dwordx4 v2, s[8:11], s25 offen  lds
s_add_u32 m0, s20, 12288
s_nop 0
buffer_load_dwordx4 v24, s[12:15], s22 offen  lds
s_add_u32 s21, s21, 196608
s_add_u32 s22, s22, 65536
s_and_b32 s22, s22, 2097151
s_sub_u32 s25, s21, 6291456
s_cselect_b32 s21, s21, s25
s_add_u32 s20, s20, 16384
s_cmp_ge_u32 s20, 143360
s_cselect_b32 s20, s26, s20
s_waitcnt vmcnt(34)
s_barrier
s_add_u32 m0, s20, 0
s_nop 0
buffer_load_dwordx4 v2, s[8:11], s21 offen  lds
s_add_u32 m0, s20, 4096
s_add_u32 s25, s21, 2048
buffer_load_dwordx4 v2, s[8:11], s25 offen  lds
s_add_u32 m0, s20, 8192
s_add_u32 s25, s21, 4096
buffer_load_dwordx4 v2, s[8:11], s25 offen  lds
s_add_u32 m0, s20, 12288
s_nop 0
buffer_load_dwordx4 v24, s[12:15], s22 offen  lds
s_add_u32 s21, s21, 196608
s_add_u32 s22, s22, 65536
s_add_u32 s20, s20, 34816
s_cmp_ge_u32 s20, 143360
s_cselect_b32 s20, s26, s20
s_waitcnt vmcnt(34)
s_barrier
s_add_u32 m0, s50, s29
s_add_u32 s25, s23, s45
buffer_load_dwordx4 v26, s[36:39], s25 offen offset:0  lds
buffer_load_dwordx4 v27, s[36:39], s25 offen offset:1024  lds
buffer_load_dwordx4 v28, s[36:39], s25 offen offset:2048  lds
buffer_load_dwordx4 v29, s[36:39], s25 offen offset:3072  lds
s_add_u32 m0, s50, s31
s_add_u32 s25, s30, s45
s_mov_b32 exec_hi, 0
buffer_load_dwordx4 v5, s[36:39], s25 offen  lds
s_mov_b32 exec_hi, -1
s_add_u32 s45, s45, 128
s_and_b32 s45, s45, 2047
s_add_u32 s50, s50, 51200
s_cmp_ge_u32 s50, 143360
s_cselect_b32 s50, s27, s50
s_add_u32 m0, s20, 0
s_nop 0
buffer_load_dwordx4 v2, s[8:11], s21 offen  lds
s_add_u32 m0, s20, 4096
s_add_u32 s25, s21, 2048
buffer_load_dwordx4 v2, s[8:11], s25 offen  lds
s_add_u32 m0, s20, 8192
s_add_u32 s25, s21, 4096
buffer_load_dwordx4 v2, s[8:11], s25 offen  lds
s_add_u32 m0, s20, 12288
s_nop 0
buffer_load_dwordx4 v24, s[12:15], s22 offen  lds
s_add_u32 s21, s21, 196608
s_add_u32 s22, s22, 65536
s_and_b32 s22, s22, 2097151
s_sub_u32 s25, s21, 6291456
s_cselect_b32 s21, s21, s25
s_add_u32 s20, s20, 16384
s_cmp_ge_u32 s20, 143360
s_cselect_b32 s20, s26, s20
s_waitcnt vmcnt(26)
v_pk_add_f32 v[32:33], v[32:33], v[34:35]
v_pk_add_f32 v[32:33], v[32:33], v[36:37]
v_pk_add_f32 v[32:33], v[32:33], v[38:39]
v_pk_add_f32 v[32:33], v[32:33], v[40:41]
v_pk_add_f32 v[32:33], v[32:33], v[42:43]
v_pk_add_f32 v[32:33], v[32:33], v[44:45]
v_pk_add_f32 v[32:33], v[32:33], v[46:47]
v_add_f32 v32, v32, v33
v_add_u32 v21, 159744, v20
ds_write_b32 v21, v32
ds_write_b128 v22, v[48:51]
s_waitcnt lgkmcnt(0)
s_waitcnt vmcnt(17)
s_barrier
s_mul_i32 s19, s18, 448
s_and_b32 s19, s19, 0xffffff80
s_mul_i32 s25, s17, 458752
s_add_u32 s19, s19, s25
s_lshl_b32 s25, s16, 7
s_add_u32 s48, s19, s25
s_mov_b32 s60, s76
s_mov_b32 s61, s77
s_mov_b32 s62, 7340032
s_mov_b32 s63, 0x20000
buffer_load_dwordx4 v[80:83], v17, s[60:63], s48 offen
s_add_u32 s48, s48, 57344
buffer_load_dwordx4 v[84:87], v17, s[60:63], s48 offen
s_add_u32 s48, s48, 57344
buffer_load_dwordx4 v[88:91], v17, s[60:63], s48 offen
s_add_u32 s48, s48, 57344
buffer_load_dwordx4 v[92:95], v17, s[60:63], s48 offen
s_add_u32 s48, s48, 57344
s_mul_i32 s21, s18, 131072
s_add_u32 s21, s21, 0
s_add_u32 m0, s20, 0
s_nop 0
buffer_load_dwordx4 v30, s[4:7], s21 offen sc1 lds
s_add_u32 m0, s20, 4096
s_add_u32 s25, s21, 4096
buffer_load_dwordx4 v30, s[4:7], s25 offen sc1 lds
s_add_u32 s21, s21, 8192
s_add_u32 s20, s20, 25600
s_cmp_ge_u32 s20, 143360
s_cselect_b32 s20, s26, s20
s_waitcnt vmcnt(19)
s_barrier
buffer_load_dwordx4 v[96:99], v17, s[60:63], s48 offen
s_add_u32 s48, s48, 57344
buffer_load_dwordx4 v[100:103], v17, s[60:63], s48 offen
s_add_u32 s48, s48, 57344
buffer_load_dwordx4 v[104:107], v17, s[60:63], s48 offen
s_add_u32 s48, s48, 57344
buffer_load_dwordx4 v[108:111], v17, s[60:63], s48 offen
s_add_u32 s48, s48, 57344
s_add_u32 m0, s20, 0
s_nop 0
buffer_load_dwordx4 v30, s[4:7], s21 offen sc1 lds
s_add_u32 m0, s20, 4096
s_add_u32 s25, s21, 4096
buffer_load_dwordx4 v30, s[4:7], s25 offen sc1 lds
s_add_u32 s21, s21, 8192
s_add_u32 s20, s20, 25600
s_cmp_ge_u32 s20, 143360
s_cselect_b32 s20, s26, s20
s_waitcnt vmcnt(16)
s_barrier
s_add_u32 m0, s20, 0
s_nop 0
buffer_load_dwordx4 v30, s[4:7], s21 offen sc1 lds
s_add_u32 m0, s20, 4096
s_add_u32 s25, s21, 4096
buffer_load_dwordx4 v30, s[4:7], s25 offen sc1 lds
s_add_u32 s21, s21, 8192
s_add_u32 s20, s20, 25600
s_cmp_ge_u32 s20, 143360
s_cselect_b32 s20, s26, s20
s_waitcnt vmcnt(14)
s_barrier
s_add_u32 m0, s20, 0
s_nop 0
buffer_load_dwordx4 v30, s[4:7], s21 offen sc1 lds
s_add_u32 m0, s20, 4096
s_add_u32 s25, s21, 4096
buffer_load_dwordx4 v30, s[4:7], s25 offen sc1 lds
s_add_u32 s21, s21, 8192
s_add_u32 s20, s20, 25600
s_cmp_ge_u32 s20, 143360
s_cselect_b32 s20, s26, s20
s_barrier
s_add_u32 m0, s20, 0
s_nop 0
buffer_load_dwordx4 v30, s[4:7], s21 offen sc1 lds
s_add_u32 m0, s20, 4096
s_add_u32 s25, s21, 4096
buffer_load_dwordx4 v30, s[4:7], s25 offen sc1 lds
s_add_u32 s21, s21, 8192
s_add_u32 s20, s20, 25600
s_cmp_ge_u32 s20, 143360
s_cselect_b32 s20, s26, s20
s_add_u32 m0, s20, 0
s_nop 0
buffer_load_dwordx4 v30, s[4:7], s21 offen sc1 lds
s_add_u32 m0, s20, 4096
s_add_u32 s25, s21, 4096
buffer_load_dwordx4 v30, s[4:7], s25 offen sc1 lds
s_add_u32 s21, s21, 8192
s_add_u32 s20, s20, 25600
s_cmp_ge_u32 s20, 143360
s_cselect_b32 s20, s26, s20
s_barrier
s_cmp_lg_u32 s16, 0
s_cbranch_scc1 NF4
v_mov_b32 v14, 2
s_mov_b64 exec, 1
buffer_store_dword v14, v15, s[4:7], s51 offen sc1
s_mov_b64 exec, -1
NF4:
v_and_b32 v31, 15, v0
v_min_u32 v31, 6, v31
v_xor_b32 v31, 4, v31
v_lshlrev_b32 v31, 7, v31
v_and_b32 v16, 0x7800, v11
v_or_b32 v31, v31, v16
PL5:
buffer_load_dword v16, v31, s[4:7], s51 offen sc1
s_waitcnt vmcnt(0)
PC5:
v_cmp_gt_u32 vcc, 2, v16
s_nop 1
s_cmp_eq_u64 vcc, 0
s_cbranch_scc1 PD5
s_sub_u32 s49, s49, 1
s_cbranch_scc0 PL5
s_mov_b32 s49, 0
PD5:
s_lshl_b32 s23, s17, 13
s_add_u32 s23, s23, 4194304
s_add_u32 m0, s50, 8192
s_nop 0
buffer_load_dwordx4 v4, s[4:7], s23 offen offset:0 sc1 lds
buffer_load_dwordx4 v4, s[4:7], s23 offen offset:1024 sc1 lds
s_add_u32 s23, s23, 131072
s_add_u32 m0, s50, 16384
s_nop 0
buffer_load_dwordx4 v4, s[4:7], s23 offen offset:0 sc1 lds
buffer_load_dwordx4 v4, s[4:7], s23 offen offset:1024 sc1 lds
s_add_u32 s23, s23, 131072
s_add_u32 s50, s50, 25600
s_cmp_ge_u32 s50, 143360
s_cselect_b32 s50, s27, s50
s_add_u32 m0, s50, 8192
s_nop 0
buffer_load_dwordx4 v4, s[4:7], s23 offen offset:0 sc1 lds
buffer_load_dwordx4 v4, s[4:7], s23 offen offset:1024 sc1 lds
s_add_u32 s23, s23, 131072
s_add_u32 m0, s50, 16384
s_nop 0
buffer_load_dwordx4 v4, s[4:7], s23 offen offset:0 sc1 lds
buffer_load_dwordx4 v4, s[4:7], s23 offen offset:1024 sc1 lds
s_add_u32 s23, s23, 131072
s_add_u32 s50, s50, 25600
s_cmp_ge_u32 s50, 143360
s_cselect_b32 s50, s27, s50
s_add_u32 m0, s50, 8192
s_nop 0
buffer_load_dwordx4 v4, s[4:7], s23 offen offset:0 sc1 lds
buffer_load_dwordx4 v4, s[4:7], s23 offen offset:1024 sc1 lds
s_add_u32 s23, s23, 131072
s_add_u32 m0, s50, 16384
s_nop 0
buffer_load_dwordx4 v4, s[4:7], s23 offen offset:0 sc1 lds
buffer_load_dwordx4 v4, s[4:7], s23 offen offset:1024 sc1 lds
s_add_u32 s23, s23, 131072
s_add_u32 s50, s50, 25600
s_cmp_ge_u32 s50, 143360
s_cselect_b32 s50, s27, s50
s_add_u32 m0, s50, 8192
s_nop 0
buffer_load_dwordx4 v4, s[4:7], s23 offen offset:0 sc1 lds
buffer_load_dwordx4 v4, s[4:7], s23 offen offset:1024 sc1 lds
s_add_u32 s23, s23, 131072
s_add_u32 m0, s50, 16384
s_nop 0
buffer_load_dwordx4 v4, s[4:7], s23 offen offset:0 sc1 lds
buffer_load_dwordx4 v4, s[4:7], s23 offen offset:1024 sc1 lds
s_add_u32 s23, s23, 131072
s_add_u32 s50, s50, 25600
s_cmp_ge_u32 s50, 143360
s_cselect_b32 s50, s27, s50
s_add_u32 m0, s50, 8192
s_nop 0
buffer_load_dwordx4 v4, s[4:7], s23 offen offset:0 sc1 lds
buffer_load_dwordx4 v4, s[4:7], s23 offen offset:1024 sc1 lds
s_add_u32 s23, s23, 131072
s_add_u32 m0, s50, 16384
s_nop 0
buffer_load_dwordx4 v4, s[4:7], s23 offen offset:0 sc1 lds
buffer_load_dwordx4 v4, s[4:7], s23 offen offset:1024 sc1 lds
s_add_u32 s23, s23, 131072
s_add_u32 s50, s50, 25600
s_cmp_ge_u32 s50, 143360
s_cselect_b32 s50, s27, s50
s_add_u32 m0, s50, 8192
s_nop 0
buffer_load_dwordx4 v4, s[4:7], s23 offen offset:0 sc1 lds
buffer_load_dwordx4 v4, s[4:7], s23 offen offset:1024 sc1 lds
s_add_u32 s23, s23, 131072
s_add_u32 m0, s50, 16384
s_nop 0
buffer_load_dwordx4 v4, s[4:7], s23 offen offset:0 sc1 lds
buffer_load_dwordx4 v4, s[4:7], s23 offen offset:1024 sc1 lds
s_add_u32 s23, s23, 131072
s_add_u32 s50, s50, 25600
s_cmp_ge_u32 s50, 143360
s_cselect_b32 s50, s27, s50
v_and_b32 v113, 0xffff0000, v80
v_lshlrev_b32 v112, 16, v80
v_and_b32 v115, 0xffff0000, v81
v_lshlrev_b32 v114, 16, v81
v_and_b32 v117, 0xffff0000, v82
v_lshlrev_b32 v116, 16, v82
v_and_b32 v119, 0xffff0000, v83
v_lshlrev_b32 v118, 16, v83
v_and_b32 v121, 0xffff0000, v84
v_lshlrev_b32 v120, 16, v84
v_and_b32 v123, 0xffff0000, v85
v_lshlrev_b32 v122, 16, v85
v_and_b32 v125, 0xffff0000, v86
v_lshlrev_b32 v124, 16, v86
v_and_b32 v127, 0xffff0000, v87
v_lshlrev_b32 v126, 16, v87
v_pk_add_f32 v[112:113], v[112:113], v[120:121]
v_pk_add_f32 v[114:115], v[114:115], v[122:123]
v_pk_add_f32 v[116:117], v[116:117], v[124:125]
v_pk_add_f32 v[118:119], v[118:119], v[126:127]
v_and_b32 v121, 0xffff0000, v88
v_lshlrev_b32 v120, 16, v88
v_and_b32 v123, 0xffff0000, v89
v_lshlrev_b32 v122, 16, v89
v_and_b32 v125, 0xffff0000, v90
v_lshlrev_b32 v124, 16, v90
v_and_b32 v127, 0xffff0000, v91
v_lshlrev_b32 v126, 16, v91
v_pk_add_f32 v[112:113], v[112:113], v[120:121]
v_pk_add_f32 v[114:115], v[114:115], v[122:123]
v_pk_add_f32 v[116:117], v[116:117], v[124:125]
v_pk_add_f32 v[118:119], v[118:119], v[126:127]
v_and_b32 v121, 0xffff0000, v92
v_lshlrev_b32 v120, 16, v92
v_and_b32 v123, 0xffff0000, v93
v_lshlrev_b32 v122, 16, v93
v_and_b32 v125, 0xffff0000, v94
v_lshlrev_b32 v124, 16, v94
v_and_b32 v127, 0xffff0000, v95
v_lshlrev_b32 v126, 16, v95
v_pk_add_f32 v[112:113], v[112:113], v[120:121]
v_pk_add_f32 v[114:115], v[114:115], v[122:123]
v_pk_add_f32 v[116:117], v[116:117], v[124:125]
v_pk_add_f32 v[118:119], v[118:119], v[126:127]
v_and_b32 v121, 0xffff0000, v96
v_lshlrev_b32 v120, 16, v96
v_and_b32 v123, 0xffff0000, v97
v_lshlrev_b32 v122, 16, v97
v_and_b32 v125, 0xffff0000, v98
v_lshlrev_b32 v124, 16, v98
v_and_b32 v127, 0xffff0000, v99
v_lshlrev_b32 v126, 16, v99
v_pk_add_f32 v[112:113], v[112:113], v[120:121]
v_pk_add_f32 v[114:115], v[114:115], v[122:123]
v_pk_add_f32 v[116:117], v[116:117], v[124:125]
v_pk_add_f32 v[118:119], v[118:119], v[126:127]
v_and_b32 v121, 0xffff0000, v100
v_lshlrev_b32 v120, 16, v100
v_and_b32 v123, 0xffff0000, v101
v_lshlrev_b32 v122, 16, v101
v_and_b32 v125, 0xffff0000, v102
v_lshlrev_b32 v124, 16, v102
v_and_b32 v127, 0xffff0000, v103
v_lshlrev_b32 v126, 16, v103
v_pk_add_f32 v[112:113], v[112:113], v[120:121]
v_pk_add_f32 v[114:115], v[114:115], v[122:123]
v_pk_add_f32 v[116:117], v[116:117], v[124:125]
v_pk_add_f32 v[118:119], v[118:119], v[126:127]
v_and_b32 v121, 0xffff0000, v104
v_lshlrev_b32 v120, 16, v104
v_and_b32 v123, 0xffff0000, v105
v_lshlrev_b32 v122, 16, v105
v_and_b32 v125, 0xffff0000, v106
v_lshlrev_b32 v124, 16, v106
v_and_b32 v127, 0xffff0000, v107
v_lshlrev_b32 v126, 16, v107
v_pk_add_f32 v[112:113], v[112:113], v[120:121]
v_pk_add_f32 v[114:115], v[114:115], v[122:123]
v_pk_add_f32 v[116:117], v[116:117], v[124:125]
v_pk_add_f32 v[118:119], v[118:119], v[126:127]
v_and_b32 v121, 0xffff0000, v108
v_lshlrev_b32 v120, 16, v108
v_and_b32 v123, 0xffff0000, v109
v_lshlrev_b32 v122, 16, v109
v_and_b32 v125, 0xffff0000, v110
v_lshlrev_b32 v124, 16, v110
v_and_b32 v127, 0xffff0000, v111
v_lshlrev_b32 v126, 16, v111
v_pk_add_f32 v[112:113], v[112:113], v[120:121]
v_pk_add_f32 v[114:115], v[114:115], v[122:123]
v_pk_add_f32 v[116:117], v[116:117], v[124:125]
v_pk_add_f32 v[118:119], v[118:119], v[126:127]
v_add_f32_dpp v112, v112, v112 row_ror:8 row_mask:0xf bank_mask:0xf
v_add_f32_dpp v113, v113, v113 row_ror:8 row_mask:0xf bank_mask:0xf
v_add_f32_dpp v114, v114, v114 row_ror:8 row_mask:0xf bank_mask:0xf
v_add_f32_dpp v115, v115, v115 row_ror:8 row_mask:0xf bank_mask:0xf
v_add_f32_dpp v116, v116, v116 row_ror:8 row_mask:0xf bank_mask:0xf
v_add_f32_dpp v117, v117, v117 row_ror:8 row_mask:0xf bank_mask:0xf
v_add_f32_dpp v118, v118, v118 row_ror:8 row_mask:0xf bank_mask:0xf
v_add_f32_dpp v119, v119, v119 row_ror:8 row_mask:0xf bank_mask:0xf
v_permlane16_swap_b32 v112, v116
v_permlane16_swap_b32 v113, v117
v_permlane16_swap_b32 v114, v118
v_permlane16_swap_b32 v115, v119
v_add_f32 v112, v112, v116
v_mov_b32 v116, v112
v_add_f32 v113, v113, v117
v_mov_b32 v117, v113
v_add_f32 v114, v114, v118
v_mov_b32 v118, v114
v_add_f32 v115, v115, v119
v_mov_b32 v119, v115
v_permlane32_swap_b32 v112, v116
v_permlane32_swap_b32 v113, v117
v_permlane32_swap_b32 v114, v118
v_permlane32_swap_b32 v115, v119
v_add_f32 v112, v112, v116
v_add_f32 v113, v113, v117
v_add_f32 v114, v114, v118
v_add_f32 v115, v115, v119
s_add_u32 s19, s32, 37814272
s_mov_b64 exec, 0xff00ff
buffer_store_dwordx4 v[112:115], v19, s[4:7], s19 offen sc1
s_mov_b64 exec, -1
s_waitcnt vmcnt(21)
s_barrier
s_cmp_lg_u32 s16, 0
s_cbranch_scc1 NF6
v_mov_b32 v14, 3
s_mov_b64 exec, 1
buffer_store_dword v14, v15, s[4:7], s51 offen sc1
s_mov_b64 exec, -1
NF6:
s_waitcnt vmcnt(17)
s_barrier
buffer_load_dword v16, v11, s[4:7], s51 offen sc1
s_add_u32 m0, s50, 8192
s_nop 0
buffer_load_dwordx4 v4, s[4:7], s23 offen offset:0 sc1 lds
buffer_load_dwordx4 v4, s[4:7], s23 offen offset:1024 sc1 lds
s_add_u32 s23, s23, 131072
s_add_u32 m0, s50, 16384
s_nop 0
buffer_load_dwordx4 v4, s[4:7], s23 offen offset:0 sc1 lds
buffer_load_dwordx4 v4, s[4:7], s23 offen offset:1024 sc1 lds
s_add_u32 s23, s23, 131072
s_add_u32 s50, s50, 25600
s_cmp_ge_u32 s50, 143360
s_cselect_b32 s50, s27, s50
s_add_u32 m0, s20, 0
s_nop 0
buffer_load_dwordx4 v30, s[4:7], s21 offen sc1 lds
s_add_u32 m0, s20, 4096
s_add_u32 s25, s21, 4096
buffer_load_dwordx4 v30, s[4:7], s25 offen sc1 lds
s_add_u32 s21, s21, 8192
s_add_u32 s20, s20, 25600
s_cmp_ge_u32 s20, 143360
s_cselect_b32 s20, s26, s20
s_waitcnt vmcnt(20)
s_barrier
s_waitcnt vmcnt(6)
s_branch PC7
PL7:
buffer_load_dword v16, v11, s[4:7], s51 offen sc1
s_waitcnt vmcnt(0)
PC7:
v_cmp_gt_u32 vcc, 2, v16
s_nop 1
s_cmp_eq_u64 vcc, 0
s_cbranch_scc1 PD7
s_sub_u32 s49, s49, 1
s_cbranch_scc0 PL7
s_mov_b32 s49, 0
PD7:
s_add_u32 m0, s50, 8192
s_nop 0
buffer_load_dwordx4 v4, s[4:7], s23 offen offset:0 sc1 lds
buffer_load_dwordx4 v4, s[4:7], s23 offen offset:1024 sc1 lds
s_add_u32 s23, s23, 131072
s_add_u32 m0, s50, 16384
s_nop 0
buffer_load_dwordx4 v4, s[4:7], s23 offen offset:0 sc1 lds
buffer_load_dwordx4 v4, s[4:7], s23 offen offset:1024 sc1 lds
s_add_u32 s23, s23, 131072
s_add_u32 s50, s50, 25600
s_cmp_ge_u32 s50, 143360
s_cselect_b32 s50, s27, s50
s_add_u32 m0, s20, 0
s_nop 0
buffer_load_dwordx4 v30, s[4:7], s21 offen sc1 lds
s_add_u32 m0, s20, 4096
s_add_u32 s25, s21, 4096
buffer_load_dwordx4 v30, s[4:7], s25 offen sc1 lds
s_add_u32 s21, s21, 8192
s_add_u32 s20, s20, 25600
s_cmp_ge_u32 s20, 143360
s_cselect_b32 s20, s26, s20
s_mov_b32 s24, 3
PS1:
s_barrier
s_add_u32 m0, s50, 8192
s_nop 0
buffer_load_dwordx4 v4, s[4:7], s23 offen offset:0 sc1 lds
buffer_load_dwordx4 v4, s[4:7], s23 offen offset:1024 sc1 lds
s_add_u32 s23, s23, 131072
s_add_u32 m0, s50, 16384
s_nop 0
buffer_load_dwordx4 v4, s[4:7], s23 offen offset:0 sc1 lds
buffer_load_dwordx4 v4, s[4:7], s23 offen offset:1024 sc1 lds
s_add_u32 s23, s23, 131072
s_add_u32 s50, s50, 25600
s_cmp_ge_u32 s50, 143360
s_cselect_b32 s50, s27, s50
s_add_u32 m0, s20, 0
s_nop 0
buffer_load_dwordx4 v30, s[4:7], s21 offen sc1 lds
s_add_u32 m0, s20, 4096
s_add_u32 s25, s21, 4096
buffer_load_dwordx4 v30, s[4:7], s25 offen sc1 lds
s_add_u32 s21, s21, 8192
s_add_u32 s20, s20, 25600
s_cmp_ge_u32 s20, 143360
s_cselect_b32 s20, s26, s20
s_sub_u32 s24, s24, 1
s_cmp_lg_u32 s24, 0
s_cbranch_scc1 PS1
s_waitcnt vmcnt(24)
s_barrier
buffer_load_dword v16, v12, s[4:7], s51 offen sc1
s_add_u32 m0, s50, 8192
s_nop 0
buffer_load_dwordx4 v4, s[4:7], s23 offen offset:0 sc1 lds
buffer_load_dwordx4 v4, s[4:7], s23 offen offset:1024 sc1 lds
s_add_u32 s23, s23, 131072
s_add_u32 m0, s50, 16384
s_nop 0
buffer_load_dwordx4 v4, s[4:7], s23 offen offset:0 sc1 lds
buffer_load_dwordx4 v4, s[4:7], s23 offen offset:1024 sc1 lds
s_add_u32 s23, s23, 131072
s_add_u32 s50, s50, 25600
s_cmp_ge_u32 s50, 143360
s_cselect_b32 s50, s27, s50
s_add_u32 m0, s20, 0
s_nop 0
buffer_load_dwordx4 v30, s[4:7], s21 offen sc1 lds
s_add_u32 m0, s20, 4096
s_add_u32 s25, s21, 4096
buffer_load_dwordx4 v30, s[4:7], s25 offen sc1 lds
s_add_u32 s21, s21, 8192
s_add_u32 s20, s20, 25600
s_cmp_ge_u32 s20, 143360
s_cselect_b32 s20, s26, s20
s_mov_b32 s24, 4
PS2:
s_waitcnt vmcnt(25)
s_barrier
s_add_u32 m0, s50, 8192
s_nop 0
buffer_load_dwordx4 v4, s[4:7], s23 offen offset:0 sc1 lds
buffer_load_dwordx4 v4, s[4:7], s23 offen offset:1024 sc1 lds
s_add_u32 s23, s23, 131072
s_add_u32 m0, s50, 16384
s_nop 0
buffer_load_dwordx4 v4, s[4:7], s23 offen offset:0 sc1 lds
buffer_load_dwordx4 v4, s[4:7], s23 offen offset:1024 sc1 lds
s_add_u32 s23, s23, 131072
s_add_u32 s50, s50, 25600
s_cmp_ge_u32 s50, 143360
s_cselect_b32 s50, s27, s50
s_add_u32 m0, s20, 0
s_nop 0
buffer_load_dwordx4 v30, s[4:7], s21 offen sc1 lds
s_add_u32 m0, s20, 4096
s_add_u32 s25, s21, 4096
buffer_load_dwordx4 v30, s[4:7], s25 offen sc1 lds
s_add_u32 s21, s21, 8192
s_add_u32 s20, s20, 25600
s_cmp_ge_u32 s20, 143360
s_cselect_b32 s20, s26, s20
s_sub_u32 s24, s24, 1
s_cmp_lg_u32 s24, 0
s_cbranch_scc1 PS2
s_waitcnt vmcnt(24)
s_barrier
s_branch PC8
PL8:
buffer_load_dword v16, v12, s[4:7], s51 offen sc1
s_waitcnt vmcnt(0)
PC8:
v_cmp_gt_u32 vcc, 3, v16
s_nop 1
s_cmp_eq_u64 vcc, 0
s_cbranch_scc1 PD8
s_sub_u32 s49, s49, 1
s_cbranch_scc0 PL8
s_mov_b32 s49, 0
PD8:
s_lshl_b32 s23, s17, 13
s_add_u32 s23, s23, 8388608
s_add_u32 m0, s50, 8192
s_nop 0
buffer_load_dwordx4 v4, s[4:7], s23 offen offset:0 sc1 lds
buffer_load_dwordx4 v4, s[4:7], s23 offen offset:1024 sc1 lds
s_add_u32 s23, s23, 131072
s_add_u32 m0, s50, 16384
s_nop 0
buffer_load_dwordx4 v4, s[4:7], s23 offen offset:0 sc1 lds
buffer_load_dwordx4 v4, s[4:7], s23 offen offset:1024 sc1 lds
s_add_u32 s23, s23, 131072
s_add_u32 s50, s50, 25600
s_cmp_ge_u32 s50, 143360
s_cselect_b32 s50, s27, s50
s_mul_i32 s21, s18, 131072
s_add_u32 s21, s21, 2097152
s_add_u32 m0, s20, 0
s_nop 0
buffer_load_dwordx4 v30, s[4:7], s21 offen sc1 lds
s_add_u32 m0, s20, 4096
s_add_u32 s25, s21, 4096
buffer_load_dwordx4 v30, s[4:7], s25 offen sc1 lds
s_add_u32 s21, s21, 8192
s_add_u32 s20, s20, 25600
s_cmp_ge_u32 s20, 143360
s_cselect_b32 s20, s26, s20
s_mov_b32 s24, 7
PS3:
s_waitcnt vmcnt(24)
s_barrier
s_add_u32 m0, s50, 8192
s_nop 0
buffer_load_dwordx4 v4, s[4:7], s23 offen offset:0 sc1 lds
buffer_load_dwordx4 v4, s[4:7], s23 offen offset:1024 sc1 lds
s_add_u32 s23, s23, 131072
s_add_u32 m0, s50, 16384
s_nop 0
buffer_load_dwordx4 v4, s[4:7], s23 offen offset:0 sc1 lds
buffer_load_dwordx4 v4, s[4:7], s23 offen offset:1024 sc1 lds
s_add_u32 s23, s23, 131072
s_add_u32 s50, s50, 25600
s_cmp_ge_u32 s50, 143360
s_cselect_b32 s50, s27, s50
s_add_u32 m0, s20, 0
s_nop 0
buffer_load_dwordx4 v30, s[4:7], s21 offen sc1 lds
s_add_u32 m0, s20, 4096
s_add_u32 s25, s21, 4096
buffer_load_dwordx4 v30, s[4:7], s25 offen sc1 lds
s_add_u32 s21, s21, 8192
s_add_u32 s20, s20, 25600
s_cmp_ge_u32 s20, 143360
s_cselect_b32 s20, s26, s20
s_sub_u32 s24, s24, 1
s_cmp_lg_u32 s24, 0
s_cbranch_scc1 PS3
s_waitcnt vmcnt(24)
s_barrier
s_cmp_lg_u32 s16, 0
s_cbranch_scc1 NF9
v_mov_b32 v14, 4
s_mov_b64 exec, 1
buffer_store_dword v14, v15, s[4:7], s51 offen sc1
s_mov_b64 exec, -1
NF9:
v_min_u32 v31, 2, v0
s_lshl_b32 s19, s17, 11
v_lshl_add_u32 v31, v31, 7, s19
PL10:
buffer_load_dword v16, v31, s[4:7], s51 offen sc1
s_waitcnt vmcnt(0)
PC10:
v_cmp_gt_u32 vcc, 4, v16
s_nop 1
s_cmp_eq_u64 vcc, 0
s_cbranch_scc1 PD10
s_sub_u32 s49, s49, 1
s_cbranch_scc0 PL10
s_mov_b32 s49, 0
PD10:
s_lshl_b32 s23, s17, 13
s_add_u32 s23, s23, 12582912
s_add_u32 m0, s50, 16384
s_nop 0
buffer_load_dwordx4 v4, s[4:7], s23 offen offset:0 sc1 lds
buffer_load_dwordx4 v4, s[4:7], s23 offen offset:1024 sc1 lds
s_add_u32 s23, s23, 131072
s_add_u32 s50, s50, 25600
s_cmp_ge_u32 s50, 143360
s_cselect_b32 s50, s27, s50
s_mul_i32 s21, s18, 448
s_and_b32 s21, s21, 0xffffff80
s_mov_b32 s8, s76
s_mov_b32 s9, s77
s_mov_b32 s10, 7340032
s_mov_b32 s11, 0x20000
s_add_u32 m0, s20, 0
s_nop 0
buffer_load_dwordx4 v9, s[8:11], s21 offen  lds
s_add_u32 m0, s20, 4096
s_add_u32 s25, s21, 128
buffer_load_dwordx4 v9, s[8:11], s25 offen  lds
s_add_u32 m0, s20, 8192
s_add_u32 s25, s21, 256
buffer_load_dwordx4 v9, s[8:11], s25 offen  lds
s_add_u32 m0, s20, 12288
s_add_u32 s25, s21, 384
buffer_load_dwordx4 v9, s[8:11], s25 offen  lds
s_add_u32 s21, s21, 229376
s_add_u32 s20, s20, 25600
s_cmp_ge_u32 s20, 143360
s_cselect_b32 s20, s26, s20
s_barrier
s_add_u32 m0, s50, 16384
s_nop 0
buffer_load_dwordx4 v4, s[4:7], s23 offen offset:0 sc1 lds
buffer_load_dwordx4 v4, s[4:7], s23 offen offset:1024 sc1 lds
s_add_u32 s23, s23, 131072
s_add_u32 s50, s50, 25600
s_cmp_ge_u32 s50, 143360
s_cselect_b32 s50, s27, s50
s_add_u32 m0, s20, 0
s_nop 0
buffer_load_dwordx4 v9, s[8:11], s21 offen  lds
s_add_u32 m0, s20, 4096
s_add_u32 s25, s21, 128
buffer_load_dwordx4 v9, s[8:11], s25 offen  lds
s_add_u32 m0, s20, 8192
s_add_u32 s25, s21, 256
buffer_load_dwordx4 v9, s[8:11], s25 offen  lds
s_add_u32 m0, s20, 12288
s_add_u32 s25, s21, 384
buffer_load_dwordx4 v9, s[8:11], s25 offen  lds
s_add_u32 s21, s21, 229376
s_add_u32 s20, s20, 25600
s_cmp_ge_u32 s20, 143360
s_cselect_b32 s20, s26, s20
s_barrier
s_add_u32 m0, s50, 16384
s_nop 0
buffer_load_dwordx4 v4, s[4:7], s23 offen offset:0 sc1 lds
buffer_load_dwordx4 v4, s[4:7], s23 offen offset:1024 sc1 lds
s_add_u32 s23, s23, 131072
s_add_u32 s50, s50, 25600
s_cmp_ge_u32 s50, 143360
s_cselect_b32 s50, s27, s50
s_add_u32 m0, s20, 0
s_nop 0
buffer_load_dwordx4 v9, s[8:11], s21 offen  lds
s_add_u32 m0, s20, 4096
s_add_u32 s25, s21, 128
buffer_load_dwordx4 v9, s[8:11], s25 offen  lds
s_add_u32 m0, s20, 8192
s_add_u32 s25, s21, 256
buffer_load_dwordx4 v9, s[8:11], s25 offen  lds
s_add_u32 m0, s20, 12288
s_add_u32 s25, s21, 384
buffer_load_dwordx4 v9, s[8:11], s25 offen  lds
s_add_u32 s21, s21, 229376
s_add_u32 s20, s20, 25600
s_cmp_ge_u32 s20, 143360
s_cselect_b32 s20, s26, s20
s_barrier
buffer_load_dword v16, v12, s[4:7], s51 offen sc1
s_add_u32 m0, s50, 16384
s_nop 0
buffer_load_dwordx4 v4, s[4:7], s23 offen offset:0 sc1 lds
buffer_load_dwordx4 v4, s[4:7], s23 offen offset:1024 sc1 lds
s_add_u32 s23, s23, 131072
s_add_u32 s50, s50, 25600
s_cmp_ge_u32 s50, 143360
s_cselect_b32 s50, s27, s50
s_add_u32 m0, s20, 0
s_nop 0
buffer_load_dwordx4 v9, s[8:11], s21 offen  lds
s_add_u32 m0, s20, 4096
s_add_u32 s25, s21, 128
buffer_load_dwordx4 v9, s[8:11], s25 offen  lds
s_add_u32 m0, s20, 8192
s_add_u32 s25, s21, 256
buffer_load_dwordx4 v9, s[8:11], s25 offen  lds
s_add_u32 m0, s20, 12288
s_add_u32 s25, s21, 384
buffer_load_dwordx4 v9, s[8:11], s25 offen  lds
s_add_u32 s21, s21, 229376
s_add_u32 s20, s20, 25600
s_cmp_ge_u32 s20, 143360
s_cselect_b32 s20, s26, s20
s_barrier
s_add_u32 m0, s50, 16384
s_nop 0
buffer_load_dwordx4 v4, s[4:7], s23 offen offset:0 sc1 lds
buffer_load_dwordx4 v4, s[4:7], s23 offen offset:1024 sc1 lds
s_add_u32 s23, s23, 131072
s_add_u32 s50, s50, 25600
s_cmp_ge_u32 s50, 143360
s_cselect_b32 s50, s27, s50
s_add_u32 m0, s20, 0
s_nop 0
buffer_load_dwordx4 v9, s[8:11], s21 offen  lds
s_add_u32 m0, s20, 4096
s_add_u32 s25, s21, 128
buffer_load_dwordx4 v9, s[8:11], s25 offen  lds
s_add_u32 m0, s20, 8192
s_add_u32 s25, s21, 256
buffer_load_dwordx4 v9, s[8:11], s25 offen  lds
s_add_u32 m0, s20, 12288
s_add_u32 s25, s21, 384
buffer_load_dwordx4 v9, s[8:11], s25 offen  lds
s_add_u32 s21, s21, 229376
s_add_u32 s20, s20, 25600
s_cmp_ge_u32 s20, 143360
s_cselect_b32 s20, s26, s20
s_waitcnt vmcnt(25)
s_barrier
s_add_u32 m0, s50, 16384
s_nop 0
buffer_load_dwordx4 v4, s[4:7], s23 offen offset:0 sc1 lds
buffer_load_dwordx4 v4, s[4:7], s23 offen offset:1024 sc1 lds
s_add_u32 s23, s23, 131072
s_add_u32 s50, s50, 25600
s_cmp_ge_u32 s50, 143360
s_cselect_b32 s50, s27, s50
s_add_u32 m0, s20, 0
s_nop 0
buffer_load_dwordx4 v9, s[8:11], s21 offen  lds
s_add_u32 m0, s20, 4096
s_add_u32 s25, s21, 128
buffer_load_dwordx4 v9, s[8:11], s25 offen  lds
s_add_u32 m0, s20, 8192
s_add_u32 s25, s21, 256
buffer_load_dwordx4 v9, s[8:11], s25 offen  lds
s_add_u32 m0, s20, 12288
s_add_u32 s25, s21, 384
buffer_load_dwordx4 v9, s[8:11], s25 offen  lds
s_add_u32 s21, s21, 229376
s_add_u32 s20, s20, 25600
s_cmp_ge_u32 s20, 143360
s_cselect_b32 s20, s26, s20
s_waitcnt vmcnt(25)
s_barrier
s_mul_i32 s46, s17, 458752
s_lshl_b32 s19, s18, 7
s_add_u32 s46, s46, s19
s_mul_i32 s47, s18, 458752
s_mul_i32 s19, s17, 28672
s_add_u32 s47, s47, s19
s_add_u32 s47, s47, 39845888
s_mov_b32 s40, s78
s_mov_b32 s41, s79
s_mov_b32 s42, 7340032
s_mov_b32 s43, 0x20000
buffer_load_dwordx4 v[192:195], v3, s[40:43], s46 offen
s_add_u32 s46, s46, 65536
buffer_load_dwordx4 v[196:199], v3, s[40:43], s46 offen
s_add_u32 s46, s46, 65536
buffer_load_dwordx4 v[200:203], v3, s[40:43], s46 offen
s_add_u32 s46, s46, 65536
buffer_load_dwordx4 v[204:207], v3, s[40:43], s46 offen
s_add_u32 s46, s46, 65536
buffer_load_dwordx4 v[208:211], v3, s[40:43], s46 offen
s_add_u32 s46, s46, 65536
buffer_load_dwordx4 v[212:215], v3, s[40:43], s46 offen
s_add_u32 s46, s46, 65536
buffer_load_dwordx4 v[216:219], v3, s[40:43], s46 offen
s_add_u32 s46, s46, 65536
s_waitcnt vmcnt(25)
s_branch PC11
PL11:
buffer_load_dword v16, v12, s[4:7], s51 offen sc1
s_waitcnt vmcnt(0)
PC11:
v_cmp_gt_u32 vcc, 4, v16
s_nop 1
s_cmp_eq_u64 vcc, 0
s_cbranch_scc1 PD11
s_sub_u32 s49, s49, 1
s_cbranch_scc0 PL11
s_mov_b32 s49, 0
PD11:
s_barrier
buffer_load_dword v16, v13, s[4:7], s51 offen sc1
s_add_u32 m0, s50, 16384
s_nop 0
buffer_load_dwordx4 v4, s[4:7], s23 offen offset:0 sc1 lds
buffer_load_dwordx4 v4, s[4:7], s23 offen offset:1024 sc1 lds
s_add_u32 s23, s23, 131072
s_add_u32 s50, s50, 25600
s_cmp_ge_u32 s50, 143360
s_cselect_b32 s50, s27, s50
s_add_u32 m0, s20, 0
s_nop 0
buffer_load_dwordx4 v9, s[8:11], s21 offen  lds
s_add_u32 m0, s20, 4096
s_add_u32 s25, s21, 128
buffer_load_dwordx4 v9, s[8:11], s25 offen  lds
s_add_u32 m0, s20, 8192
s_add_u32 s25, s21, 256
buffer_load_dwordx4 v9, s[8:11], s25 offen  lds
s_add_u32 m0, s20, 12288
s_add_u32 s25, s21, 384
buffer_load_dwordx4 v9, s[8:11], s25 offen  lds
s_add_u32 s21, s21, 229376
s_add_u32 s20, s20, 25600
s_cmp_ge_u32 s20, 143360
s_cselect_b32 s20, s26, s20
s_mov_b32 s24, 3
PS4:
s_waitcnt vmcnt(26)
s_barrier
s_add_u32 m0, s50, 16384
s_nop 0
buffer_load_dwordx4 v4, s[4:7], s23 offen offset:0 sc1 lds
buffer_load_dwordx4 v4, s[4:7], s23 offen offset:1024 sc1 lds
s_add_u32 s23, s23, 131072
s_add_u32 s50, s50, 25600
s_cmp_ge_u32 s50, 143360
s_cselect_b32 s50, s27, s50
s_add_u32 m0, s20, 0
s_nop 0
buffer_load_dwordx4 v9, s[8:11], s21 offen  lds
s_add_u32 m0, s20, 4096
s_add_u32 s25, s21, 128
buffer_load_dwordx4 v9, s[8:11], s25 offen  lds
s_add_u32 m0, s20, 8192
s_add_u32 s25, s21, 256
buffer_load_dwordx4 v9, s[8:11], s25 offen  lds
s_add_u32 m0, s20, 12288
s_add_u32 s25, s21, 384
buffer_load_dwordx4 v9, s[8:11], s25 offen  lds
s_add_u32 s21, s21, 229376
s_add_u32 s20, s20, 25600
s_cmp_ge_u32 s20, 143360
s_cselect_b32 s20, s26, s20
s_sub_u32 s24, s24, 1
s_cmp_lg_u32 s24, 0
s_cbranch_scc1 PS4
s_waitcnt vmcnt(18)
s_barrier
s_branch PC12
PL12:
buffer_load_dword v16, v13, s[4:7], s51 offen sc1
s_waitcnt vmcnt(0)
PC12:
v_cmp_gt_u32 vcc, 4, v16
s_nop 1
s_cmp_eq_u64 vcc, 0
s_cbranch_scc1 PD12
s_sub_u32 s49, s49, 1
s_cbranch_scc0 PL12
s_mov_b32 s49, 0
PD12:
s_lshl_b32 s19, s18, 14
s_add_u32 s19, s19, 37814272
buffer_load_dword v32, v20, s[4:7], s19 offen offset:0 sc1
buffer_load_dword v33, v20, s[4:7], s19 offen offset:1024 sc1
buffer_load_dword v34, v20, s[4:7], s19 offen offset:2048 sc1
buffer_load_dword v35, v20, s[4:7], s19 offen offset:3072 sc1
s_add_u32 s19, s19, 4096
buffer_load_dword v36, v20, s[4:7], s19 offen offset:0 sc1
buffer_load_dword v37, v20, s[4:7], s19 offen offset:1024 sc1
buffer_load_dword v38, v20, s[4:7], s19 offen offset:2048 sc1
buffer_load_dword v39, v20, s[4:7], s19 offen offset:3072 sc1
s_add_u32 s19, s19, 4096
buffer_load_dword v40, v20, s[4:7], s19 offen offset:0 sc1
buffer_load_dword v41, v20, s[4:7], s19 offen offset:1024 sc1
buffer_load_dword v42, v20, s[4:7], s19 offen offset:2048 sc1
buffer_load_dword v43, v20, s[4:7], s19 offen offset:3072 sc1
s_add_u32 s19, s19, 4096
buffer_load_dword v44, v20, s[4:7], s19 offen offset:0 sc1
buffer_load_dword v45, v20, s[4:7], s19 offen offset:1024 sc1
buffer_load_dword v46, v20, s[4:7], s19 offen offset:2048 sc1
buffer_load_dword v47, v20, s[4:7], s19 offen offset:3072 sc1
s_add_u32 s19, s19, 4096
v_and_b32 v21, 31, v0
v_lshl_add_u32 v22, v21, 3, s28
v_lshrrev_b32 v21, 5, v0
v_lshl_add_u32 v21, v21, 17, v22
s_lshl_b32 s19, s17, 10
s_add_u32 s19, s19, 38797312
buffer_load_dwordx2 v[48:49], v21, s[4:7], s19 offen sc1
s_add_u32 s19, s19, 16384
buffer_load_dwordx2 v[50:51], v21, s[4:7], s19 offen sc1
s_add_u32 s19, s19, 16384
buffer_load_dwordx2 v[52:53], v21, s[4:7], s19 offen sc1
s_add_u32 s19, s19, 16384
buffer_load_dwordx2 v[54:55], v21, s[4:7], s19 offen sc1
s_add_u32 s19, s19, 16384
buffer_load_dwordx2 v[56:57], v21, s[4:7], s19 offen sc1
s_add_u32 s19, s19, 16384
buffer_load_dwordx2 v[58:59], v21, s[4:7], s19 offen sc1
s_add_u32 s19, s19, 16384
buffer_load_dwordx2 v[60:61], v21, s[4:7], s19 offen sc1
s_add_u32 s19, s19, 16384
buffer_load_dwordx2 v[62:63], v21, s[4:7], s19 offen sc1
s_add_u32 s19, s19, 16384
s_add_u32 m0, s50, 16384
s_nop 0
buffer_load_dwordx4 v4, s[4:7], s23 offen offset:0 sc1 lds
buffer_load_dwordx4 v4, s[4:7], s23 offen offset:1024 sc1 lds
s_add_u32 s23, s23, 131072
s_add_u32 s50, s50, 25600
s_cmp_ge_u32 s50, 143360
s_cselect_b32 s50, s27, s50
s_add_u32 m0, s20, 0
s_nop 0
buffer_load_dwordx4 v9, s[8:11], s21 offen  lds
s_add_u32 m0, s20, 4096
s_add_u32 s25, s21, 128
buffer_load_dwordx4 v9, s[8:11], s25 offen  lds
s_add_u32 m0, s20, 8192
s_add_u32 s25, s21, 256
buffer_load_dwordx4 v9, s[8:11], s25 offen  lds
s_add_u32 m0, s20, 12288
s_add_u32 s25, s21, 384
buffer_load_dwordx4 v9, s[8:11], s25 offen  lds
s_add_u32 s21, s21, 229376
s_add_u32 s20, s20, 25600
s_cmp_ge_u32 s20, 143360
s_cselect_b32 s20, s26, s20
s_mov_b32 s24, 3
PS5:
s_waitcnt vmcnt(42)
s_barrier
s_add_u32 m0, s50, 16384
s_nop 0
buffer_load_dwordx4 v4, s[4:7], s23 offen offset:0 sc1 lds
buffer_load_dwordx4 v4, s[4:7], s23 offen offset:1024 sc1 lds
s_add_u32 s23, s23, 131072
s_add_u32 s50, s50, 25600
s_cmp_ge_u32 s50, 143360
s_cselect_b32 s50, s27, s50
s_add_u32 m0, s20, 0
s_nop 0
buffer_load_dwordx4 v9, s[8:11], s21 offen  lds
s_add_u32 m0, s20, 4096
s_add_u32 s25, s21, 128
buffer_load_dwordx4 v9, s[8:11], s25 offen  lds
s_add_u32 m0, s20, 8192
s_add_u32 s25, s21, 256
buffer_load_dwordx4 v9, s[8:11], s25 offen  lds
s_add_u32 m0, s20, 12288
s_add_u32 s25, s21, 384
buffer_load_dwordx4 v9, s[8:11], s25 offen  lds
s_add_u32 s21, s21, 229376
s_add_u32 s20, s20, 25600
s_cmp_ge_u32 s20, 143360
s_cselect_b32 s20, s26, s20
s_sub_u32 s24, s24, 1
s_cmp_lg_u32 s24, 0
s_cbranch_scc1 PS5
s_waitcnt vmcnt(18)
s_barrier
s_add_u32 m0, s50, 16384
s_nop 0
buffer_load_dwordx4 v4, s[4:7], s23 offen offset:0 sc1 lds
buffer_load_dwordx4 v4, s[4:7], s23 offen offset:1024 sc1 lds
s_add_u32 s23, s23, 131072
s_add_u32 s50, s50, 25600
s_cmp_ge_u32 s50, 143360
s_cselect_b32 s50, s27, s50
s_add_u32 m0, s20, 0
s_nop 0
buffer_load_dwordx4 v9, s[8:11], s21 offen  lds
s_add_u32 m0, s20, 4096
s_add_u32 s25, s21, 128
buffer_load_dwordx4 v9, s[8:11], s25 offen  lds
s_add_u32 m0, s20, 8192
s_add_u32 s25, s21, 256
buffer_load_dwordx4 v9, s[8:11], s25 offen  lds
s_add_u32 m0, s20, 12288
s_add_u32 s25, s21, 384
buffer_load_dwordx4 v9, s[8:11], s25 offen  lds
s_add_u32 s21, s21, 229376
s_add_u32 s20, s20, 25600
s_cmp_ge_u32 s20, 143360
s_cselect_b32 s20, s26, s20
s_waitcnt vmcnt(18)
s_barrier
s_add_u32 m0, s50, 16384
s_nop 0
buffer_load_dwordx4 v4, s[4:7], s23 offen offset:0 sc1 lds
buffer_load_dwordx4 v4, s[4:7], s23 offen offset:1024 sc1 lds
s_add_u32 s23, s23, 131072
s_add_u32 s50, s50, 25600
s_cmp_ge_u32 s50, 143360
s_cselect_b32 s50, s27, s50
s_add_u32 m0, s20, 0
s_nop 0
buffer_load_dwordx4 v9, s[8:11], s21 offen  lds
s_add_u32 m0, s20, 4096
s_add_u32 s25, s21, 128
buffer_load_dwordx4 v9, s[8:11], s25 offen  lds
s_add_u32 m0, s20, 8192
s_add_u32 s25, s21, 256
buffer_load_dwordx4 v9, s[8:11], s25 offen  lds
s_add_u32 m0, s20, 12288
s_add_u32 s25, s21, 384
buffer_load_dwordx4 v9, s[8:11], s25 offen  lds
s_add_u32 s21, s21, 229376
s_add_u32 s20, s20, 25600
s_cmp_ge_u32 s20, 143360
s_cselect_b32 s20, s26, s20
v_pk_add_f32 v[32:33], v[32:33], v[34:35]
v_pk_add_f32 v[48:49], v[48:49], v[50:51]
v_pk_add_f32 v[32:33], v[32:33], v[36:37]
v_pk_add_f32 v[48:49], v[48:49], v[52:53]
v_pk_add_f32 v[32:33], v[32:33], v[38:39]
v_pk_add_f32 v[48:49], v[48:49], v[54:55]
v_pk_add_f32 v[32:33], v[32:33], v[40:41]
v_pk_add_f32 v[48:49], v[48:49], v[56:57]
v_pk_add_f32 v[32:33], v[32:33], v[42:43]
v_pk_add_f32 v[48:49], v[48:49], v[58:59]
v_pk_add_f32 v[32:33], v[32:33], v[44:45]
v_pk_add_f32 v[48:49], v[48:49], v[60:61]
v_pk_add_f32 v[32:33], v[32:33], v[46:47]
v_pk_add_f32 v[48:49], v[48:49], v[62:63]
v_add_f32 v32, v32, v33
v_mov_b32 v50, v48
v_mov_b32 v51, v49
v_add_u32 v20, 153600, v20
ds_write_b32 v20, v32
v_permlane32_swap_b32 v48, v50
v_permlane32_swap_b32 v49, v51
v_add_f32 v48, v48, v50
v_add_f32 v49, v49, v51
v_mul_f32 v48, 0xba800000, v48
v_mul_f32 v49, 0x3a800000, v49
v_fma_f32 v49, -v48, v48, v49
v_max_f32 v49, 0, v49
v_add_f32 v49, 0x3727c5ac, v49
v_rsq_f32 v49, v49
v_add_u32 v22, 154624, v22
ds_write_b64 v22, v[48:49]
s_waitcnt lgkmcnt(0)
s_waitcnt vmcnt(18)
s_barrier
buffer_store_dwordx4 v[192:195], v30, s[4:7], s47 offen sc1
s_add_u32 s47, s47, 4096
s_add_u32 m0, s50, 16384
s_nop 0
buffer_load_dwordx4 v4, s[4:7], s23 offen offset:0 sc1 lds
buffer_load_dwordx4 v4, s[4:7], s23 offen offset:1024 sc1 lds
s_add_u32 s23, s23, 131072
s_add_u32 s50, s50, 25600
s_cmp_ge_u32 s50, 143360
s_cselect_b32 s50, s27, s50
s_add_u32 m0, s20, 0
s_nop 0
buffer_load_dwordx4 v9, s[8:11], s21 offen  lds
s_add_u32 m0, s20, 4096
s_add_u32 s25, s21, 128
buffer_load_dwordx4 v9, s[8:11], s25 offen  lds
s_add_u32 m0, s20, 8192
s_add_u32 s25, s21, 256
buffer_load_dwordx4 v9, s[8:11], s25 offen  lds
s_add_u32 m0, s20, 12288
s_add_u32 s25, s21, 384
buffer_load_dwordx4 v9, s[8:11], s25 offen  lds
s_add_u32 s21, s21, 229376
s_add_u32 s20, s20, 25600
s_cmp_ge_u32 s20, 143360
s_cselect_b32 s20, s26, s20
s_waitcnt vmcnt(19)
s_barrier
buffer_store_dwordx4 v[196:199], v30, s[4:7], s47 offen sc1
s_add_u32 s47, s47, 4096
s_add_u32 m0, s50, 16384
s_nop 0
buffer_load_dwordx4 v4, s[4:7], s23 offen offset:0 sc1 lds
buffer_load_dwordx4 v4, s[4:7], s23 offen offset:1024 sc1 lds
s_add_u32 s23, s23, 131072
s_add_u32 s50, s50, 25600
s_cmp_ge_u32 s50, 143360
s_cselect_b32 s50, s27, s50
s_add_u32 m0, s20, 0
s_nop 0
buffer_load_dwordx4 v9, s[8:11], s21 offen  lds
s_add_u32 m0, s20, 4096
s_add_u32 s25, s21, 128
buffer_load_dwordx4 v9, s[8:11], s25 offen  lds
s_add_u32 m0, s20, 8192
s_add_u32 s25, s21, 256
buffer_load_dwordx4 v9, s[8:11], s25 offen  lds
s_add_u32 m0, s20, 12288
s_add_u32 s25, s21, 384
buffer_load_dwordx4 v9, s[8:11], s25 offen  lds
s_add_u32 s21, s21, 229376
s_add_u32 s20, s20, 25600
s_cmp_ge_u32 s20, 143360
s_cselect_b32 s20, s26, s20
s_waitcnt vmcnt(20)
s_barrier
buffer_store_dwordx4 v[200:203], v30, s[4:7], s47 offen sc1
s_add_u32 s47, s47, 4096
s_add_u32 m0, s50, 16384
s_nop 0
buffer_load_dwordx4 v4, s[4:7], s23 offen offset:0 sc1 lds
buffer_load_dwordx4 v4, s[4:7], s23 offen offset:1024 sc1 lds
s_add_u32 s23, s23, 131072
s_add_u32 s50, s50, 25600
s_cmp_ge_u32 s50, 143360
s_cselect_b32 s50, s27, s50
s_add_u32 m0, s20, 0
s_nop 0
buffer_load_dwordx4 v9, s[8:11], s21 offen  lds
s_add_u32 m0, s20, 4096
s_add_u32 s25, s21, 128
buffer_load_dwordx4 v9, s[8:11], s25 offen  lds
s_add_u32 m0, s20, 8192
s_add_u32 s25, s21, 256
buffer_load_dwordx4 v9, s[8:11], s25 offen  lds
s_add_u32 m0, s20, 12288
s_add_u32 s25, s21, 384
buffer_load_dwordx4 v9, s[8:11], s25 offen  lds
s_add_u32 s21, s21, 229376
s_add_u32 s20, s20, 25600
s_cmp_ge_u32 s20, 143360
s_cselect_b32 s20, s26, s20
s_waitcnt vmcnt(21)
s_barrier
buffer_store_dwordx4 v[204:207], v30, s[4:7], s47 offen sc1
s_add_u32 s47, s47, 4096
s_add_u32 m0, s50, 16384
s_nop 0
buffer_load_dwordx4 v4, s[4:7], s23 offen offset:0 sc1 lds
buffer_load_dwordx4 v4, s[4:7], s23 offen offset:1024 sc1 lds
s_add_u32 s23, s23, 131072
s_add_u32 s50, s50, 25600
s_cmp_ge_u32 s50, 143360
s_cselect_b32 s50, s27, s50
s_add_u32 m0, s20, 0
s_nop 0
buffer_load_dwordx4 v9, s[8:11], s21 offen  lds
s_add_u32 m0, s20, 4096
s_add_u32 s25, s21, 128
buffer_load_dwordx4 v9, s[8:11], s25 offen  lds
s_add_u32 m0, s20, 8192
s_add_u32 s25, s21, 256
buffer_load_dwordx4 v9, s[8:11], s25 offen  lds
s_add_u32 m0, s20, 12288
s_add_u32 s25, s21, 384
buffer_load_dwordx4 v9, s[8:11], s25 offen  lds
s_add_u32 s21, s21, 229376
s_add_u32 s20, s20, 25600
s_cmp_ge_u32 s20, 143360
s_cselect_b32 s20, s26, s20
s_waitcnt vmcnt(21)
s_barrier
buffer_store_dwordx4 v[208:211], v30, s[4:7], s47 offen sc1
s_add_u32 s47, s47, 4096
s_add_u32 m0, s50, 16384
s_nop 0
buffer_load_dwordx4 v4, s[4:7], s23 offen offset:0 sc1 lds
buffer_load_dwordx4 v4, s[4:7], s23 offen offset:1024 sc1 lds
s_add_u32 s23, s23, 131072
s_add_u32 s50, s50, 25600
s_cmp_ge_u32 s50, 143360
s_cselect_b32 s50, s27, s50
s_add_u32 m0, s20, 0
s_nop 0
buffer_load_dwordx4 v9, s[8:11], s21 offen  lds
s_add_u32 m0, s20, 4096
s_add_u32 s25, s21, 128
buffer_load_dwordx4 v9, s[8:11], s25 offen  lds
s_add_u32 m0, s20, 8192
s_add_u32 s25, s21, 256
buffer_load_dwordx4 v9, s[8:11], s25 offen  lds
s_add_u32 m0, s20, 12288
s_add_u32 s25, s21, 384
buffer_load_dwordx4 v9, s[8:11], s25 offen  lds
s_add_u32 s21, s21, 229376
s_add_u32 s20, s20, 25600
s_cmp_ge_u32 s20, 143360
s_cselect_b32 s20, s26, s20
s_waitcnt vmcnt(21)
s_barrier
buffer_store_dwordx4 v[212:215], v30, s[4:7], s47 offen sc1
s_add_u32 s47, s47, 4096
s_add_u32 m0, s50, 16384
s_nop 0
buffer_load_dwordx4 v4, s[4:7], s23 offen offset:0 sc1 lds
buffer_load_dwordx4 v4, s[4:7], s23 offen offset:1024 sc1 lds
s_add_u32 s23, s23, 131072
s_add_u32 s50, s50, 25600
s_cmp_ge_u32 s50, 143360
s_cselect_b32 s50, s27, s50
s_add_u32 m0, s20, 0
s_nop 0
buffer_load_dwordx4 v9, s[8:11], s21 offen  lds
s_add_u32 m0, s20, 4096
s_add_u32 s25, s21, 128
buffer_load_dwordx4 v9, s[8:11], s25 offen  lds
s_add_u32 m0, s20, 8192
s_add_u32 s25, s21, 256
buffer_load_dwordx4 v9, s[8:11], s25 offen  lds
s_add_u32 m0, s20, 12288
s_add_u32 s25, s21, 384
buffer_load_dwordx4 v9, s[8:11], s25 offen  lds
s_add_u32 s21, s21, 229376
s_add_u32 s20, s20, 25600
s_cmp_ge_u32 s20, 143360
s_cselect_b32 s20, s26, s20
s_waitcnt vmcnt(21)
s_barrier
buffer_store_dwordx4 v[216:219], v30, s[4:7], s47 offen sc1
s_add_u32 s47, s47, 4096
s_add_u32 m0, s50, 16384
s_nop 0
buffer_load_dwordx4 v4, s[4:7], s23 offen offset:0 sc1 lds
buffer_load_dwordx4 v4, s[4:7], s23 offen offset:1024 sc1 lds
s_add_u32 s23, s23, 131072
s_add_u32 s50, s50, 25600
s_cmp_ge_u32 s50, 143360
s_cselect_b32 s50, s27, s50
s_add_u32 m0, s20, 0
s_nop 0
buffer_load_dwordx4 v9, s[8:11], s21 offen  lds
s_add_u32 m0, s20, 4096
s_add_u32 s25, s21, 128
buffer_load_dwordx4 v9, s[8:11], s25 offen  lds
s_add_u32 m0, s20, 8192
s_add_u32 s25, s21, 256
buffer_load_dwordx4 v9, s[8:11], s25 offen  lds
s_add_u32 m0, s20, 12288
s_add_u32 s25, s21, 384
buffer_load_dwordx4 v9, s[8:11], s25 offen  lds
s_add_u32 s21, s21, 229376
s_add_u32 s20, s20, 25600
s_cmp_ge_u32 s20, 143360
s_cselect_b32 s20, s26, s20
s_waitcnt vmcnt(21)
s_barrier
s_add_u32 m0, s50, 16384
s_nop 0
buffer_load_dwordx4 v4, s[4:7], s23 offen offset:0 sc1 lds
buffer_load_dwordx4 v4, s[4:7], s23 offen offset:1024 sc1 lds
s_add_u32 s23, s23, 131072
s_add_u32 s50, s50, 25600
s_cmp_ge_u32 s50, 143360
s_cselect_b32 s50, s27, s50
s_add_u32 m0, s20, 0
s_nop 0
buffer_load_dwordx4 v9, s[8:11], s21 offen  lds
s_add_u32 m0, s20, 4096
s_add_u32 s25, s21, 128
buffer_load_dwordx4 v9, s[8:11], s25 offen  lds
s_add_u32 m0, s20, 8192
s_add_u32 s25, s21, 256
buffer_load_dwordx4 v9, s[8:11], s25 offen  lds
s_add_u32 m0, s20, 12288
s_add_u32 s25, s21, 384
buffer_load_dwordx4 v9, s[8:11], s25 offen  lds
s_add_u32 s21, s21, 229376
s_add_u32 s20, s20, 25600
s_cmp_ge_u32 s20, 143360
s_cselect_b32 s20, s26, s20
s_waitcnt vmcnt(20)
s_barrier
s_add_u32 m0, s50, 16384
s_nop 0
buffer_load_dwordx4 v4, s[4:7], s23 offen offset:0 sc1 lds
buffer_load_dwordx4 v4, s[4:7], s23 offen offset:1024 sc1 lds
s_add_u32 s23, s23, 131072
s_add_u32 s50, s50, 25600
s_cmp_ge_u32 s50, 143360
s_cselect_b32 s50, s27, s50
s_add_u32 m0, s20, 0
s_nop 0
buffer_load_dwordx4 v9, s[8:11], s21 offen  lds
s_add_u32 m0, s20, 4096
s_add_u32 s25, s21, 128
buffer_load_dwordx4 v9, s[8:11], s25 offen  lds
s_add_u32 m0, s20, 8192
s_add_u32 s25, s21, 256
buffer_load_dwordx4 v9, s[8:11], s25 offen  lds
s_add_u32 m0, s20, 12288
s_add_u32 s25, s21, 384
buffer_load_dwordx4 v9, s[8:11], s25 offen  lds
s_add_u32 s21, s21, 229376
s_add_u32 s20, s20, 25600
s_cmp_ge_u32 s20, 143360
s_cselect_b32 s20, s26, s20
s_waitcnt vmcnt(19)
s_barrier
s_add_u32 m0, s50, 16384
s_nop 0
buffer_load_dwordx4 v4, s[4:7], s23 offen offset:0 sc1 lds
buffer_load_dwordx4 v4, s[4:7], s23 offen offset:1024 sc1 lds
s_add_u32 s23, s23, 131072
s_add_u32 s50, s50, 25600
s_cmp_ge_u32 s50, 143360
s_cselect_b32 s50, s27, s50
s_add_u32 m0, s20, 0
s_nop 0
buffer_load_dwordx4 v9, s[8:11], s21 offen  lds
s_add_u32 m0, s20, 4096
s_add_u32 s25, s21, 128
buffer_load_dwordx4 v9, s[8:11], s25 offen  lds
s_add_u32 m0, s20, 8192
s_add_u32 s25, s21, 256
buffer_load_dwordx4 v9, s[8:11], s25 offen  lds
s_add_u32 m0, s20, 12288
s_add_u32 s25, s21, 384
buffer_load_dwordx4 v9, s[8:11], s25 offen  lds
s_add_u32 s21, s21, 229376
s_add_u32 s20, s20, 25600
s_cmp_ge_u32 s20, 143360
s_cselect_b32 s20, s26, s20
s_waitcnt vmcnt(18)
s_barrier
s_add_u32 m0, s50, 16384
s_nop 0
buffer_load_dwordx4 v4, s[4:7], s23 offen offset:0 sc1 lds
buffer_load_dwordx4 v4, s[4:7], s23 offen offset:1024 sc1 lds
s_add_u32 s23, s23, 131072
s_add_u32 s50, s50, 25600
s_cmp_ge_u32 s50, 143360
s_cselect_b32 s50, s27, s50
s_add_u32 m0, s20, 0
s_nop 0
buffer_load_dwordx4 v9, s[8:11], s21 offen  lds
s_add_u32 m0, s20, 4096
s_add_u32 s25, s21, 128
buffer_load_dwordx4 v9, s[8:11], s25 offen  lds
s_add_u32 m0, s20, 8192
s_add_u32 s25, s21, 256
buffer_load_dwordx4 v9, s[8:11], s25 offen  lds
s_add_u32 m0, s20, 12288
s_add_u32 s25, s21, 384
buffer_load_dwordx4 v9, s[8:11], s25 offen  lds
s_add_u32 s21, s21, 229376
s_add_u32 s20, s20, 25600
s_cmp_ge_u32 s20, 143360
s_cselect_b32 s20, s26, s20
s_waitcnt vmcnt(18)
s_barrier
s_add_u32 m0, s50, 16384
s_nop 0
buffer_load_dwordx4 v4, s[4:7], s23 offen offset:0 sc1 lds
buffer_load_dwordx4 v4, s[4:7], s23 offen offset:1024 sc1 lds
s_add_u32 s23, s23, 131072
s_add_u32 s50, s50, 25600
s_cmp_ge_u32 s50, 143360
s_cselect_b32 s50, s27, s50
s_add_u32 m0, s20, 0
s_nop 0
buffer_load_dwordx4 v9, s[8:11], s21 offen  lds
s_add_u32 m0, s20, 4096
s_add_u32 s25, s21, 128
buffer_load_dwordx4 v9, s[8:11], s25 offen  lds
s_add_u32 m0, s20, 8192
s_add_u32 s25, s21, 256
buffer_load_dwordx4 v9, s[8:11], s25 offen  lds
s_add_u32 m0, s20, 12288
s_add_u32 s25, s21, 384
buffer_load_dwordx4 v9, s[8:11], s25 offen  lds
s_add_u32 s21, s21, 229376
s_add_u32 s20, s20, 25600
s_cmp_ge_u32 s20, 143360
s_cselect_b32 s20, s26, s20
s_waitcnt vmcnt(18)
s_barrier
s_cmp_lg_u32 s16, 0
s_cbranch_scc1 NF13
v_mov_b32 v14, 5
s_mov_b64 exec, 1
buffer_store_dword v14, v15, s[4:7], s51 offen sc1
s_mov_b64 exec, -1
NF13:
s_add_u32 m0, s50, 16384
s_nop 0
buffer_load_dwordx4 v4, s[4:7], s23 offen offset:0 sc1 lds
buffer_load_dwordx4 v4, s[4:7], s23 offen offset:1024 sc1 lds
s_add_u32 s23, s23, 131072
s_add_u32 s50, s50, 25600
s_cmp_ge_u32 s50, 143360
s_cselect_b32 s50, s27, s50
s_add_u32 m0, s20, 0
s_nop 0
buffer_load_dwordx4 v9, s[8:11], s21 offen  lds
s_add_u32 m0, s20, 4096
s_add_u32 s25, s21, 128
buffer_load_dwordx4 v9, s[8:11], s25 offen  lds
s_add_u32 m0, s20, 8192
s_add_u32 s25, s21, 256
buffer_load_dwordx4 v9, s[8:11], s25 offen  lds
s_add_u32 m0, s20, 12288
s_add_u32 s25, s21, 384
buffer_load_dwordx4 v9, s[8:11], s25 offen  lds
s_add_u32 s21, s21, 229376
s_add_u32 s20, s20, 25600
s_cmp_ge_u32 s20, 143360
s_cselect_b32 s20, s26, s20
s_mov_b32 s24, 3
PS6:
s_waitcnt vmcnt(18)
s_barrier
s_add_u32 m0, s50, 16384
s_nop 0
buffer_load_dwordx4 v4, s[4:7], s23 offen offset:0 sc1 lds
buffer_load_dwordx4 v4, s[4:7], s23 offen offset:1024 sc1 lds
s_add_u32 s23, s23, 131072
s_add_u32 s50, s50, 25600
s_cmp_ge_u32 s50, 143360
s_cselect_b32 s50, s27, s50
s_add_u32 m0, s20, 0
s_nop 0
buffer_load_dwordx4 v9, s[8:11], s21 offen  lds
s_add_u32 m0, s20, 4096
s_add_u32 s25, s21, 128
buffer_load_dwordx4 v9, s[8:11], s25 offen  lds
s_add_u32 m0, s20, 8192
s_add_u32 s25, s21, 256
buffer_load_dwordx4 v9, s[8:11], s25 offen  lds
s_add_u32 m0, s20, 12288
s_add_u32 s25, s21, 384
buffer_load_dwordx4 v9, s[8:11], s25 offen  lds
s_add_u32 s21, s21, 229376
s_add_u32 s20, s20, 25600
s_cmp_ge_u32 s20, 143360
s_cselect_b32 s20, s26, s20
s_sub_u32 s24, s24, 1
s_cmp_lg_u32 s24, 0
s_cbranch_scc1 PS6
s_waitcnt vmcnt(18)
s_barrier
s_lshl_b32 s23, s17, 13
s_add_u32 s23, s23, 10485760
s_add_u32 m0, s50, 8192
s_nop 0
buffer_load_dwordx4 v4, s[4:7], s23 offen offset:0 sc1 lds
buffer_load_dwordx4 v4, s[4:7], s23 offen offset:1024 sc1 lds
s_add_u32 s23, s23, 131072
s_add_u32 m0, s50, 16384
s_nop 0
buffer_load_dwordx4 v4, s[4:7], s23 offen offset:0 sc1 lds
buffer_load_dwordx4 v4, s[4:7], s23 offen offset:1024 sc1 lds
s_add_u32 s23, s23, 131072
s_add_u32 s50, s50, 25600
s_cmp_ge_u32 s50, 143360
s_cselect_b32 s50, s27, s50
s_mul_i32 s21, s18, 131072
s_add_u32 s21, s21, 2162688
s_add_u32 m0, s20, 0
s_nop 0
buffer_load_dwordx4 v30, s[4:7], s21 offen sc1 lds
s_add_u32 m0, s20, 4096
s_add_u32 s25, s21, 4096
buffer_load_dwordx4 v30, s[4:7], s25 offen sc1 lds
s_add_u32 s21, s21, 8192
s_add_u32 s20, s20, 25600
s_cmp_ge_u32 s20, 143360
s_cselect_b32 s20, s26, s20
s_waitcnt vmcnt(18)
s_barrier
v_lshrrev_b32 v31, 5, v0
v_lshlrev_b32 v31, 7, v31
v_xor_b32 v31, v31, v13
buffer_load_dword v16, v31, s[4:7], s51 offen sc1
s_add_u32 m0, s50, 8192
s_nop 0
buffer_load_dwordx4 v4, s[4:7], s23 offen offset:0 sc1 lds
buffer_load_dwordx4 v4, s[4:7], s23 offen offset:1024 sc1 lds
s_add_u32 s23, s23, 131072
s_add_u32 m0, s50, 16384
s_nop 0
buffer_load_dwordx4 v4, s[4:7], s23 offen offset:0 sc1 lds
buffer_load_dwordx4 v4, s[4:7], s23 offen offset:1024 sc1 lds
s_add_u32 s23, s23, 131072
s_add_u32 s50, s50, 25600
s_cmp_ge_u32 s50, 143360
s_cselect_b32 s50, s27, s50
s_add_u32 m0, s20, 0
s_nop 0
buffer_load_dwordx4 v30, s[4:7], s21 offen sc1 lds
s_add_u32 m0, s20, 4096
s_add_u32 s25, s21, 4096
buffer_load_dwordx4 v30, s[4:7], s25 offen sc1 lds
s_add_u32 s21, s21, 8192
s_add_u32 s20, s20, 25600
s_cmp_ge_u32 s20, 143360
s_cselect_b32 s20, s26, s20
s_waitcnt vmcnt(19)
s_barrier
s_add_u32 m0, s50, 8192
s_nop 0
buffer_load_dwordx4 v4, s[4:7], s23 offen offset:0 sc1 lds
buffer_load_dwordx4 v4, s[4:7], s23 offen offset:1024 sc1 lds
s_add_u32 s23, s23, 131072
s_add_u32 m0, s50, 16384
s_nop 0
buffer_load_dwordx4 v4, s[4:7], s23 offen offset:0 sc1 lds
buffer_load_dwordx4 v4, s[4:7], s23 offen offset:1024 sc1 lds
s_add_u32 s23, s23, 131072
s_add_u32 s50, s50, 25600
s_cmp_ge_u32 s50, 143360
s_cselect_b32 s50, s27, s50
s_add_u32 m0, s20, 0
s_nop 0
buffer_load_dwordx4 v30, s[4:7], s21 offen sc1 lds
s_add_u32 m0, s20, 4096
s_add_u32 s25, s21, 4096
buffer_load_dwordx4 v30, s[4:7], s25 offen sc1 lds
s_add_u32 s21, s21, 8192
s_add_u32 s20, s20, 25600
s_cmp_ge_u32 s20, 143360
s_cselect_b32 s20, s26, s20
s_waitcnt vmcnt(19)
s_barrier
s_add_u32 m0, s50, 8192
s_nop 0
buffer_load_dwordx4 v4, s[4:7], s23 offen offset:0 sc1 lds
buffer_load_dwordx4 v4, s[4:7], s23 offen offset:1024 sc1 lds
s_add_u32 s23, s23, 131072
s_add_u32 m0, s50, 16384
s_nop 0
buffer_load_dwordx4 v4, s[4:7], s23 offen offset:0 sc1 lds
buffer_load_dwordx4 v4, s[4:7], s23 offen offset:1024 sc1 lds
s_add_u32 s23, s23, 131072
s_add_u32 s50, s50, 25600
s_cmp_ge_u32 s50, 143360
s_cselect_b32 s50, s27, s50
s_add_u32 m0, s20, 0
s_nop 0
buffer_load_dwordx4 v30, s[4:7], s21 offen sc1 lds
s_add_u32 m0, s20, 4096
s_add_u32 s25, s21, 4096
buffer_load_dwordx4 v30, s[4:7], s25 offen sc1 lds
s_add_u32 s21, s21, 8192
s_add_u32 s20, s20, 25600
s_cmp_ge_u32 s20, 143360
s_cselect_b32 s20, s26, s20
s_waitcnt vmcnt(19)
s_barrier
s_add_u32 m0, s50, 8192
s_nop 0
buffer_load_dwordx4 v4, s[4:7], s23 offen offset:0 sc1 lds
buffer_load_dwordx4 v4, s[4:7], s23 offen offset:1024 sc1 lds
s_add_u32 s23, s23, 131072
s_add_u32 m0, s50, 16384
s_nop 0
buffer_load_dwordx4 v4, s[4:7], s23 offen offset:0 sc1 lds
buffer_load_dwordx4 v4, s[4:7], s23 offen offset:1024 sc1 lds
s_add_u32 s23, s23, 131072
s_add_u32 s50, s50, 25600
s_cmp_ge_u32 s50, 143360
s_cselect_b32 s50, s27, s50
s_add_u32 m0, s20, 0
s_nop 0
buffer_load_dwordx4 v30, s[4:7], s21 offen sc1 lds
s_add_u32 m0, s20, 4096
s_add_u32 s25, s21, 4096
buffer_load_dwordx4 v30, s[4:7], s25 offen sc1 lds
s_add_u32 s21, s21, 8192
s_add_u32 s20, s20, 25600
s_cmp_ge_u32 s20, 143360
s_cselect_b32 s20, s26, s20
s_add_u32 m0, s50, 8192
s_nop 0
buffer_load_dwordx4 v4, s[4:7], s23 offen offset:0 sc1 lds
buffer_load_dwordx4 v4, s[4:7], s23 offen offset:1024 sc1 lds
s_add_u32 s23, s23, 131072
s_add_u32 m0, s50, 16384
s_nop 0
buffer_load_dwordx4 v4, s[4:7], s23 offen offset:0 sc1 lds
buffer_load_dwordx4 v4, s[4:7], s23 offen offset:1024 sc1 lds
s_add_u32 s23, s23, 131072
s_add_u32 s50, s50, 25600
s_cmp_ge_u32 s50, 143360
s_cselect_b32 s50, s27, s50
s_add_u32 m0, s20, 0
s_nop 0
buffer_load_dwordx4 v30, s[4:7], s21 offen sc1 lds
s_add_u32 m0, s20, 4096
s_add_u32 s25, s21, 4096
buffer_load_dwordx4 v30, s[4:7], s25 offen sc1 lds
s_add_u32 s21, s21, 8192
s_add_u32 s20, s20, 25600
s_cmp_ge_u32 s20, 143360
s_cselect_b32 s20, s26, s20
s_waitcnt vmcnt(24)
s_barrier
s_branch PC14
PL14:
buffer_load_dword v16, v31, s[4:7], s51 offen sc1
s_waitcnt vmcnt(0)
PC14:
v_cmp_gt_u32 vcc, 5, v16
s_nop 1
s_cmp_eq_u64 vcc, 0
s_cbranch_scc1 PD14
s_sub_u32 s49, s49, 1
s_cbranch_scc0 PL14
s_mov_b32 s49, 0
PD14:
s_add_u32 m0, s50, 8192
s_nop 0
buffer_load_dwordx4 v4, s[4:7], s23 offen offset:0 sc1 lds
buffer_load_dwordx4 v4, s[4:7], s23 offen offset:1024 sc1 lds
s_add_u32 s23, s23, 131072
s_add_u32 m0, s50, 16384
s_nop 0
buffer_load_dwordx4 v4, s[4:7], s23 offen offset:0 sc1 lds
buffer_load_dwordx4 v4, s[4:7], s23 offen offset:1024 sc1 lds
s_add_u32 s23, s23, 131072
s_add_u32 s50, s50, 25600
s_cmp_ge_u32 s50, 143360
s_cselect_b32 s50, s27, s50
s_add_u32 m0, s20, 0
s_nop 0
buffer_load_dwordx4 v30, s[4:7], s21 offen sc1 lds
s_add_u32 m0, s20, 4096
s_add_u32 s25, s21, 4096
buffer_load_dwordx4 v30, s[4:7], s25 offen sc1 lds
s_add_u32 s21, s21, 8192
s_add_u32 s20, s20, 25600
s_cmp_ge_u32 s20, 143360
s_cselect_b32 s20, s26, s20
s_waitcnt vmcnt(24)
s_barrier
s_add_u32 m0, s50, 8192
s_nop 0
buffer_load_dwordx4 v4, s[4:7], s23 offen offset:0 sc1 lds
buffer_load_dwordx4 v4, s[4:7], s23 offen offset:1024 sc1 lds
s_add_u32 s23, s23, 131072
s_add_u32 m0, s50, 16384
s_nop 0
buffer_load_dwordx4 v4, s[4:7], s23 offen offset:0 sc1 lds
buffer_load_dwordx4 v4, s[4:7], s23 offen offset:1024 sc1 lds
s_add_u32 s23, s23, 131072
s_add_u32 s50, s50, 25600
s_cmp_ge_u32 s50, 143360
s_cselect_b32 s50, s27, s50
s_add_u32 m0, s20, 0
s_nop 0
buffer_load_dwordx4 v30, s[4:7], s21 offen sc1 lds
s_add_u32 m0, s20, 4096
s_add_u32 s25, s21, 4096
buffer_load_dwordx4 v30, s[4:7], s25 offen sc1 lds
s_add_u32 s21, s21, 8192
s_add_u32 s20, s20, 25600
s_cmp_ge_u32 s20, 143360
s_cselect_b32 s20, s26, s20
s_waitcnt vmcnt(24)
s_barrier
s_cmp_lg_u32 s16, 0
s_cbranch_scc1 NF15
v_mov_b32 v14, 6
s_mov_b64 exec, 1
buffer_store_dword v14, v15, s[4:7], s51 offen sc1
s_mov_b64 exec, -1
NF15:
v_and_b32 v31, 1, v0
v_add_u32 v31, 6, v31
s_and_b32 s19, s18, 1
v_mul_u32_u24 v31, s19, v31
s_lshl_b32 s19, s17, 11
v_lshl_add_u32 v31, v31, 7, s19
PL16:
buffer_load_dword v16, v31, s[4:7], s51 offen sc1
s_waitcnt vmcnt(0)
PC16:
v_cmp_gt_u32 vcc, 6, v16
s_nop 1
s_cmp_eq_u64 vcc, 0
s_cbranch_scc1 PD16
s_sub_u32 s49, s49, 1
s_cbranch_scc0 PL16
s_mov_b32 s49, 0
PD16:
s_lshl_b32 s23, s17, 13
s_add_u32 s23, s23, 20971520
s_and_b32 s19, s18, 1
s_mul_i32 s19, s19, 6291456
s_add_u32 s23, s23, s19
s_add_u32 m0, s50, 8192
s_nop 0
buffer_load_dwordx4 v4, s[4:7], s23 offen offset:0 sc1 lds
buffer_load_dwordx4 v4, s[4:7], s23 offen offset:1024 sc1 lds
s_add_u32 s23, s23, 131072
s_add_u32 s50, s50, 16384
s_cmp_ge_u32 s50, 143360
s_cselect_b32 s50, s27, s50
s_mul_i32 s21, s18, 458752
s_add_u32 s21, s21, 39845888
s_and_b32 s19, s18, 1
s_mul_i32 s25, s19, 196608
s_add_u32 s21, s21, s25
s_mul_i32 s25, s19, 917504
s_add_u32 s22, s21, 458752
s_sub_u32 s22, s22, s25
s_add_u32 m0, s20, 0
s_nop 0
buffer_load_dwordx4 v30, s[4:7], s21 offen sc1 lds
s_add_u32 m0, s20, 4096
s_nop 0
buffer_load_dwordx4 v30, s[4:7], s22 offen sc1 lds
s_add_u32 s21, s21, 4096
s_add_u32 s22, s22, 4096
s_add_u32 s20, s20, 16384
s_cmp_ge_u32 s20, 143360
s_cselect_b32 s20, s26, s20
s_barrier
s_add_u32 m0, s50, 8192
s_nop 0
buffer_load_dwordx4 v4, s[4:7], s23 offen offset:0 sc1 lds
buffer_load_dwordx4 v4, s[4:7], s23 offen offset:1024 sc1 lds
s_add_u32 s23, s23, 131072
s_add_u32 s50, s50, 16384
s_cmp_ge_u32 s50, 143360
s_cselect_b32 s50, s27, s50
s_add_u32 m0, s20, 0
s_nop 0
buffer_load_dwordx4 v30, s[4:7], s21 offen sc1 lds
s_add_u32 m0, s20, 4096
s_nop 0
buffer_load_dwordx4 v30, s[4:7], s22 offen sc1 lds
s_add_u32 s21, s21, 4096
s_add_u32 s22, s22, 4096
s_add_u32 s20, s20, 16384
s_cmp_ge_u32 s20, 143360
s_cselect_b32 s20, s26, s20
s_add_u32 m0, s50, 8192
s_nop 0
buffer_load_dwordx4 v4, s[4:7], s23 offen offset:0 sc1 lds
buffer_load_dwordx4 v4, s[4:7], s23 offen offset:1024 sc1 lds
s_add_u32 s23, s23, 131072
s_add_u32 s50, s50, 16384
s_cmp_ge_u32 s50, 143360
s_cselect_b32 s50, s27, s50
s_add_u32 m0, s20, 0
s_nop 0
buffer_load_dwordx4 v30, s[4:7], s21 offen sc1 lds
s_add_u32 m0, s20, 4096
s_nop 0
buffer_load_dwordx4 v30, s[4:7], s22 offen sc1 lds
s_add_u32 s21, s21, 4096
s_add_u32 s22, s22, 4096
s_add_u32 s20, s20, 16384
s_cmp_ge_u32 s20, 143360
s_cselect_b32 s20, s26, s20
s_barrier
buffer_load_dword v16, v12, s[4:7], s51 offen sc1
s_add_u32 m0, s50, 8192
s_nop 0
buffer_load_dwordx4 v4, s[4:7], s23 offen offset:0 sc1 lds
buffer_load_dwordx4 v4, s[4:7], s23 offen offset:1024 sc1 lds
s_add_u32 s23, s23, 131072
s_add_u32 s50, s50, 16384
s_cmp_ge_u32 s50, 143360
s_cselect_b32 s50, s27, s50
s_add_u32 m0, s20, 0
s_nop 0
buffer_load_dwordx4 v30, s[4:7], s21 offen sc1 lds
s_add_u32 m0, s20, 4096
s_nop 0
buffer_load_dwordx4 v30, s[4:7], s22 offen sc1 lds
s_add_u32 s21, s21, 4096
s_add_u32 s22, s22, 4096
s_add_u32 s20, s20, 16384
s_cmp_ge_u32 s20, 143360
s_cselect_b32 s20, s26, s20
s_barrier
s_add_u32 m0, s50, 8192
s_nop 0
buffer_load_dwordx4 v4, s[4:7], s23 offen offset:0 sc1 lds
buffer_load_dwordx4 v4, s[4:7], s23 offen offset:1024 sc1 lds
s_add_u32 s23, s23, 131072
s_add_u32 s50, s50, 16384
s_cmp_ge_u32 s50, 143360
s_cselect_b32 s50, s27, s50
s_add_u32 m0, s20, 0
s_nop 0
buffer_load_dwordx4 v30, s[4:7], s21 offen sc1 lds
s_add_u32 m0, s20, 4096
s_nop 0
buffer_load_dwordx4 v30, s[4:7], s22 offen sc1 lds
s_add_u32 s21, s21, 4096
s_add_u32 s22, s22, 4096
s_add_u32 s20, s20, 16384
s_cmp_ge_u32 s20, 143360
s_cselect_b32 s20, s26, s20
s_add_u32 m0, s50, 8192
s_nop 0
buffer_load_dwordx4 v4, s[4:7], s23 offen offset:0 sc1 lds
buffer_load_dwordx4 v4, s[4:7], s23 offen offset:1024 sc1 lds
s_add_u32 s23, s23, 131072
s_add_u32 s50, s50, 16384
s_cmp_ge_u32 s50, 143360
s_cselect_b32 s50, s27, s50
s_add_u32 m0, s20, 0
s_nop 0
buffer_load_dwordx4 v30, s[4:7], s21 offen sc1 lds
s_add_u32 m0, s20, 4096
s_nop 0
buffer_load_dwordx4 v30, s[4:7], s22 offen sc1 lds
s_add_u32 s21, s21, 4096
s_add_u32 s22, s22, 4096
s_add_u32 s20, s20, 16384
s_cmp_ge_u32 s20, 143360
s_cselect_b32 s20, s26, s20
s_barrier
s_waitcnt vmcnt(12)
s_branch PC17
PL17:
buffer_load_dword v16, v12, s[4:7], s51 offen sc1
s_waitcnt vmcnt(0)
PC17:
v_cmp_gt_u32 vcc, 6, v16
s_nop 1
s_cmp_eq_u64 vcc, 0
s_cbranch_scc1 PD17
s_sub_u32 s49, s49, 1
s_cbranch_scc0 PL17
s_mov_b32 s49, 0
PD17:
s_add_u32 m0, s50, 8192
s_nop 0
buffer_load_dwordx4 v4, s[4:7], s23 offen offset:0 sc1 lds
buffer_load_dwordx4 v4, s[4:7], s23 offen offset:1024 sc1 lds
s_add_u32 s23, s23, 131072
s_add_u32 s50, s50, 16384
s_cmp_ge_u32 s50, 143360
s_cselect_b32 s50, s27, s50
s_add_u32 m0, s20, 0
s_nop 0
buffer_load_dwordx4 v30, s[4:7], s21 offen sc1 lds
s_add_u32 m0, s20, 4096
s_nop 0
buffer_load_dwordx4 v30, s[4:7], s22 offen sc1 lds
s_add_u32 s21, s21, 4096
s_add_u32 s22, s22, 4096
s_add_u32 s20, s20, 16384
s_cmp_ge_u32 s20, 143360
s_cselect_b32 s20, s26, s20
s_barrier
s_add_u32 m0, s50, 8192
s_nop 0
buffer_load_dwordx4 v4, s[4:7], s23 offen offset:0 sc1 lds
buffer_load_dwordx4 v4, s[4:7], s23 offen offset:1024 sc1 lds
s_add_u32 s23, s23, 131072
s_add_u32 s50, s50, 16384
s_cmp_ge_u32 s50, 143360
s_cselect_b32 s50, s27, s50
s_add_u32 m0, s20, 0
s_nop 0
buffer_load_dwordx4 v30, s[4:7], s21 offen sc1 lds
s_add_u32 m0, s20, 4096
s_nop 0
buffer_load_dwordx4 v30, s[4:7], s22 offen sc1 lds
s_add_u32 s21, s21, 4096
s_add_u32 s22, s22, 4096
s_add_u32 s20, s20, 16384
s_cmp_ge_u32 s20, 143360
s_cselect_b32 s20, s26, s20
s_add_u32 m0, s50, 8192
s_nop 0
buffer_load_dwordx4 v4, s[4:7], s23 offen offset:0 sc1 lds
buffer_load_dwordx4 v4, s[4:7], s23 offen offset:1024 sc1 lds
s_add_u32 s23, s23, 131072
s_add_u32 s50, s50, 16384
s_cmp_ge_u32 s50, 143360
s_cselect_b32 s50, s27, s50
s_add_u32 m0, s20, 0
s_nop 0
buffer_load_dwordx4 v30, s[4:7], s21 offen sc1 lds
s_add_u32 m0, s20, 4096
s_nop 0
buffer_load_dwordx4 v30, s[4:7], s22 offen sc1 lds
s_add_u32 s21, s21, 4096
s_add_u32 s22, s22, 4096
s_add_u32 s20, s20, 16384
s_cmp_ge_u32 s20, 143360
s_cselect_b32 s20, s26, s20
s_barrier
s_barrier
s_add_u32 m0, s50, 8192
s_nop 0
buffer_load_dwordx4 v4, s[4:7], s23 offen offset:0 sc1 lds
buffer_load_dwordx4 v4, s[4:7], s23 offen offset:1024 sc1 lds
s_add_u32 s23, s23, 131072
s_add_u32 s50, s50, 16384
s_cmp_ge_u32 s50, 143360
s_cselect_b32 s50, s27, s50
s_add_u32 m0, s20, 0
s_nop 0
buffer_load_dwordx4 v30, s[4:7], s21 offen sc1 lds
s_add_u32 m0, s20, 4096
s_nop 0
buffer_load_dwordx4 v30, s[4:7], s22 offen sc1 lds
s_add_u32 s21, s21, 4096
s_add_u32 s22, s22, 4096
s_add_u32 s20, s20, 16384
s_cmp_ge_u32 s20, 143360
s_cselect_b32 s20, s26, s20
s_mov_b32 s24, 38
PS7:
s_waitcnt vmcnt(24)
s_barrier
s_add_u32 m0, s50, 8192
s_nop 0
buffer_load_dwordx4 v4, s[4:7], s23 offen offset:0 sc1 lds
buffer_load_dwordx4 v4, s[4:7], s23 offen offset:1024 sc1 lds
s_add_u32 s23, s23, 131072
s_add_u32 s50, s50, 16384
s_cmp_ge_u32 s50, 143360
s_cselect_b32 s50, s27, s50
s_add_u32 m0, s20, 0
s_nop 0
buffer_load_dwordx4 v30, s[4:7], s21 offen sc1 lds
s_add_u32 m0, s20, 4096
s_nop 0
buffer_load_dwordx4 v30, s[4:7], s22 offen sc1 lds
s_add_u32 s21, s21, 4096
s_add_u32 s22, s22, 4096
s_add_u32 s20, s20, 16384
s_cmp_ge_u32 s20, 143360
s_cselect_b32 s20, s26, s20
s_sub_u32 s24, s24, 1
s_cmp_lg_u32 s24, 0
s_cbranch_scc1 PS7
s_waitcnt vmcnt(24)
s_barrier
s_waitcnt vmcnt(20)
s_barrier
s_lshl_b32 s23, s17, 13
s_add_u32 s23, s23, 33554432
s_add_u32 m0, s50, 8192
s_nop 0
buffer_load_dwordx4 v4, s[4:7], s23 offen offset:0 sc1 lds
buffer_load_dwordx4 v4, s[4:7], s23 offen offset:1024 sc1 lds
s_add_u32 s23, s23, 131072
s_add_u32 m0, s50, 16384
s_nop 0
buffer_load_dwordx4 v4, s[4:7], s23 offen offset:0 sc1 lds
buffer_load_dwordx4 v4, s[4:7], s23 offen offset:1024 sc1 lds
s_add_u32 s23, s23, 131072
s_add_u32 s50, s50, 25600
s_cmp_ge_u32 s50, 143360
s_cselect_b32 s50, s27, s50
s_mul_i32 s21, s18, 458752
s_add_u32 s21, s21, 40239104
s_add_u32 m0, s20, 0
s_nop 0
buffer_load_dwordx4 v30, s[4:7], s21 offen sc1 lds
s_add_u32 m0, s20, 4096
s_add_u32 s25, s21, 4096
buffer_load_dwordx4 v30, s[4:7], s25 offen sc1 lds
s_add_u32 s21, s21, 8192
s_add_u32 s20, s20, 25600
s_cmp_ge_u32 s20, 143360
s_cselect_b32 s20, s26, s20
s_waitcnt vmcnt(22)
s_barrier
s_waitcnt vmcnt(18)
s_barrier
s_add_u32 m0, s50, 8192
s_nop 0
buffer_load_dwordx4 v4, s[4:7], s23 offen offset:0 sc1 lds
buffer_load_dwordx4 v4, s[4:7], s23 offen offset:1024 sc1 lds
s_add_u32 s23, s23, 131072
s_add_u32 m0, s50, 16384
s_nop 0
buffer_load_dwordx4 v4, s[4:7], s23 offen offset:0 sc1 lds
buffer_load_dwordx4 v4, s[4:7], s23 offen offset:1024 sc1 lds
s_add_u32 s23, s23, 131072
s_add_u32 s50, s50, 25600
s_cmp_ge_u32 s50, 143360
s_cselect_b32 s50, s27, s50
s_add_u32 m0, s20, 0
s_nop 0
buffer_load_dwordx4 v30, s[4:7], s21 offen sc1 lds
s_add_u32 m0, s20, 4096
s_add_u32 s25, s21, 4096
buffer_load_dwordx4 v30, s[4:7], s25 offen sc1 lds
s_add_u32 s21, s21, 8192
s_add_u32 s20, s20, 25600
s_cmp_ge_u32 s20, 143360
s_cselect_b32 s20, s26, s20
s_waitcnt vmcnt(20)
s_barrier
s_add_u32 m0, s50, 8192
s_nop 0
buffer_load_dwordx4 v4, s[4:7], s23 offen offset:0 sc1 lds
buffer_load_dwordx4 v4, s[4:7], s23 offen offset:1024 sc1 lds
s_add_u32 s23, s23, 131072
s_add_u32 m0, s50, 16384
s_nop 0
buffer_load_dwordx4 v4, s[4:7], s23 offen offset:0 sc1 lds
buffer_load_dwordx4 v4, s[4:7], s23 offen offset:1024 sc1 lds
s_add_u32 s23, s23, 131072
s_add_u32 s50, s50, 25600
s_cmp_ge_u32 s50, 143360
s_cselect_b32 s50, s27, s50
s_add_u32 m0, s20, 0
s_nop 0
buffer_load_dwordx4 v30, s[4:7], s21 offen sc1 lds
s_add_u32 m0, s20, 4096
s_add_u32 s25, s21, 4096
buffer_load_dwordx4 v30, s[4:7], s25 offen sc1 lds
s_add_u32 s21, s21, 8192
s_add_u32 s20, s20, 25600
s_cmp_ge_u32 s20, 143360
s_cselect_b32 s20, s26, s20
s_waitcnt vmcnt(22)
s_barrier
s_add_u32 m0, s50, 8192
s_nop 0
buffer_load_dwordx4 v4, s[4:7], s23 offen offset:0 sc1 lds
buffer_load_dwordx4 v4, s[4:7], s23 offen offset:1024 sc1 lds
s_add_u32 s23, s23, 131072
s_add_u32 m0, s50, 16384
s_nop 0
buffer_load_dwordx4 v4, s[4:7], s23 offen offset:0 sc1 lds
buffer_load_dwordx4 v4, s[4:7], s23 offen offset:1024 sc1 lds
s_add_u32 s23, s23, 131072
s_add_u32 s50, s50, 25600
s_cmp_ge_u32 s50, 143360
s_cselect_b32 s50, s27, s50
s_add_u32 m0, s20, 0
s_nop 0
buffer_load_dwordx4 v30, s[4:7], s21 offen sc1 lds
s_add_u32 m0, s20, 4096
s_add_u32 s25, s21, 4096
buffer_load_dwordx4 v30, s[4:7], s25 offen sc1 lds
s_add_u32 s21, s21, 8192
s_add_u32 s20, s20, 25600
s_cmp_ge_u32 s20, 143360
s_cselect_b32 s20, s26, s20
s_waitcnt vmcnt(24)
s_barrier
s_mov_b32 s24, 3
PS8:
s_waitcnt vmcnt(18)
s_barrier
s_add_u32 m0, s50, 8192
s_nop 0
buffer_load_dwordx4 v4, s[4:7], s23 offen offset:0 sc1 lds
buffer_load_dwordx4 v4, s[4:7], s23 offen offset:1024 sc1 lds
s_add_u32 s23, s23, 131072
s_add_u32 m0, s50, 16384
s_nop 0
buffer_load_dwordx4 v4, s[4:7], s23 offen offset:0 sc1 lds
buffer_load_dwordx4 v4, s[4:7], s23 offen offset:1024 sc1 lds
s_add_u32 s23, s23, 131072
s_add_u32 s50, s50, 25600
s_cmp_ge_u32 s50, 143360
s_cselect_b32 s50, s27, s50
s_add_u32 m0, s20, 0
s_nop 0
buffer_load_dwordx4 v30, s[4:7], s21 offen sc1 lds
s_add_u32 m0, s20, 4096
s_add_u32 s25, s21, 4096
buffer_load_dwordx4 v30, s[4:7], s25 offen sc1 lds
s_add_u32 s21, s21, 8192
s_add_u32 s20, s20, 25600
s_cmp_ge_u32 s20, 143360
s_cselect_b32 s20, s26, s20
s_sub_u32 s24, s24, 1
s_cmp_lg_u32 s24, 0
s_cbranch_scc1 PS8
s_waitcnt vmcnt(18)
s_barrier
s_cmp_lg_u32 s16, 0
s_cbranch_scc1 NF18
v_mov_b32 v14, 7
s_mov_b64 exec, 1
buffer_store_dword v14, v15, s[4:7], s51 offen sc1
s_mov_b64 exec, -1
NF18:
v_xor_b32 v31, 128, v15
s_add_u32 m0, s50, 8192
s_nop 0
buffer_load_dwordx4 v4, s[4:7], s23 offen offset:0 sc1 lds
buffer_load_dwordx4 v4, s[4:7], s23 offen offset:1024 sc1 lds
s_add_u32 s23, s23, 131072
s_add_u32 m0, s50, 16384
s_nop 0
buffer_load_dwordx4 v4, s[4:7], s23 offen offset:0 sc1 lds
buffer_load_dwordx4 v4, s[4:7], s23 offen offset:1024 sc1 lds
s_add_u32 s23, s23, 131072
s_add_u32 s50, s50, 25600
s_cmp_ge_u32 s50, 143360
s_cselect_b32 s50, s27, s50
s_add_u32 m0, s20, 0
s_nop 0
buffer_load_dwordx4 v30, s[4:7], s21 offen sc1 lds
s_add_u32 m0, s20, 4096
s_add_u32 s25, s21, 4096
buffer_load_dwordx4 v30, s[4:7], s25 offen sc1 lds
s_add_u32 s21, s21, 8192
s_add_u32 s20, s20, 25600
s_cmp_ge_u32 s20, 143360
s_cselect_b32 s20, s26, s20
s_waitcnt vmcnt(18)
s_barrier
s_waitcnt vmcnt(12)
s_barrier
buffer_load_dword v16, v31, s[4:7], s51 offen sc1
s_waitcnt vmcnt(7)
s_barrier
s_waitcnt vmcnt(0)
s_branch PC19
PL19:
buffer_load_dword v16, v31, s[4:7], s51 offen sc1
s_waitcnt vmcnt(0)
PC19:
v_cmp_gt_u32 vcc, 7, v16
s_nop 1
s_cmp_eq_u64 vcc, 0
s_cbranch_scc1 PD19
s_sub_u32 s49, s49, 1
s_cbranch_scc0 PL19
s_mov_b32 s49, 0
PD19:
s_xor_b32 s19, s3, 1
s_lshl_b32 s19, s19, 15
s_lshl_b32 s25, s16, 13
s_add_u32 s19, s19, s25
s_add_u32 s19, s19, 47185920
s_add_u32 m0, s25, 0
s_nop 0
buffer_load_dwordx4 v6, s[4:7], s19 offen offset:0 sc1 lds
buffer_load_dwordx4 v6, s[4:7], s19 offen offset:1024 sc1 lds
buffer_load_dwordx4 v6, s[4:7], s19 offen offset:2048 sc1 lds
buffer_load_dwordx4 v6, s[4:7], s19 offen offset:3072 sc1 lds
s_barrier
s_waitcnt vmcnt(0)
s_barrier
s_endpgm
CONS:
s_getpc_b64 s[58:59]
PCB:
s_sub_u32 s58, s58, PCB-parallel_sum__sliding_local_dilated__mixer_s_mlp__prompt_kernel
s_subb_u32 s59, s59, 0
s_lshl_b32 s19, s16, 13
v_lshl_add_u32 v2, v0, 7, s19
v_mov_b32 v3, 0
v_lshl_add_u64 v[4:5], s[58:59], 0, v[2:3]
global_load_dword v16, v[4:5], off
v_add_u32 v2, 32768, v2
v_min_u32 v2, END-parallel_sum__sliding_local_dilated__mixer_s_mlp__prompt_kernel, v2
v_lshl_add_u64 v[4:5], s[58:59], 0, v[2:3]
global_load_dword v17, v[4:5], off
s_add_u32 s19, s2, s16
s_cmp_lg_u32 s19, 0
s_waitcnt lgkmcnt(0)
s_cbranch_scc1 NZ
v_lshlrev_b32 v2, 7, v0
v_mov_b32 v4, 1
v_mov_b32 v3, 0
s_mov_b32 s54, 256
s_mov_b32 s55, 0x20000
s_mov_b32 s19, 37781504
buffer_store_dword v3, v2, s[4:7], s19 offen sc1
s_mov_b32 s19, 37789696
buffer_store_dword v3, v2, s[4:7], s19 offen sc1
s_mov_b32 s19, 37797888
buffer_store_dword v3, v2, s[4:7], s19 offen sc1
s_mov_b32 s19, 37806080
buffer_store_dword v3, v2, s[4:7], s19 offen sc1
s_waitcnt vmcnt(0)
s_mov_b64 exec, 1
buffer_store_dword v4, v3, s[52:55], 0 offen sc1
s_mov_b64 exec, -1
NZ:
s_cmp_eq_u32 s16, 3
s_cselect_b32 s60, s72, s66
s_cselect_b32 s61, s73, s67
s_mov_b32 s62, 6291456
s_cmov_b32 s62, 2097152
s_mov_b32 s63, 0x20000
s_movk_i32 s21, 6144
s_cmov_b32 s21, 2048
s_cselect_b32 s22, 0, s16
s_lshl_b32 s22, s22, 4
s_add_u32 s22, s22, s18
s_lshl_b32 s22, s22, 7
s_lshl_b32 s19, s17, 6
v_add_u32 v4, s19, v0
v_mul_lo_u32 v4, v4, s21
s_lshr_b32 s32, s16, 1
s_and_b32 s33, s16, 1
s_lshl_b32 s34, s33, 1
s_add_u32 s35, s34, 1
s_lshl_b32 s36, s32, 2
v_lshrrev_b32 v2, 2, v0
v_lshrrev_b32 v3, 4, v0
v_lshl_add_u32 v2, v3, 2, v2
v_lshlrev_b32 v3, 7, v2
v_and_b32 v4, 3, v0
v_lshl_add_u32 v3, v4, 3, v3
v_bfe_u32 v2, v0, 3, 2
s_and_b32 s19, s34, 3
v_xor_b32 v4, s19, v2
v_lshl_add_u32 v4, v4, 5, v3
s_lshr_b32 s19, s34, 2
s_mul_i32 s19, s19, 4096
v_add_u32 v216, s19, v4
s_and_b32 s19, s35, 3
v_xor_b32 v4, s19, v2
v_lshl_add_u32 v4, v4, 5, v3
s_lshr_b32 s19, s35, 2
s_mul_i32 s19, s19, 4096
v_add_u32 v217, s19, v4
s_lshl_b32 s19, s36, 10
s_add_u32 s19, s19, 16384
v_lshl_add_u32 v220, v0, 4, s19
s_lshl_b32 s37, s17, 7
s_lshl_b32 s19, s32, 6
s_add_u32 s37, s37, s19
v_and_b32 v2, 15, v0
v_lshrrev_b32 v3, 4, v0
v_lshrrev_b32 v4, 1, v2
v_xor_b32 v4, v4, v3
v_lshlrev_b32 v4, 4, v4
v_lshl_add_u32 v4, v2, 7, v4
s_lshl_b32 s19, s32, 13
s_add_u32 s19, s19, 16384
v_add_u32 v220, s19, v4
v_xor_b32 v221, 64, v220
v_subrev_u32 v221, 34816, v221
v_lshrrev_b32 v3, 4, v0
v_lshlrev_b32 v3, 2, v3
v_sub_u32 v3, v2, v3
v_mov_b32 v6, 0xf149f2ca
v_add_u32 v4, 16, v3
v_and_b32 v4, 0xfffffff1, v4
v_cmp_eq_u32 vcc, 0, v4
s_nop 1
v_cndmask_b32 v224, v6, 0, vcc
v_add_u32 v4, 0, v3
v_and_b32 v4, 0xfffffff1, v4
v_cmp_eq_u32 vcc, 0, v4
s_nop 1
v_cndmask_b32 v228, v6, 0, vcc
v_add_u32 v4, 15, v3
v_and_b32 v4, 0xfffffff1, v4
v_cmp_eq_u32 vcc, 0, v4
s_nop 1
v_cndmask_b32 v225, v6, 0, vcc
v_add_u32 v4, -1, v3
v_and_b32 v4, 0xfffffff1, v4
v_cmp_eq_u32 vcc, 0, v4
s_nop 1
v_cndmask_b32 v229, v6, 0, vcc
v_add_u32 v4, 14, v3
v_and_b32 v4, 0xfffffff1, v4
v_cmp_eq_u32 vcc, 0, v4
s_nop 1
v_cndmask_b32 v226, v6, 0, vcc
v_add_u32 v4, -2, v3
v_and_b32 v4, 0xfffffff1, v4
v_cmp_eq_u32 vcc, 0, v4
s_nop 1
v_cndmask_b32 v230, v6, 0, vcc
v_add_u32 v4, 13, v3
v_and_b32 v4, 0xfffffff1, v4
v_cmp_eq_u32 vcc, 0, v4
s_nop 1
v_cndmask_b32 v227, v6, 0, vcc
v_add_u32 v4, -3, v3
v_and_b32 v4, 0xfffffff1, v4
v_cmp_eq_u32 vcc, 0, v4
s_nop 1
v_cndmask_b32 v231, v6, 0, vcc
s_cmp_eq_u32 s37, 0
s_cselect_b64 vcc, -1, 0
v_cndmask_b32 v232, v224, v6, vcc
v_cndmask_b32 v233, v225, v6, vcc
v_cndmask_b32 v234, v226, v6, vcc
v_cndmask_b32 v235, v227, v6, vcc
v_mov_b32 v80, 0
v_mov_b32 v81, 0
v_mov_b32 v82, 0
v_mov_b32 v83, 0
v_mov_b32 v84, 0
v_mov_b32 v85, 0
v_mov_b32 v86, 0
v_mov_b32 v87, 0
v_mov_b32 v88, 0
v_mov_b32 v89, 0
v_mov_b32 v90, 0
v_mov_b32 v91, 0
v_mov_b32 v92, 0
v_mov_b32 v93, 0
v_mov_b32 v94, 0
v_mov_b32 v95, 0
v_mov_b32 v96, 0
v_mov_b32 v97, 0
v_mov_b32 v98, 0
v_mov_b32 v99, 0
v_mov_b32 v100, 0
v_mov_b32 v101, 0
v_mov_b32 v102, 0
v_mov_b32 v103, 0
v_mov_b32 v104, 0
v_mov_b32 v105, 0
v_mov_b32 v106, 0
v_mov_b32 v107, 0
v_mov_b32 v108, 0
v_mov_b32 v109, 0
v_mov_b32 v110, 0
v_mov_b32 v111, 0
v_mov_b32 v112, 0
v_mov_b32 v113, 0
v_mov_b32 v114, 0
v_mov_b32 v115, 0
v_mov_b32 v116, 0
v_mov_b32 v117, 0
v_mov_b32 v118, 0
v_mov_b32 v119, 0
v_mov_b32 v120, 0
v_mov_b32 v121, 0
v_mov_b32 v122, 0
v_mov_b32 v123, 0
v_mov_b32 v124, 0
v_mov_b32 v125, 0
v_mov_b32 v126, 0
v_mov_b32 v127, 0
v_mov_b32 v128, 0
v_mov_b32 v129, 0
v_mov_b32 v130, 0
v_mov_b32 v131, 0
v_mov_b32 v132, 0
v_mov_b32 v133, 0
v_mov_b32 v134, 0
v_mov_b32 v135, 0
v_mov_b32 v136, 0
v_mov_b32 v137, 0
v_mov_b32 v138, 0
v_mov_b32 v139, 0
v_mov_b32 v140, 0
v_mov_b32 v141, 0
v_mov_b32 v142, 0
v_mov_b32 v143, 0
v_mov_b32 v144, 0
v_mov_b32 v145, 0
v_mov_b32 v146, 0
v_mov_b32 v147, 0
v_mov_b32 v148, 0
v_mov_b32 v149, 0
v_mov_b32 v150, 0
v_mov_b32 v151, 0
v_mov_b32 v152, 0
v_mov_b32 v153, 0
v_mov_b32 v154, 0
v_mov_b32 v155, 0
v_mov_b32 v156, 0
v_mov_b32 v157, 0
v_mov_b32 v158, 0
v_mov_b32 v159, 0
v_mov_b32 v160, 0
v_mov_b32 v161, 0
v_mov_b32 v162, 0
v_mov_b32 v163, 0
v_mov_b32 v164, 0
v_mov_b32 v165, 0
v_mov_b32 v166, 0
v_mov_b32 v167, 0
v_mov_b32 v168, 0
v_mov_b32 v169, 0
v_mov_b32 v170, 0
v_mov_b32 v171, 0
v_mov_b32 v172, 0
v_mov_b32 v173, 0
v_mov_b32 v174, 0
v_mov_b32 v175, 0
v_mov_b32 v176, 0
v_mov_b32 v177, 0
v_mov_b32 v178, 0
v_mov_b32 v179, 0
v_mov_b32 v180, 0
v_mov_b32 v181, 0
v_mov_b32 v182, 0
v_mov_b32 v183, 0
v_mov_b32 v184, 0
v_mov_b32 v185, 0
v_mov_b32 v186, 0
v_mov_b32 v187, 0
v_mov_b32 v188, 0
v_mov_b32 v189, 0
v_mov_b32 v190, 0
v_mov_b32 v191, 0
v_mov_b32 v192, 0
v_mov_b32 v193, 0
v_mov_b32 v194, 0
v_mov_b32 v195, 0
v_mov_b32 v196, 0
v_mov_b32 v197, 0
v_mov_b32 v198, 0
v_mov_b32 v199, 0
v_mov_b32 v200, 0
v_mov_b32 v201, 0
v_mov_b32 v202, 0
v_mov_b32 v203, 0
v_mov_b32 v204, 0
v_mov_b32 v205, 0
v_mov_b32 v206, 0
v_mov_b32 v207, 0
v_mov_b32 v208, 0
v_mov_b32 v209, 0
v_mov_b32 v210, 0
v_mov_b32 v211, 0
v_mov_b32 v212, 0
v_mov_b32 v213, 0
v_mov_b32 v214, 0
v_mov_b32 v215, 0
s_mov_b32 s40, 0xc0135761
s_mov_b32 s41, 0xc0135761
s_mov_b32 s42, 0xbdd2d3e8
s_mov_b32 s43, 0xbdd2d3e8
v_mov_b32 v14, s40
v_mov_b32 v15, s40
s_lshl_b32 s38, s18, 1
s_add_u32 s38, s38, s33
s_lshl_b32 s39, s38, 17
s_lshl_b32 s19, s37, 6
s_add_u32 s46, s39, s19
s_add_u32 s46, s46, 8388608
s_xor_b32 s38, s38, 8
s_lshl_b32 s39, s38, 17
s_add_u32 s39, s39, 4194304
s_lshr_b32 s19, s38, 4
s_add_u32 s19, s19, 1
s_sub_u32 s47, 0, s19
s_bitcmp1_b32 s38, 3
s_cselect_b32 s19, s47, s19
s_add_u32 s19, s19, s37
v_add_u32 v3, s19, v2
v_and_b32 v4, 48, v0
v_lshlrev_b32 v4, 4, v4
v_add_u32 v6, 0, v3
v_and_b32 v7, 0x7ff, v6
v_cmp_eq_u32 s[28:29], v6, v7
v_lshrrev_b32 v6, 4, v7
v_and_b32 v7, 15, v7
v_lshl_add_u32 v7, v7, 4, v4
v_lshl_add_u32 v8, v6, 10, v7
v_add_u32 v6, 16, v3
v_and_b32 v7, 0x7ff, v6
v_lshrrev_b32 v6, 4, v7
v_and_b32 v7, 15, v7
v_lshl_add_u32 v7, v7, 4, v4
v_lshl_add_u32 v9, v6, 10, v7
v_add_u32 v6, 32, v3
v_and_b32 v7, 0x7ff, v6
v_lshrrev_b32 v6, 4, v7
v_and_b32 v7, 15, v7
v_lshl_add_u32 v7, v7, 4, v4
v_lshl_add_u32 v10, v6, 10, v7
v_add_u32 v6, 48, v3
v_and_b32 v7, 0x7ff, v6
v_cmp_eq_u32 s[30:31], v6, v7
v_lshrrev_b32 v6, 4, v7
v_and_b32 v7, 15, v7
v_lshl_add_u32 v7, v7, 4, v4
v_lshl_add_u32 v11, v6, 10, v7
s_mul_i32 s19, s33, 3072
s_add_u32 s19, s19, 153600
v_lshlrev_b32 v12, 4, v0
v_add_u32 v2, s19, v12
s_mov_b32 s20, 0
s_cmp_eq_u32 s32, 1
s_cbranch_scc1 C1
s_barrier
v_add_u32 v222, s20, v220
ds_read_b128 v[40:43], v222 offset:0
ds_read_b128 v[44:47], v222 offset:2048
ds_read_b128 v[48:51], v222 offset:4096
v_add_u32 v218, s20, v216
ds_read_b64_tr_b16 v[24:25], v218 offset:0
ds_read_b64_tr_b16 v[26:27], v218 offset:512
ds_read_b128 v[52:55], v222 offset:6144
ds_read_b128 v[56:59], v222 offset:16384
v_add_u32 v219, s20, v217
ds_read_b64_tr_b16 v[28:29], v219 offset:0
ds_read_b64_tr_b16 v[30:31], v219 offset:512
ds_read_b64_tr_b16 v[32:33], v218 offset:4096
ds_read_b64_tr_b16 v[34:35], v218 offset:4608
s_mov_b32 s24, 15
.p2align 3
CL_p10_0:
s_waitcnt lgkmcnt(6)
v_mfma_f32_16x16x32_bf16 v[80:83], v[24:27], v[40:43], v[80:83]
v_mfma_f32_16x16x32_bf16 v[112:115], v[24:27], v[44:47], v[112:115]
ds_read_b64_tr_b16 v[36:37], v219 offset:4096
v_mfma_f32_16x16x32_bf16 v[144:147], v[24:27], v[48:51], v[144:147]
s_waitcnt lgkmcnt(6)
v_mfma_f32_16x16x32_bf16 v[176:179], v[24:27], v[52:55], v[176:179]
ds_read_b64_tr_b16 v[38:39], v219 offset:4608
s_waitcnt lgkmcnt(4)
v_mfma_f32_16x16x32_bf16 v[84:87], v[28:31], v[40:43], v[84:87]
v_mfma_f32_16x16x32_bf16 v[116:119], v[28:31], v[44:47], v[116:119]
ds_read_b64_tr_b16 v[24:25], v218 offset:8192
v_mfma_f32_16x16x32_bf16 v[148:151], v[28:31], v[48:51], v[148:151]
v_mfma_f32_16x16x32_bf16 v[180:183], v[28:31], v[52:55], v[180:183]
ds_read_b64_tr_b16 v[26:27], v218 offset:8704
s_waitcnt lgkmcnt(4)
v_mfma_f32_16x16x32_bf16 v[88:91], v[32:35], v[40:43], v[88:91]
v_mfma_f32_16x16x32_bf16 v[120:123], v[32:35], v[44:47], v[120:123]
v_mfma_f32_16x16x32_bf16 v[152:155], v[32:35], v[48:51], v[152:155]
ds_read_b64_tr_b16 v[28:29], v219 offset:8192
v_mfma_f32_16x16x32_bf16 v[184:187], v[32:35], v[52:55], v[184:187]
v_mfma_f32_16x16x32_bf16 v[208:211], v[32:35], v[56:59], v[208:211]
ds_read_b64_tr_b16 v[30:31], v219 offset:8704
s_waitcnt lgkmcnt(4)
v_mfma_f32_16x16x32_bf16 v[92:95], v[36:39], v[40:43], v[92:95]
v_mfma_f32_16x16x32_bf16 v[124:127], v[36:39], v[44:47], v[124:127]
v_mfma_f32_16x16x32_bf16 v[156:159], v[36:39], v[48:51], v[156:159]
ds_read_b64_tr_b16 v[32:33], v218 offset:12288
v_mfma_f32_16x16x32_bf16 v[188:191], v[36:39], v[52:55], v[188:191]
v_mfma_f32_16x16x32_bf16 v[212:215], v[36:39], v[56:59], v[212:215]
ds_read_b64_tr_b16 v[34:35], v218 offset:12800
s_waitcnt lgkmcnt(4)
v_mfma_f32_16x16x32_bf16 v[96:99], v[40:43], v[24:27], v[96:99]
ds_read_b64_tr_b16 v[36:37], v219 offset:12288
v_mfma_f32_16x16x32_bf16 v[128:131], v[44:47], v[24:27], v[128:131]
ds_read_b64_tr_b16 v[38:39], v219 offset:12800
v_mfma_f32_16x16x32_bf16 v[160:163], v[48:51], v[24:27], v[160:163]
s_add_u32 s20, s20, 34816
v_mfma_f32_16x16x32_bf16 v[192:195], v[52:55], v[24:27], v[192:195]
s_cmp_ge_u32 s20, 143360
s_cselect_b32 s20, 0, s20
s_waitcnt lgkmcnt(4)
v_mfma_f32_16x16x32_bf16 v[100:103], v[40:43], v[28:31], v[100:103]
s_barrier
v_add_u32 v222, s20, v221
v_mfma_f32_16x16x32_bf16 v[132:135], v[44:47], v[28:31], v[132:135]
ds_read_b128 v[60:63], v222 offset:0
ds_read_b128 v[64:67], v222 offset:2048
v_mfma_f32_16x16x32_bf16 v[164:167], v[48:51], v[28:31], v[164:167]
ds_read_b128 v[68:71], v222 offset:4096
v_add_u32 v218, s20, v216
v_mfma_f32_16x16x32_bf16 v[196:199], v[52:55], v[28:31], v[196:199]
ds_read_b64_tr_b16 v[24:25], v218 offset:0
ds_read_b64_tr_b16 v[26:27], v218 offset:512
s_waitcnt lgkmcnt(7)
v_mfma_f32_16x16x32_bf16 v[104:107], v[32:35], v[40:43], v[104:107]
ds_read_b128 v[72:75], v222 offset:6144
v_mfma_f32_16x16x32_bf16 v[136:139], v[32:35], v[44:47], v[136:139]
ds_read_b128 v[76:79], v222 offset:16384
v_mfma_f32_16x16x32_bf16 v[168:171], v[32:35], v[48:51], v[168:171]
v_add_u32 v219, s20, v217
v_mfma_f32_16x16x32_bf16 v[200:203], v[32:35], v[52:55], v[200:203]
ds_read_b64_tr_b16 v[28:29], v219 offset:0
ds_read_b64_tr_b16 v[30:31], v219 offset:512
s_waitcnt lgkmcnt(9)
v_mfma_f32_16x16x32_bf16 v[108:111], v[36:39], v[40:43], v[108:111]
v_mfma_f32_16x16x32_bf16 v[140:143], v[36:39], v[44:47], v[140:143]
ds_read_b64_tr_b16 v[32:33], v218 offset:4096
v_mfma_f32_16x16x32_bf16 v[172:175], v[36:39], v[48:51], v[172:175]
v_mfma_f32_16x16x32_bf16 v[204:207], v[36:39], v[52:55], v[204:207]
ds_read_b64_tr_b16 v[34:35], v218 offset:4608
s_waitcnt lgkmcnt(6)
v_mfma_f32_16x16x32_bf16 v[80:83], v[24:27], v[60:63], v[80:83]
v_mfma_f32_16x16x32_bf16 v[112:115], v[24:27], v[64:67], v[112:115]
ds_read_b64_tr_b16 v[36:37], v219 offset:4096
v_mfma_f32_16x16x32_bf16 v[144:147], v[24:27], v[68:71], v[144:147]
s_waitcnt lgkmcnt(6)
v_mfma_f32_16x16x32_bf16 v[176:179], v[24:27], v[72:75], v[176:179]
ds_read_b64_tr_b16 v[38:39], v219 offset:4608
s_waitcnt lgkmcnt(4)
v_mfma_f32_16x16x32_bf16 v[84:87], v[28:31], v[60:63], v[84:87]
v_mfma_f32_16x16x32_bf16 v[116:119], v[28:31], v[64:67], v[116:119]
ds_read_b64_tr_b16 v[24:25], v218 offset:8192
v_mfma_f32_16x16x32_bf16 v[148:151], v[28:31], v[68:71], v[148:151]
v_mfma_f32_16x16x32_bf16 v[180:183], v[28:31], v[72:75], v[180:183]
ds_read_b64_tr_b16 v[26:27], v218 offset:8704
s_waitcnt lgkmcnt(4)
v_mfma_f32_16x16x32_bf16 v[88:91], v[32:35], v[60:63], v[88:91]
v_mfma_f32_16x16x32_bf16 v[120:123], v[32:35], v[64:67], v[120:123]
v_mfma_f32_16x16x32_bf16 v[152:155], v[32:35], v[68:71], v[152:155]
ds_read_b64_tr_b16 v[28:29], v219 offset:8192
v_mfma_f32_16x16x32_bf16 v[184:187], v[32:35], v[72:75], v[184:187]
v_mfma_f32_16x16x32_bf16 v[208:211], v[32:35], v[76:79], v[208:211]
ds_read_b64_tr_b16 v[30:31], v219 offset:8704
s_waitcnt lgkmcnt(4)
v_mfma_f32_16x16x32_bf16 v[92:95], v[36:39], v[60:63], v[92:95]
v_mfma_f32_16x16x32_bf16 v[124:127], v[36:39], v[64:67], v[124:127]
v_mfma_f32_16x16x32_bf16 v[156:159], v[36:39], v[68:71], v[156:159]
ds_read_b64_tr_b16 v[32:33], v218 offset:12288
v_mfma_f32_16x16x32_bf16 v[188:191], v[36:39], v[72:75], v[188:191]
v_mfma_f32_16x16x32_bf16 v[212:215], v[36:39], v[76:79], v[212:215]
ds_read_b64_tr_b16 v[34:35], v218 offset:12800
s_waitcnt lgkmcnt(4)
v_mfma_f32_16x16x32_bf16 v[96:99], v[60:63], v[24:27], v[96:99]
ds_read_b64_tr_b16 v[36:37], v219 offset:12288
v_mfma_f32_16x16x32_bf16 v[128:131], v[64:67], v[24:27], v[128:131]
ds_read_b64_tr_b16 v[38:39], v219 offset:12800
v_mfma_f32_16x16x32_bf16 v[160:163], v[68:71], v[24:27], v[160:163]
s_add_u32 s20, s20, 16384
v_mfma_f32_16x16x32_bf16 v[192:195], v[72:75], v[24:27], v[192:195]
s_cmp_ge_u32 s20, 143360
s_cselect_b32 s20, 0, s20
s_waitcnt lgkmcnt(4)
v_mfma_f32_16x16x32_bf16 v[100:103], v[60:63], v[28:31], v[100:103]
s_barrier
v_add_u32 v222, s20, v220
v_mfma_f32_16x16x32_bf16 v[132:135], v[64:67], v[28:31], v[132:135]
ds_read_b128 v[40:43], v222 offset:0
ds_read_b128 v[44:47], v222 offset:2048
v_mfma_f32_16x16x32_bf16 v[164:167], v[68:71], v[28:31], v[164:167]
ds_read_b128 v[48:51], v222 offset:4096
v_add_u32 v218, s20, v216
v_mfma_f32_16x16x32_bf16 v[196:199], v[72:75], v[28:31], v[196:199]
ds_read_b64_tr_b16 v[24:25], v218 offset:0
ds_read_b64_tr_b16 v[26:27], v218 offset:512
s_waitcnt lgkmcnt(7)
v_mfma_f32_16x16x32_bf16 v[104:107], v[32:35], v[60:63], v[104:107]
ds_read_b128 v[52:55], v222 offset:6144
v_mfma_f32_16x16x32_bf16 v[136:139], v[32:35], v[64:67], v[136:139]
ds_read_b128 v[56:59], v222 offset:16384
v_mfma_f32_16x16x32_bf16 v[168:171], v[32:35], v[68:71], v[168:171]
v_add_u32 v219, s20, v217
v_mfma_f32_16x16x32_bf16 v[200:203], v[32:35], v[72:75], v[200:203]
ds_read_b64_tr_b16 v[28:29], v219 offset:0
ds_read_b64_tr_b16 v[30:31], v219 offset:512
s_waitcnt lgkmcnt(9)
v_mfma_f32_16x16x32_bf16 v[108:111], v[36:39], v[60:63], v[108:111]
ds_read_b64_tr_b16 v[32:33], v218 offset:4096
v_mfma_f32_16x16x32_bf16 v[140:143], v[36:39], v[64:67], v[140:143]
ds_read_b64_tr_b16 v[34:35], v218 offset:4608
v_mfma_f32_16x16x32_bf16 v[172:175], v[36:39], v[68:71], v[172:175]
s_sub_u32 s24, s24, 1
v_mfma_f32_16x16x32_bf16 v[204:207], v[36:39], v[72:75], v[204:207]
s_cmp_lg_u32 s24, 0
s_cbranch_scc1 CL_p10_0
v_and_b32 v4, 15, v0
v_lshlrev_b32 v4, 2, v4
v_and_b32 v5, 48, v0
s_lshl_b32 s19, s33, 7
s_add_u32 s19, s19, 159744
v_add_u32 v3, s19, v5
v_add_u32 v6, s19, v4
s_lshl_b32 s19, s32, 8
s_add_u32 s19, s19, 160768
v_add_u32 v13, s19, v5
v_add_u32 v4, s19, v4
v_add_u32 v5, 576, v4
ds_read_b128 v[236:239], v3 offset:768
ds_read_b128 v[240:243], v3 offset:832
ds_read2_b32 v[244:245], v5 offset0:16 offset1:160
ds_read2_b32 v[246:247], v5 offset0:32 offset1:176
ds_read2_b32 v[248:249], v5 offset0:48 offset1:192
ds_read2_b32 v[250:251], v5 offset0:64 offset1:208
s_waitcnt lgkmcnt(6)
v_mfma_f32_16x16x32_bf16 v[80:83], v[24:27], v[40:43], v[80:83]
v_mfma_f32_16x16x32_bf16 v[112:115], v[24:27], v[44:47], v[112:115]
ds_read_b64_tr_b16 v[36:37], v219 offset:4096
v_mfma_f32_16x16x32_bf16 v[144:147], v[24:27], v[48:51], v[144:147]
s_waitcnt lgkmcnt(6)
v_mfma_f32_16x16x32_bf16 v[176:179], v[24:27], v[52:55], v[176:179]
ds_read_b64_tr_b16 v[38:39], v219 offset:4608
s_waitcnt lgkmcnt(4)
v_mfma_f32_16x16x32_bf16 v[84:87], v[28:31], v[40:43], v[84:87]
v_mfma_f32_16x16x32_bf16 v[116:119], v[28:31], v[44:47], v[116:119]
ds_read_b64_tr_b16 v[24:25], v218 offset:8192
v_mfma_f32_16x16x32_bf16 v[148:151], v[28:31], v[48:51], v[148:151]
v_mfma_f32_16x16x32_bf16 v[180:183], v[28:31], v[52:55], v[180:183]
ds_read_b64_tr_b16 v[26:27], v218 offset:8704
s_waitcnt lgkmcnt(4)
v_mfma_f32_16x16x32_bf16 v[88:91], v[32:35], v[40:43], v[88:91]
v_mfma_f32_16x16x32_bf16 v[120:123], v[32:35], v[44:47], v[120:123]
v_mfma_f32_16x16x32_bf16 v[152:155], v[32:35], v[48:51], v[152:155]
ds_read_b64_tr_b16 v[28:29], v219 offset:8192
v_mfma_f32_16x16x32_bf16 v[184:187], v[32:35], v[52:55], v[184:187]
v_mfma_f32_16x16x32_bf16 v[208:211], v[32:35], v[56:59], v[208:211]
ds_read_b64_tr_b16 v[30:31], v219 offset:8704
s_waitcnt lgkmcnt(4)
v_mfma_f32_16x16x32_bf16 v[92:95], v[36:39], v[40:43], v[92:95]
v_mfma_f32_16x16x32_bf16 v[124:127], v[36:39], v[44:47], v[124:127]
v_mfma_f32_16x16x32_bf16 v[156:159], v[36:39], v[48:51], v[156:159]
ds_read_b64_tr_b16 v[32:33], v218 offset:12288
v_mfma_f32_16x16x32_bf16 v[188:191], v[36:39], v[52:55], v[188:191]
v_mfma_f32_16x16x32_bf16 v[212:215], v[36:39], v[56:59], v[212:215]
ds_read_b64_tr_b16 v[34:35], v218 offset:12800
s_waitcnt lgkmcnt(4)
v_mfma_f32_16x16x32_bf16 v[96:99], v[40:43], v[24:27], v[96:99]
ds_read_b64_tr_b16 v[36:37], v219 offset:12288
v_mfma_f32_16x16x32_bf16 v[128:131], v[44:47], v[24:27], v[128:131]
ds_read_b64_tr_b16 v[38:39], v219 offset:12800
v_mfma_f32_16x16x32_bf16 v[160:163], v[48:51], v[24:27], v[160:163]
s_add_u32 s20, s20, 34816
v_mfma_f32_16x16x32_bf16 v[192:195], v[52:55], v[24:27], v[192:195]
s_cmp_ge_u32 s20, 143360
s_cselect_b32 s20, 0, s20
s_waitcnt lgkmcnt(4)
v_mfma_f32_16x16x32_bf16 v[100:103], v[40:43], v[28:31], v[100:103]
s_barrier
v_add_u32 v222, s20, v221
v_mfma_f32_16x16x32_bf16 v[132:135], v[44:47], v[28:31], v[132:135]
ds_read_b128 v[60:63], v222 offset:0
ds_read_b128 v[64:67], v222 offset:2048
v_mfma_f32_16x16x32_bf16 v[164:167], v[48:51], v[28:31], v[164:167]
ds_read_b128 v[68:71], v222 offset:4096
v_add_u32 v218, s20, v216
v_mfma_f32_16x16x32_bf16 v[196:199], v[52:55], v[28:31], v[196:199]
ds_read_b64_tr_b16 v[24:25], v218 offset:0
ds_read_b64_tr_b16 v[26:27], v218 offset:512
s_waitcnt lgkmcnt(7)
v_mfma_f32_16x16x32_bf16 v[104:107], v[32:35], v[40:43], v[104:107]
ds_read_b128 v[72:75], v222 offset:6144
v_mfma_f32_16x16x32_bf16 v[136:139], v[32:35], v[44:47], v[136:139]
ds_read_b128 v[76:79], v222 offset:16384
v_mfma_f32_16x16x32_bf16 v[168:171], v[32:35], v[48:51], v[168:171]
v_add_u32 v219, s20, v217
v_mfma_f32_16x16x32_bf16 v[200:203], v[32:35], v[52:55], v[200:203]
ds_read_b64_tr_b16 v[28:29], v219 offset:0
ds_read_b64_tr_b16 v[30:31], v219 offset:512
s_waitcnt lgkmcnt(9)
v_mfma_f32_16x16x32_bf16 v[108:111], v[36:39], v[40:43], v[108:111]
v_mfma_f32_16x16x32_bf16 v[140:143], v[36:39], v[44:47], v[140:143]
ds_read_b64_tr_b16 v[32:33], v218 offset:4096
v_mfma_f32_16x16x32_bf16 v[172:175], v[36:39], v[48:51], v[172:175]
v_mfma_f32_16x16x32_bf16 v[204:207], v[36:39], v[52:55], v[204:207]
ds_read_b64_tr_b16 v[34:35], v218 offset:4608
s_waitcnt lgkmcnt(6)
v_mfma_f32_16x16x32_bf16 v[80:83], v[24:27], v[60:63], v[80:83]
v_mfma_f32_16x16x32_bf16 v[112:115], v[24:27], v[64:67], v[112:115]
ds_read_b64_tr_b16 v[36:37], v219 offset:4096
v_mfma_f32_16x16x32_bf16 v[144:147], v[24:27], v[68:71], v[144:147]
s_waitcnt lgkmcnt(6)
v_mfma_f32_16x16x32_bf16 v[176:179], v[24:27], v[72:75], v[176:179]
ds_read_b64_tr_b16 v[38:39], v219 offset:4608
s_waitcnt lgkmcnt(4)
v_mfma_f32_16x16x32_bf16 v[84:87], v[28:31], v[60:63], v[84:87]
v_mfma_f32_16x16x32_bf16 v[116:119], v[28:31], v[64:67], v[116:119]
ds_read_b64_tr_b16 v[24:25], v218 offset:8192
v_mfma_f32_16x16x32_bf16 v[148:151], v[28:31], v[68:71], v[148:151]
v_mfma_f32_16x16x32_bf16 v[180:183], v[28:31], v[72:75], v[180:183]
ds_read_b64_tr_b16 v[26:27], v218 offset:8704
s_waitcnt lgkmcnt(4)
v_mfma_f32_16x16x32_bf16 v[88:91], v[32:35], v[60:63], v[88:91]
v_mfma_f32_16x16x32_bf16 v[120:123], v[32:35], v[64:67], v[120:123]
v_mfma_f32_16x16x32_bf16 v[152:155], v[32:35], v[68:71], v[152:155]
ds_read_b64_tr_b16 v[28:29], v219 offset:8192
v_mfma_f32_16x16x32_bf16 v[184:187], v[32:35], v[72:75], v[184:187]
v_mfma_f32_16x16x32_bf16 v[208:211], v[32:35], v[76:79], v[208:211]
ds_read_b64_tr_b16 v[30:31], v219 offset:8704
s_waitcnt lgkmcnt(4)
v_mfma_f32_16x16x32_bf16 v[92:95], v[36:39], v[60:63], v[92:95]
v_mfma_f32_16x16x32_bf16 v[124:127], v[36:39], v[64:67], v[124:127]
v_mfma_f32_16x16x32_bf16 v[156:159], v[36:39], v[68:71], v[156:159]
ds_read_b64_tr_b16 v[32:33], v218 offset:12288
v_mfma_f32_16x16x32_bf16 v[188:191], v[36:39], v[72:75], v[188:191]
v_mfma_f32_16x16x32_bf16 v[212:215], v[36:39], v[76:79], v[212:215]
ds_read_b64_tr_b16 v[34:35], v218 offset:12800
s_waitcnt lgkmcnt(4)
v_mfma_f32_16x16x32_bf16 v[96:99], v[60:63], v[24:27], v[96:99]
ds_read_b64_tr_b16 v[36:37], v219 offset:12288
v_mfma_f32_16x16x32_bf16 v[128:131], v[64:67], v[24:27], v[128:131]
ds_read_b64_tr_b16 v[38:39], v219 offset:12800
v_mfma_f32_16x16x32_bf16 v[160:163], v[68:71], v[24:27], v[160:163]
s_add_u32 s20, s20, 16384
v_mfma_f32_16x16x32_bf16 v[192:195], v[72:75], v[24:27], v[192:195]
s_cmp_ge_u32 s20, 143360
s_cselect_b32 s20, 0, s20
s_waitcnt lgkmcnt(4)
v_mfma_f32_16x16x32_bf16 v[100:103], v[60:63], v[28:31], v[100:103]
v_mfma_f32_16x16x32_bf16 v[132:135], v[64:67], v[28:31], v[132:135]
v_mfma_f32_16x16x32_bf16 v[164:167], v[68:71], v[28:31], v[164:167]
v_mfma_f32_16x16x32_bf16 v[196:199], v[72:75], v[28:31], v[196:199]
s_waitcnt lgkmcnt(2)
v_mfma_f32_16x16x32_bf16 v[104:107], v[32:35], v[60:63], v[104:107]
v_mfma_f32_16x16x32_bf16 v[136:139], v[32:35], v[64:67], v[136:139]
v_mfma_f32_16x16x32_bf16 v[168:171], v[32:35], v[68:71], v[168:171]
v_mfma_f32_16x16x32_bf16 v[200:203], v[32:35], v[72:75], v[200:203]
s_waitcnt lgkmcnt(0)
v_mfma_f32_16x16x32_bf16 v[108:111], v[36:39], v[60:63], v[108:111]
v_mfma_f32_16x16x32_bf16 v[140:143], v[36:39], v[64:67], v[140:143]
v_mfma_f32_16x16x32_bf16 v[172:175], v[36:39], v[68:71], v[172:175]
v_mfma_f32_16x16x32_bf16 v[204:207], v[36:39], v[72:75], v[204:207]
s_waitcnt vmcnt(0)
ds_read_b128 v[40:43], v3 offset:0
ds_read_b128 v[44:47], v3 offset:64
ds_read_b128 v[48:51], v3 offset:256
ds_read_b128 v[52:55], v3 offset:320
ds_read2_b32 v[16:17], v4 offset0:160 offset1:16
ds_read2_b32 v[18:19], v4 offset0:176 offset1:32
ds_read2_b32 v[20:21], v4 offset0:192 offset1:48
ds_read2_b32 v[22:23], v4 offset0:208 offset1:64
ds_read2_b32 v[218:219], v6 offset0:128 offset1:144
ds_read2_b32 v[216:217], v4 offset0:144 offset1:0
ds_read_b128 v[56:59], v13 offset:640
ds_read_b128 v[60:63], v13 offset:64
ds_read_b128 v[64:67], v13 offset:704
ds_read_b128 v[68:71], v13 offset:128
ds_read_b128 v[72:75], v13 offset:768
ds_read_b128 v[76:79], v13 offset:192
ds_read_b128 v[220:223], v13 offset:832
ds_read_b128 v[252:255], v13 offset:256
v_pk_fma_f32 v[200:201], v[236:237], v[250:251], v[200:201] op_sel_hi:[1,0,1]
v_pk_fma_f32 v[202:203], v[238:239], v[250:251], v[202:203] op_sel_hi:[1,0,1]
v_pk_fma_f32 v[204:205], v[240:241], v[250:251], v[204:205] op_sel_hi:[1,0,1]
v_pk_fma_f32 v[206:207], v[242:243], v[250:251], v[206:207] op_sel_hi:[1,0,1]
v_pk_mul_f32 v[200:201], v[200:201], v[250:251] op_sel:[0,1] op_sel_hi:[1,1]
v_pk_mul_f32 v[202:203], v[202:203], v[250:251] op_sel:[0,1] op_sel_hi:[1,1]
v_pk_mul_f32 v[204:205], v[204:205], v[250:251] op_sel:[0,1] op_sel_hi:[1,1]
v_pk_mul_f32 v[206:207], v[206:207], v[250:251] op_sel:[0,1] op_sel_hi:[1,1]
v_pk_fma_f32 v[168:169], v[236:237], v[248:249], v[168:169] op_sel_hi:[1,0,1]
v_pk_fma_f32 v[170:171], v[238:239], v[248:249], v[170:171] op_sel_hi:[1,0,1]
v_pk_fma_f32 v[172:173], v[240:241], v[248:249], v[172:173] op_sel_hi:[1,0,1]
v_pk_fma_f32 v[174:175], v[242:243], v[248:249], v[174:175] op_sel_hi:[1,0,1]
v_pk_mul_f32 v[168:169], v[168:169], v[248:249] op_sel:[0,1] op_sel_hi:[1,1]
v_pk_mul_f32 v[170:171], v[170:171], v[248:249] op_sel:[0,1] op_sel_hi:[1,1]
v_pk_mul_f32 v[172:173], v[172:173], v[248:249] op_sel:[0,1] op_sel_hi:[1,1]
v_pk_mul_f32 v[174:175], v[174:175], v[248:249] op_sel:[0,1] op_sel_hi:[1,1]
v_pk_mul_f32 v[24:25], v[200:201], v[200:201]
v_pk_mul_f32 v[26:27], v[202:203], v[202:203]
v_pk_mul_f32 v[28:29], v[204:205], v[204:205]
v_pk_mul_f32 v[30:31], v[206:207], v[206:207]
v_pk_mul_f32 v[32:33], v[168:169], v[168:169]
v_pk_mul_f32 v[34:35], v[170:171], v[170:171]
v_pk_mul_f32 v[36:37], v[172:173], v[172:173]
v_pk_mul_f32 v[38:39], v[174:175], v[174:175]
v_pk_fma_f32 v[24:25], v[24:25], s[42:43], v[14:15]
v_pk_fma_f32 v[26:27], v[26:27], s[42:43], v[14:15]
v_pk_fma_f32 v[28:29], v[28:29], s[42:43], v[14:15]
v_pk_fma_f32 v[30:31], v[30:31], s[42:43], v[14:15]
v_pk_fma_f32 v[32:33], v[32:33], s[42:43], v[14:15]
v_pk_fma_f32 v[34:35], v[34:35], s[42:43], v[14:15]
v_pk_fma_f32 v[36:37], v[36:37], s[42:43], v[14:15]
v_pk_fma_f32 v[38:39], v[38:39], s[42:43], v[14:15]
v_pk_mul_f32 v[24:25], v[24:25], v[200:201]
v_pk_mul_f32 v[26:27], v[26:27], v[202:203]
v_pk_mul_f32 v[28:29], v[28:29], v[204:205]
v_pk_mul_f32 v[30:31], v[30:31], v[206:207]
v_pk_mul_f32 v[32:33], v[32:33], v[168:169]
v_pk_mul_f32 v[34:35], v[34:35], v[170:171]
v_pk_mul_f32 v[36:37], v[36:37], v[172:173]
v_pk_mul_f32 v[38:39], v[38:39], v[174:175]
v_exp_f32 v24, v24
v_exp_f32 v25, v25
v_exp_f32 v26, v26
v_exp_f32 v27, v27
v_exp_f32 v28, v28
v_exp_f32 v29, v29
v_exp_f32 v30, v30
v_exp_f32 v31, v31
v_exp_f32 v32, v32
v_exp_f32 v33, v33
v_exp_f32 v34, v34
v_exp_f32 v35, v35
v_exp_f32 v36, v36
v_exp_f32 v37, v37
v_exp_f32 v38, v38
v_exp_f32 v39, v39
v_pk_add_f32 v[24:25], v[24:25], 1.0 op_sel_hi:[1,0]
v_pk_add_f32 v[26:27], v[26:27], 1.0 op_sel_hi:[1,0]
v_pk_add_f32 v[28:29], v[28:29], 1.0 op_sel_hi:[1,0]
v_pk_add_f32 v[30:31], v[30:31], 1.0 op_sel_hi:[1,0]
v_pk_add_f32 v[32:33], v[32:33], 1.0 op_sel_hi:[1,0]
v_pk_add_f32 v[34:35], v[34:35], 1.0 op_sel_hi:[1,0]
v_pk_add_f32 v[36:37], v[36:37], 1.0 op_sel_hi:[1,0]
v_pk_add_f32 v[38:39], v[38:39], 1.0 op_sel_hi:[1,0]
v_rcp_f32 v24, v24
v_rcp_f32 v25, v25
v_rcp_f32 v26, v26
v_rcp_f32 v27, v27
v_rcp_f32 v28, v28
v_rcp_f32 v29, v29
v_rcp_f32 v30, v30
v_rcp_f32 v31, v31
v_rcp_f32 v32, v32
v_rcp_f32 v33, v33
v_rcp_f32 v34, v34
v_rcp_f32 v35, v35
v_rcp_f32 v36, v36
v_rcp_f32 v37, v37
v_rcp_f32 v38, v38
v_rcp_f32 v39, v39
v_pk_mul_f32 v[200:201], v[200:201], v[24:25]
v_pk_mul_f32 v[202:203], v[202:203], v[26:27]
v_pk_mul_f32 v[204:205], v[204:205], v[28:29]
v_pk_mul_f32 v[206:207], v[206:207], v[30:31]
v_pk_mul_f32 v[168:169], v[168:169], v[32:33]
v_pk_mul_f32 v[170:171], v[170:171], v[34:35]
v_pk_mul_f32 v[172:173], v[172:173], v[36:37]
v_pk_mul_f32 v[174:175], v[174:175], v[38:39]
v_cvt_pk_bf16_f32 v200, v200, v201
v_cvt_pk_bf16_f32 v201, v202, v203
v_cvt_pk_bf16_f32 v202, v204, v205
v_cvt_pk_bf16_f32 v203, v206, v207
buffer_store_dwordx4 v[200:203], v11, s[4:7], s39 offen sc1
v_cvt_pk_bf16_f32 v168, v168, v169
v_cvt_pk_bf16_f32 v169, v170, v171
v_cvt_pk_bf16_f32 v170, v172, v173
v_cvt_pk_bf16_f32 v171, v174, v175
buffer_store_dwordx4 v[168:171], v10, s[4:7], s39 offen sc1
v_pk_fma_f32 v[136:137], v[236:237], v[246:247], v[136:137] op_sel_hi:[1,0,1]
v_pk_fma_f32 v[138:139], v[238:239], v[246:247], v[138:139] op_sel_hi:[1,0,1]
v_pk_fma_f32 v[140:141], v[240:241], v[246:247], v[140:141] op_sel_hi:[1,0,1]
v_pk_fma_f32 v[142:143], v[242:243], v[246:247], v[142:143] op_sel_hi:[1,0,1]
v_pk_mul_f32 v[136:137], v[136:137], v[246:247] op_sel:[0,1] op_sel_hi:[1,1]
v_pk_mul_f32 v[138:139], v[138:139], v[246:247] op_sel:[0,1] op_sel_hi:[1,1]
v_pk_mul_f32 v[140:141], v[140:141], v[246:247] op_sel:[0,1] op_sel_hi:[1,1]
v_pk_mul_f32 v[142:143], v[142:143], v[246:247] op_sel:[0,1] op_sel_hi:[1,1]
v_pk_fma_f32 v[104:105], v[236:237], v[244:245], v[104:105] op_sel_hi:[1,0,1]
v_pk_fma_f32 v[106:107], v[238:239], v[244:245], v[106:107] op_sel_hi:[1,0,1]
v_pk_fma_f32 v[108:109], v[240:241], v[244:245], v[108:109] op_sel_hi:[1,0,1]
v_pk_fma_f32 v[110:111], v[242:243], v[244:245], v[110:111] op_sel_hi:[1,0,1]
v_pk_mul_f32 v[104:105], v[104:105], v[244:245] op_sel:[0,1] op_sel_hi:[1,1]
v_pk_mul_f32 v[106:107], v[106:107], v[244:245] op_sel:[0,1] op_sel_hi:[1,1]
v_pk_mul_f32 v[108:109], v[108:109], v[244:245] op_sel:[0,1] op_sel_hi:[1,1]
v_pk_mul_f32 v[110:111], v[110:111], v[244:245] op_sel:[0,1] op_sel_hi:[1,1]
v_pk_mul_f32 v[24:25], v[136:137], v[136:137]
v_pk_mul_f32 v[26:27], v[138:139], v[138:139]
v_pk_mul_f32 v[28:29], v[140:141], v[140:141]
v_pk_mul_f32 v[30:31], v[142:143], v[142:143]
v_pk_mul_f32 v[32:33], v[104:105], v[104:105]
v_pk_mul_f32 v[34:35], v[106:107], v[106:107]
v_pk_mul_f32 v[36:37], v[108:109], v[108:109]
v_pk_mul_f32 v[38:39], v[110:111], v[110:111]
v_pk_fma_f32 v[24:25], v[24:25], s[42:43], v[14:15]
v_pk_fma_f32 v[26:27], v[26:27], s[42:43], v[14:15]
v_pk_fma_f32 v[28:29], v[28:29], s[42:43], v[14:15]
v_pk_fma_f32 v[30:31], v[30:31], s[42:43], v[14:15]
v_pk_fma_f32 v[32:33], v[32:33], s[42:43], v[14:15]
v_pk_fma_f32 v[34:35], v[34:35], s[42:43], v[14:15]
v_pk_fma_f32 v[36:37], v[36:37], s[42:43], v[14:15]
v_pk_fma_f32 v[38:39], v[38:39], s[42:43], v[14:15]
v_pk_mul_f32 v[24:25], v[24:25], v[136:137]
v_pk_mul_f32 v[26:27], v[26:27], v[138:139]
v_pk_mul_f32 v[28:29], v[28:29], v[140:141]
v_pk_mul_f32 v[30:31], v[30:31], v[142:143]
v_pk_mul_f32 v[32:33], v[32:33], v[104:105]
v_pk_mul_f32 v[34:35], v[34:35], v[106:107]
v_pk_mul_f32 v[36:37], v[36:37], v[108:109]
v_pk_mul_f32 v[38:39], v[38:39], v[110:111]
v_exp_f32 v24, v24
v_exp_f32 v25, v25
v_exp_f32 v26, v26
v_exp_f32 v27, v27
v_exp_f32 v28, v28
v_exp_f32 v29, v29
v_exp_f32 v30, v30
v_exp_f32 v31, v31
v_exp_f32 v32, v32
v_exp_f32 v33, v33
v_exp_f32 v34, v34
v_exp_f32 v35, v35
v_exp_f32 v36, v36
v_exp_f32 v37, v37
v_exp_f32 v38, v38
v_exp_f32 v39, v39
v_pk_add_f32 v[24:25], v[24:25], 1.0 op_sel_hi:[1,0]
v_pk_add_f32 v[26:27], v[26:27], 1.0 op_sel_hi:[1,0]
v_pk_add_f32 v[28:29], v[28:29], 1.0 op_sel_hi:[1,0]
v_pk_add_f32 v[30:31], v[30:31], 1.0 op_sel_hi:[1,0]
v_pk_add_f32 v[32:33], v[32:33], 1.0 op_sel_hi:[1,0]
v_pk_add_f32 v[34:35], v[34:35], 1.0 op_sel_hi:[1,0]
v_pk_add_f32 v[36:37], v[36:37], 1.0 op_sel_hi:[1,0]
v_pk_add_f32 v[38:39], v[38:39], 1.0 op_sel_hi:[1,0]
v_rcp_f32 v24, v24
v_rcp_f32 v25, v25
v_rcp_f32 v26, v26
v_rcp_f32 v27, v27
v_rcp_f32 v28, v28
v_rcp_f32 v29, v29
v_rcp_f32 v30, v30
v_rcp_f32 v31, v31
v_rcp_f32 v32, v32
v_rcp_f32 v33, v33
v_rcp_f32 v34, v34
v_rcp_f32 v35, v35
v_rcp_f32 v36, v36
v_rcp_f32 v37, v37
v_rcp_f32 v38, v38
v_rcp_f32 v39, v39
v_pk_mul_f32 v[136:137], v[136:137], v[24:25]
v_pk_mul_f32 v[138:139], v[138:139], v[26:27]
v_pk_mul_f32 v[140:141], v[140:141], v[28:29]
v_pk_mul_f32 v[142:143], v[142:143], v[30:31]
v_pk_mul_f32 v[104:105], v[104:105], v[32:33]
v_pk_mul_f32 v[106:107], v[106:107], v[34:35]
v_pk_mul_f32 v[108:109], v[108:109], v[36:37]
v_pk_mul_f32 v[110:111], v[110:111], v[38:39]
v_cvt_pk_bf16_f32 v136, v136, v137
v_cvt_pk_bf16_f32 v137, v138, v139
v_cvt_pk_bf16_f32 v138, v140, v141
v_cvt_pk_bf16_f32 v139, v142, v143
buffer_store_dwordx4 v[136:139], v9, s[4:7], s39 offen sc1
v_cvt_pk_bf16_f32 v104, v104, v105
v_cvt_pk_bf16_f32 v105, v106, v107
v_cvt_pk_bf16_f32 v106, v108, v109
v_cvt_pk_bf16_f32 v107, v110, v111
v_cndmask_b32 v104, 0, v104, s[28:29]
v_cndmask_b32 v105, 0, v105, s[28:29]
v_cndmask_b32 v106, 0, v106, s[28:29]
v_cndmask_b32 v107, 0, v107, s[28:29]
buffer_store_dwordx4 v[104:107], v8, s[4:7], s39 offen sc1
s_waitcnt lgkmcnt(0)
v_pk_fma_f32 v[80:81], v[40:41], v[16:17], v[80:81] op_sel_hi:[1,0,1]
v_pk_fma_f32 v[82:83], v[42:43], v[16:17], v[82:83] op_sel_hi:[1,0,1]
v_pk_fma_f32 v[84:85], v[44:45], v[16:17], v[84:85] op_sel_hi:[1,0,1]
v_pk_fma_f32 v[86:87], v[46:47], v[16:17], v[86:87] op_sel_hi:[1,0,1]
v_pk_fma_f32 v[88:89], v[48:49], v[16:17], v[88:89] op_sel_hi:[1,0,1]
v_pk_fma_f32 v[90:91], v[50:51], v[16:17], v[90:91] op_sel_hi:[1,0,1]
v_pk_fma_f32 v[92:93], v[52:53], v[16:17], v[92:93] op_sel_hi:[1,0,1]
v_pk_fma_f32 v[94:95], v[54:55], v[16:17], v[94:95] op_sel_hi:[1,0,1]
v_pk_mul_f32 v[80:81], v[80:81], v[16:17] op_sel:[0,1] op_sel_hi:[1,1]
v_pk_mul_f32 v[82:83], v[82:83], v[16:17] op_sel:[0,1] op_sel_hi:[1,1]
v_pk_mul_f32 v[84:85], v[84:85], v[16:17] op_sel:[0,1] op_sel_hi:[1,1]
v_pk_mul_f32 v[86:87], v[86:87], v[16:17] op_sel:[0,1] op_sel_hi:[1,1]
v_pk_mul_f32 v[88:89], v[88:89], v[16:17] op_sel:[0,1] op_sel_hi:[1,1]
v_pk_mul_f32 v[90:91], v[90:91], v[16:17] op_sel:[0,1] op_sel_hi:[1,1]
v_pk_mul_f32 v[92:93], v[92:93], v[16:17] op_sel:[0,1] op_sel_hi:[1,1]
v_pk_mul_f32 v[94:95], v[94:95], v[16:17] op_sel:[0,1] op_sel_hi:[1,1]
v_pk_fma_f32 v[96:97], v[56:57], v[218:219], v[96:97] op_sel:[0,0,0] op_sel_hi:[1,0,1]
v_pk_fma_f32 v[98:99], v[58:59], v[218:219], v[98:99] op_sel:[0,0,0] op_sel_hi:[1,0,1]
v_pk_fma_f32 v[100:101], v[56:57], v[218:219], v[100:101] op_sel:[0,1,0] op_sel_hi:[1,1,1]
v_pk_fma_f32 v[102:103], v[58:59], v[218:219], v[102:103] op_sel:[0,1,0] op_sel_hi:[1,1,1]
v_pk_mul_f32 v[96:97], v[96:97], v[60:61]
v_pk_mul_f32 v[98:99], v[98:99], v[62:63]
v_pk_mul_f32 v[100:101], v[100:101], v[60:61]
v_pk_mul_f32 v[102:103], v[102:103], v[62:63]
v_pk_fma_f32 v[112:113], v[40:41], v[18:19], v[112:113] op_sel_hi:[1,0,1]
v_pk_fma_f32 v[114:115], v[42:43], v[18:19], v[114:115] op_sel_hi:[1,0,1]
v_pk_fma_f32 v[116:117], v[44:45], v[18:19], v[116:117] op_sel_hi:[1,0,1]
v_pk_fma_f32 v[118:119], v[46:47], v[18:19], v[118:119] op_sel_hi:[1,0,1]
v_pk_fma_f32 v[120:121], v[48:49], v[18:19], v[120:121] op_sel_hi:[1,0,1]
v_pk_fma_f32 v[122:123], v[50:51], v[18:19], v[122:123] op_sel_hi:[1,0,1]
v_pk_fma_f32 v[124:125], v[52:53], v[18:19], v[124:125] op_sel_hi:[1,0,1]
v_pk_fma_f32 v[126:127], v[54:55], v[18:19], v[126:127] op_sel_hi:[1,0,1]
v_pk_mul_f32 v[112:113], v[112:113], v[18:19] op_sel:[0,1] op_sel_hi:[1,1]
v_pk_mul_f32 v[114:115], v[114:115], v[18:19] op_sel:[0,1] op_sel_hi:[1,1]
v_pk_mul_f32 v[116:117], v[116:117], v[18:19] op_sel:[0,1] op_sel_hi:[1,1]
v_pk_mul_f32 v[118:119], v[118:119], v[18:19] op_sel:[0,1] op_sel_hi:[1,1]
v_pk_mul_f32 v[120:121], v[120:121], v[18:19] op_sel:[0,1] op_sel_hi:[1,1]
v_pk_mul_f32 v[122:123], v[122:123], v[18:19] op_sel:[0,1] op_sel_hi:[1,1]
v_pk_mul_f32 v[124:125], v[124:125], v[18:19] op_sel:[0,1] op_sel_hi:[1,1]
v_pk_mul_f32 v[126:127], v[126:127], v[18:19] op_sel:[0,1] op_sel_hi:[1,1]
v_pk_fma_f32 v[128:129], v[64:65], v[218:219], v[128:129] op_sel:[0,0,0] op_sel_hi:[1,0,1]
v_pk_fma_f32 v[130:131], v[66:67], v[218:219], v[130:131] op_sel:[0,0,0] op_sel_hi:[1,0,1]
v_pk_fma_f32 v[132:133], v[64:65], v[218:219], v[132:133] op_sel:[0,1,0] op_sel_hi:[1,1,1]
v_pk_fma_f32 v[134:135], v[66:67], v[218:219], v[134:135] op_sel:[0,1,0] op_sel_hi:[1,1,1]
v_pk_mul_f32 v[128:129], v[128:129], v[68:69]
v_pk_mul_f32 v[130:131], v[130:131], v[70:71]
v_pk_mul_f32 v[132:133], v[132:133], v[68:69]
v_pk_mul_f32 v[134:135], v[134:135], v[70:71]
v_pk_fma_f32 v[144:145], v[40:41], v[20:21], v[144:145] op_sel_hi:[1,0,1]
v_pk_fma_f32 v[146:147], v[42:43], v[20:21], v[146:147] op_sel_hi:[1,0,1]
v_pk_fma_f32 v[148:149], v[44:45], v[20:21], v[148:149] op_sel_hi:[1,0,1]
v_pk_fma_f32 v[150:151], v[46:47], v[20:21], v[150:151] op_sel_hi:[1,0,1]
v_pk_fma_f32 v[152:153], v[48:49], v[20:21], v[152:153] op_sel_hi:[1,0,1]
v_pk_fma_f32 v[154:155], v[50:51], v[20:21], v[154:155] op_sel_hi:[1,0,1]
v_pk_fma_f32 v[156:157], v[52:53], v[20:21], v[156:157] op_sel_hi:[1,0,1]
v_pk_fma_f32 v[158:159], v[54:55], v[20:21], v[158:159] op_sel_hi:[1,0,1]
v_pk_mul_f32 v[144:145], v[144:145], v[20:21] op_sel:[0,1] op_sel_hi:[1,1]
v_pk_mul_f32 v[146:147], v[146:147], v[20:21] op_sel:[0,1] op_sel_hi:[1,1]
v_pk_mul_f32 v[148:149], v[148:149], v[20:21] op_sel:[0,1] op_sel_hi:[1,1]
v_pk_mul_f32 v[150:151], v[150:151], v[20:21] op_sel:[0,1] op_sel_hi:[1,1]
v_pk_mul_f32 v[152:153], v[152:153], v[20:21] op_sel:[0,1] op_sel_hi:[1,1]
v_pk_mul_f32 v[154:155], v[154:155], v[20:21] op_sel:[0,1] op_sel_hi:[1,1]
v_pk_mul_f32 v[156:157], v[156:157], v[20:21] op_sel:[0,1] op_sel_hi:[1,1]
v_pk_mul_f32 v[158:159], v[158:159], v[20:21] op_sel:[0,1] op_sel_hi:[1,1]
v_pk_fma_f32 v[160:161], v[72:73], v[218:219], v[160:161] op_sel:[0,0,0] op_sel_hi:[1,0,1]
v_pk_fma_f32 v[162:163], v[74:75], v[218:219], v[162:163] op_sel:[0,0,0] op_sel_hi:[1,0,1]
v_pk_fma_f32 v[164:165], v[72:73], v[218:219], v[164:165] op_sel:[0,1,0] op_sel_hi:[1,1,1]
v_pk_fma_f32 v[166:167], v[74:75], v[218:219], v[166:167] op_sel:[0,1,0] op_sel_hi:[1,1,1]
v_pk_mul_f32 v[160:161], v[160:161], v[76:77]
v_pk_mul_f32 v[162:163], v[162:163], v[78:79]
v_pk_mul_f32 v[164:165], v[164:165], v[76:77]
v_pk_mul_f32 v[166:167], v[166:167], v[78:79]
v_pk_fma_f32 v[176:177], v[40:41], v[22:23], v[176:177] op_sel_hi:[1,0,1]
v_pk_fma_f32 v[178:179], v[42:43], v[22:23], v[178:179] op_sel_hi:[1,0,1]
v_pk_fma_f32 v[180:181], v[44:45], v[22:23], v[180:181] op_sel_hi:[1,0,1]
v_pk_fma_f32 v[182:183], v[46:47], v[22:23], v[182:183] op_sel_hi:[1,0,1]
v_pk_fma_f32 v[184:185], v[48:49], v[22:23], v[184:185] op_sel_hi:[1,0,1]
v_pk_fma_f32 v[186:187], v[50:51], v[22:23], v[186:187] op_sel_hi:[1,0,1]
v_pk_fma_f32 v[188:189], v[52:53], v[22:23], v[188:189] op_sel_hi:[1,0,1]
v_pk_fma_f32 v[190:191], v[54:55], v[22:23], v[190:191] op_sel_hi:[1,0,1]
v_pk_mul_f32 v[176:177], v[176:177], v[22:23] op_sel:[0,1] op_sel_hi:[1,1]
v_pk_mul_f32 v[178:179], v[178:179], v[22:23] op_sel:[0,1] op_sel_hi:[1,1]
v_pk_mul_f32 v[180:181], v[180:181], v[22:23] op_sel:[0,1] op_sel_hi:[1,1]
v_pk_mul_f32 v[182:183], v[182:183], v[22:23] op_sel:[0,1] op_sel_hi:[1,1]
v_pk_mul_f32 v[184:185], v[184:185], v[22:23] op_sel:[0,1] op_sel_hi:[1,1]
v_pk_mul_f32 v[186:187], v[186:187], v[22:23] op_sel:[0,1] op_sel_hi:[1,1]
v_pk_mul_f32 v[188:189], v[188:189], v[22:23] op_sel:[0,1] op_sel_hi:[1,1]
v_pk_mul_f32 v[190:191], v[190:191], v[22:23] op_sel:[0,1] op_sel_hi:[1,1]
v_pk_fma_f32 v[192:193], v[220:221], v[218:219], v[192:193] op_sel:[0,0,0] op_sel_hi:[1,0,1]
v_pk_fma_f32 v[194:195], v[222:223], v[218:219], v[194:195] op_sel:[0,0,0] op_sel_hi:[1,0,1]
v_pk_fma_f32 v[196:197], v[220:221], v[218:219], v[196:197] op_sel:[0,1,0] op_sel_hi:[1,1,1]
v_pk_fma_f32 v[198:199], v[222:223], v[218:219], v[198:199] op_sel:[0,1,0] op_sel_hi:[1,1,1]
v_pk_mul_f32 v[192:193], v[192:193], v[252:253]
v_pk_mul_f32 v[194:195], v[194:195], v[254:255]
v_pk_mul_f32 v[196:197], v[196:197], v[252:253]
v_pk_mul_f32 v[198:199], v[198:199], v[254:255]
v_pk_fma_f32 v[208:209], v[48:49], v[216:217], v[208:209] op_sel_hi:[1,0,1]
v_pk_fma_f32 v[210:211], v[50:51], v[216:217], v[210:211] op_sel_hi:[1,0,1]
v_pk_fma_f32 v[212:213], v[52:53], v[216:217], v[212:213] op_sel_hi:[1,0,1]
v_pk_fma_f32 v[214:215], v[54:55], v[216:217], v[214:215] op_sel_hi:[1,0,1]
v_pk_mul_f32 v[208:209], v[208:209], v[216:217] op_sel:[0,1] op_sel_hi:[1,1]
v_pk_mul_f32 v[210:211], v[210:211], v[216:217] op_sel:[0,1] op_sel_hi:[1,1]
v_pk_mul_f32 v[212:213], v[212:213], v[216:217] op_sel:[0,1] op_sel_hi:[1,1]
v_pk_mul_f32 v[214:215], v[214:215], v[216:217] op_sel:[0,1] op_sel_hi:[1,1]
v_cvt_pk_bf16_f32 v56, v184, v185
v_cvt_pk_bf16_f32 v57, v186, v187
v_cvt_pk_bf16_f32 v58, v188, v189
v_cvt_pk_bf16_f32 v59, v190, v191
v_cvt_pk_bf16_f32 v4, v192, v193
v_cvt_pk_bf16_f32 v5, v194, v195
v_cvt_pk_bf16_f32 v6, v196, v197
v_cvt_pk_bf16_f32 v7, v198, v199
ds_write_b128 v2, v[56:59]
ds_write_b128 v2, v[4:7] offset:1024
v_cvt_pk_bf16_f32 v40, v208, v209
v_cvt_pk_bf16_f32 v41, v210, v211
v_cvt_pk_bf16_f32 v42, v212, v213
v_cvt_pk_bf16_f32 v43, v214, v215
v_cvt_pk_bf16_f32 v24, v80, v81
v_cvt_pk_bf16_f32 v25, v82, v83
v_cvt_pk_bf16_f32 v26, v84, v85
v_cvt_pk_bf16_f32 v27, v86, v87
v_cvt_pk_bf16_f32 v44, v88, v89
v_cvt_pk_bf16_f32 v45, v90, v91
v_cvt_pk_bf16_f32 v46, v92, v93
v_cvt_pk_bf16_f32 v47, v94, v95
v_cvt_pk_bf16_f32 v62, v96, v97
v_cvt_pk_bf16_f32 v63, v98, v99
v_cvt_pk_bf16_f32 v72, v100, v101
v_cvt_pk_bf16_f32 v73, v102, v103
v_cvt_pk_bf16_f32 v28, v112, v113
v_cvt_pk_bf16_f32 v29, v114, v115
v_cvt_pk_bf16_f32 v30, v116, v117
v_cvt_pk_bf16_f32 v31, v118, v119
v_cvt_pk_bf16_f32 v48, v120, v121
v_cvt_pk_bf16_f32 v49, v122, v123
v_cvt_pk_bf16_f32 v50, v124, v125
v_cvt_pk_bf16_f32 v51, v126, v127
v_cvt_pk_bf16_f32 v64, v128, v129
v_cvt_pk_bf16_f32 v65, v130, v131
v_cvt_pk_bf16_f32 v74, v132, v133
v_cvt_pk_bf16_f32 v75, v134, v135
v_cvt_pk_bf16_f32 v32, v144, v145
v_cvt_pk_bf16_f32 v33, v146, v147
v_cvt_pk_bf16_f32 v34, v148, v149
v_cvt_pk_bf16_f32 v35, v150, v151
v_cvt_pk_bf16_f32 v52, v152, v153
v_cvt_pk_bf16_f32 v53, v154, v155
v_cvt_pk_bf16_f32 v54, v156, v157
v_cvt_pk_bf16_f32 v55, v158, v159
v_cvt_pk_bf16_f32 v66, v160, v161
v_cvt_pk_bf16_f32 v67, v162, v163
v_cvt_pk_bf16_f32 v76, v164, v165
v_cvt_pk_bf16_f32 v77, v166, v167
v_cvt_pk_bf16_f32 v36, v176, v177
v_cvt_pk_bf16_f32 v37, v178, v179
v_cvt_pk_bf16_f32 v38, v180, v181
v_cvt_pk_bf16_f32 v39, v182, v183
v_cvt_pk_bf16_f32 v68, v192, v193
v_cvt_pk_bf16_f32 v69, v194, v195
v_cvt_pk_bf16_f32 v78, v196, v197
v_cvt_pk_bf16_f32 v79, v198, v199
s_waitcnt lgkmcnt(0)
s_barrier
ds_read_b64 v[60:61], v2 offset:2048
ds_read_b64 v[70:71], v2 offset:2056
v_mfma_f32_16x16x32_bf16 v[180:183], v[56:59], v[36:39], v[228:231]
v_mfma_f32_16x16x32_bf16 v[176:179], v[52:55], v[36:39], v[224:227]
v_mfma_f32_16x16x32_bf16 v[148:151], v[52:55], v[32:35], v[228:231]
v_mfma_f32_16x16x32_bf16 v[144:147], v[48:51], v[32:35], v[224:227]
v_mfma_f32_16x16x32_bf16 v[116:119], v[48:51], v[28:31], v[228:231]
v_mfma_f32_16x16x32_bf16 v[112:115], v[44:47], v[28:31], v[224:227]
v_mfma_f32_16x16x32_bf16 v[84:87], v[44:47], v[24:27], v[228:231]
s_waitcnt lgkmcnt(0)
v_mfma_f32_16x16x32_bf16 v[80:83], v[40:43], v[24:27], v[232:235]
s_nop 0
v_max3_f32 v184, v176, v177, v178
v_max3_f32 v185, v179, v180, v181
v_max3_f32 v152, v144, v145, v146
v_max3_f32 v153, v147, v148, v149
v_max3_f32 v120, v112, v113, v114
v_max3_f32 v121, v115, v116, v117
s_nop 0
v_max3_f32 v88, v80, v81, v82
v_max3_f32 v89, v83, v84, v85
v_max3_f32 v184, v184, v182, v183
v_max3_f32 v152, v152, v150, v151
v_max3_f32 v120, v120, v118, v119
v_max3_f32 v88, v88, v86, v87
v_max_f32 v184, v184, v185
v_max_f32 v152, v152, v153
v_max_f32 v120, v120, v121
v_max_f32 v88, v88, v89
v_mov_b32 v185, v184
v_mov_b32 v153, v152
v_mov_b32 v121, v120
v_mov_b32 v89, v88
v_permlane16_swap_b32 v184, v185
v_permlane16_swap_b32 v152, v153
v_permlane16_swap_b32 v120, v121
v_permlane16_swap_b32 v88, v89
v_max_f32 v184, v184, v185
v_max_f32 v152, v152, v153
v_max_f32 v120, v120, v121
v_max_f32 v88, v88, v89
v_mov_b32 v185, v184
v_mov_b32 v153, v152
v_mov_b32 v121, v120
v_mov_b32 v89, v88
v_permlane32_swap_b32 v184, v185
v_permlane32_swap_b32 v152, v153
v_permlane32_swap_b32 v120, v121
v_permlane32_swap_b32 v88, v89
v_max_f32 v184, v184, v185
v_max_f32 v152, v152, v153
v_max_f32 v120, v120, v121
v_max_f32 v88, v88, v89
s_mov_b32 s44, 0x3e8293ee
s_mov_b32 s45, 0x3e8293ee
v_mul_f32 v184, 0xbe8293ee, v184
v_mul_f32 v152, 0xbe8293ee, v152
v_mul_f32 v120, 0xbe8293ee, v120
v_mul_f32 v88, 0xbe8293ee, v88
v_pk_fma_f32 v[176:177], v[176:177], s[44:45], v[184:185] op_sel_hi:[1,1,0]
v_pk_fma_f32 v[178:179], v[178:179], s[44:45], v[184:185] op_sel_hi:[1,1,0]
v_pk_fma_f32 v[180:181], v[180:181], s[44:45], v[184:185] op_sel_hi:[1,1,0]
v_pk_fma_f32 v[182:183], v[182:183], s[44:45], v[184:185] op_sel_hi:[1,1,0]
v_pk_fma_f32 v[144:145], v[144:145], s[44:45], v[152:153] op_sel_hi:[1,1,0]
v_pk_fma_f32 v[146:147], v[146:147], s[44:45], v[152:153] op_sel_hi:[1,1,0]
v_pk_fma_f32 v[148:149], v[148:149], s[44:45], v[152:153] op_sel_hi:[1,1,0]
v_pk_fma_f32 v[150:151], v[150:151], s[44:45], v[152:153] op_sel_hi:[1,1,0]
v_pk_fma_f32 v[112:113], v[112:113], s[44:45], v[120:121] op_sel_hi:[1,1,0]
v_pk_fma_f32 v[114:115], v[114:115], s[44:45], v[120:121] op_sel_hi:[1,1,0]
v_pk_fma_f32 v[116:117], v[116:117], s[44:45], v[120:121] op_sel_hi:[1,1,0]
v_pk_fma_f32 v[118:119], v[118:119], s[44:45], v[120:121] op_sel_hi:[1,1,0]
v_pk_fma_f32 v[80:81], v[80:81], s[44:45], v[88:89] op_sel_hi:[1,1,0]
v_pk_fma_f32 v[82:83], v[82:83], s[44:45], v[88:89] op_sel_hi:[1,1,0]
v_pk_fma_f32 v[84:85], v[84:85], s[44:45], v[88:89] op_sel_hi:[1,1,0]
v_pk_fma_f32 v[86:87], v[86:87], s[44:45], v[88:89] op_sel_hi:[1,1,0]
v_exp_f32 v176, v176
v_exp_f32 v177, v177
v_exp_f32 v178, v178
v_exp_f32 v179, v179
v_exp_f32 v180, v180
v_exp_f32 v181, v181
v_exp_f32 v182, v182
v_exp_f32 v183, v183
v_exp_f32 v144, v144
v_exp_f32 v145, v145
v_exp_f32 v146, v146
v_exp_f32 v147, v147
v_exp_f32 v148, v148
v_exp_f32 v149, v149
v_exp_f32 v150, v150
v_exp_f32 v151, v151
v_exp_f32 v112, v112
v_exp_f32 v113, v113
v_exp_f32 v114, v114
v_exp_f32 v115, v115
v_exp_f32 v116, v116
v_exp_f32 v117, v117
v_exp_f32 v118, v118
v_exp_f32 v119, v119
v_exp_f32 v80, v80
v_exp_f32 v81, v81
v_exp_f32 v82, v82
v_exp_f32 v83, v83
v_exp_f32 v84, v84
v_exp_f32 v85, v85
v_exp_f32 v86, v86
v_exp_f32 v87, v87
s_waitcnt vmcnt(0)
s_barrier
v_pk_add_f32 v[184:185], v[176:177], v[178:179]
v_pk_add_f32 v[186:187], v[180:181], v[182:183]
v_pk_add_f32 v[152:153], v[144:145], v[146:147]
v_pk_add_f32 v[154:155], v[148:149], v[150:151]
v_pk_add_f32 v[120:121], v[112:113], v[114:115]
v_pk_add_f32 v[122:123], v[116:117], v[118:119]
v_pk_add_f32 v[88:89], v[80:81], v[82:83]
v_pk_add_f32 v[90:91], v[84:85], v[86:87]
v_pk_add_f32 v[184:185], v[184:185], v[186:187]
v_pk_add_f32 v[152:153], v[152:153], v[154:155]
v_pk_add_f32 v[120:121], v[120:121], v[122:123]
v_pk_add_f32 v[88:89], v[88:89], v[90:91]
v_add_f32 v184, v184, v185
v_add_f32 v152, v152, v153
v_add_f32 v120, v120, v121
v_add_f32 v88, v88, v89
v_mov_b32 v185, v184
v_mov_b32 v153, v152
v_mov_b32 v121, v120
v_mov_b32 v89, v88
v_permlane16_swap_b32 v184, v185
v_permlane16_swap_b32 v152, v153
v_permlane16_swap_b32 v120, v121
v_permlane16_swap_b32 v88, v89
v_add_f32 v184, v184, v185
v_add_f32 v152, v152, v153
v_add_f32 v120, v120, v121
v_add_f32 v88, v88, v89
v_mov_b32 v185, v184
v_mov_b32 v153, v152
v_mov_b32 v121, v120
v_mov_b32 v89, v88
v_permlane32_swap_b32 v184, v185
v_permlane32_swap_b32 v152, v153
v_permlane32_swap_b32 v120, v121
v_permlane32_swap_b32 v88, v89
v_add_f32 v184, v184, v185
v_add_f32 v152, v152, v153
v_add_f32 v120, v120, v121
v_add_f32 v88, v88, v89
v_rcp_f32 v184, v184
v_rcp_f32 v152, v152
v_rcp_f32 v120, v120
v_rcp_f32 v88, v88
v_pk_mul_f32 v[176:177], v[176:177], v[184:185] op_sel_hi:[1,0]
v_pk_mul_f32 v[178:179], v[178:179], v[184:185] op_sel_hi:[1,0]
v_pk_mul_f32 v[180:181], v[180:181], v[184:185] op_sel_hi:[1,0]
v_pk_mul_f32 v[182:183], v[182:183], v[184:185] op_sel_hi:[1,0]
v_pk_mul_f32 v[144:145], v[144:145], v[152:153] op_sel_hi:[1,0]
v_pk_mul_f32 v[146:147], v[146:147], v[152:153] op_sel_hi:[1,0]
v_pk_mul_f32 v[148:149], v[148:149], v[152:153] op_sel_hi:[1,0]
v_pk_mul_f32 v[150:151], v[150:151], v[152:153] op_sel_hi:[1,0]
v_pk_mul_f32 v[112:113], v[112:113], v[120:121] op_sel_hi:[1,0]
v_pk_mul_f32 v[114:115], v[114:115], v[120:121] op_sel_hi:[1,0]
v_pk_mul_f32 v[116:117], v[116:117], v[120:121] op_sel_hi:[1,0]
v_pk_mul_f32 v[118:119], v[118:119], v[120:121] op_sel_hi:[1,0]
v_pk_mul_f32 v[80:81], v[80:81], v[88:89] op_sel_hi:[1,0]
v_pk_mul_f32 v[82:83], v[82:83], v[88:89] op_sel_hi:[1,0]
v_pk_mul_f32 v[84:85], v[84:85], v[88:89] op_sel_hi:[1,0]
v_pk_mul_f32 v[86:87], v[86:87], v[88:89] op_sel_hi:[1,0]
v_cvt_pk_bf16_f32 v36, v176, v177
v_cvt_pk_bf16_f32 v37, v178, v179
v_cvt_pk_bf16_f32 v38, v180, v181
v_cvt_pk_bf16_f32 v39, v182, v183
v_cvt_pk_bf16_f32 v32, v144, v145
v_cvt_pk_bf16_f32 v33, v146, v147
v_cvt_pk_bf16_f32 v34, v148, v149
v_cvt_pk_bf16_f32 v35, v150, v151
v_cvt_pk_bf16_f32 v28, v112, v113
v_cvt_pk_bf16_f32 v29, v114, v115
v_cvt_pk_bf16_f32 v30, v116, v117
v_cvt_pk_bf16_f32 v31, v118, v119
v_cvt_pk_bf16_f32 v24, v80, v81
v_cvt_pk_bf16_f32 v25, v82, v83
v_cvt_pk_bf16_f32 v26, v84, v85
v_cvt_pk_bf16_f32 v27, v86, v87
v_mfma_f32_16x16x32_bf16 v[176:179], v[66:69], v[36:39], 0
v_mfma_f32_16x16x32_bf16 v[180:183], v[76:79], v[36:39], 0
v_mfma_f32_16x16x32_bf16 v[144:147], v[64:67], v[32:35], 0
v_mfma_f32_16x16x32_bf16 v[148:151], v[74:77], v[32:35], 0
v_mfma_f32_16x16x32_bf16 v[112:115], v[62:65], v[28:31], 0
v_mfma_f32_16x16x32_bf16 v[116:119], v[72:75], v[28:31], 0
v_mfma_f32_16x16x32_bf16 v[80:83], v[60:63], v[24:27], 0
v_mfma_f32_16x16x32_bf16 v[84:87], v[70:73], v[24:27], 0
s_nop 0
v_cvt_pk_bf16_f32 v36, v176, v177
v_cvt_pk_bf16_f32 v37, v178, v179
v_cvt_pk_bf16_f32 v38, v180, v181
v_cvt_pk_bf16_f32 v39, v182, v183
buffer_store_dwordx4 v[36:39], v12, s[4:7], s46 offen offset:3072 sc1
v_cvt_pk_bf16_f32 v32, v144, v145
v_cvt_pk_bf16_f32 v33, v146, v147
v_cvt_pk_bf16_f32 v34, v148, v149
v_cvt_pk_bf16_f32 v35, v150, v151
buffer_store_dwordx4 v[32:35], v12, s[4:7], s46 offen offset:2048 sc1
v_cvt_pk_bf16_f32 v28, v112, v113
v_cvt_pk_bf16_f32 v29, v114, v115
v_cvt_pk_bf16_f32 v30, v116, v117
v_cvt_pk_bf16_f32 v31, v118, v119
buffer_store_dwordx4 v[28:31], v12, s[4:7], s46 offen offset:1024 sc1
v_cvt_pk_bf16_f32 v24, v80, v81
v_cvt_pk_bf16_f32 v25, v82, v83
v_cvt_pk_bf16_f32 v26, v84, v85
v_cvt_pk_bf16_f32 v27, v86, v87
buffer_store_dwordx4 v[24:27], v12, s[4:7], s46 offen offset:0 sc1
s_branch P2
C1:
s_barrier
v_add_u32 v222, s20, v220
ds_read_b128 v[40:43], v222 offset:0
ds_read_b128 v[44:47], v222 offset:2048
ds_read_b128 v[48:51], v222 offset:4096
v_add_u32 v218, s20, v216
ds_read_b64_tr_b16 v[24:25], v218 offset:0
ds_read_b64_tr_b16 v[26:27], v218 offset:512
ds_read_b128 v[52:55], v222 offset:6144
ds_read_b128 v[56:59], v222 offset:8192
v_add_u32 v219, s20, v217
ds_read_b64_tr_b16 v[28:29], v219 offset:0
ds_read_b64_tr_b16 v[30:31], v219 offset:512
ds_read_b64_tr_b16 v[32:33], v218 offset:4096
ds_read_b64_tr_b16 v[34:35], v218 offset:4608
s_mov_b32 s24, 15
.p2align 3
CL_p11_0:
s_waitcnt lgkmcnt(6)
v_mfma_f32_16x16x32_bf16 v[80:83], v[24:27], v[40:43], v[80:83]
v_mfma_f32_16x16x32_bf16 v[112:115], v[24:27], v[44:47], v[112:115]
ds_read_b64_tr_b16 v[36:37], v219 offset:4096
v_mfma_f32_16x16x32_bf16 v[144:147], v[24:27], v[48:51], v[144:147]
s_waitcnt lgkmcnt(6)
v_mfma_f32_16x16x32_bf16 v[176:179], v[24:27], v[52:55], v[176:179]
ds_read_b64_tr_b16 v[38:39], v219 offset:4608
s_waitcnt lgkmcnt(4)
v_mfma_f32_16x16x32_bf16 v[84:87], v[28:31], v[40:43], v[84:87]
v_mfma_f32_16x16x32_bf16 v[116:119], v[28:31], v[44:47], v[116:119]
ds_read_b64_tr_b16 v[24:25], v218 offset:8192
v_mfma_f32_16x16x32_bf16 v[148:151], v[28:31], v[48:51], v[148:151]
v_mfma_f32_16x16x32_bf16 v[180:183], v[28:31], v[52:55], v[180:183]
ds_read_b64_tr_b16 v[26:27], v218 offset:8704
s_waitcnt lgkmcnt(4)
v_mfma_f32_16x16x32_bf16 v[88:91], v[32:35], v[40:43], v[88:91]
v_mfma_f32_16x16x32_bf16 v[120:123], v[32:35], v[44:47], v[120:123]
ds_read_b64_tr_b16 v[28:29], v219 offset:8192
v_mfma_f32_16x16x32_bf16 v[152:155], v[32:35], v[48:51], v[152:155]
v_mfma_f32_16x16x32_bf16 v[184:187], v[32:35], v[52:55], v[184:187]
ds_read_b64_tr_b16 v[30:31], v219 offset:8704
s_waitcnt lgkmcnt(4)
v_mfma_f32_16x16x32_bf16 v[92:95], v[36:39], v[40:43], v[92:95]
v_mfma_f32_16x16x32_bf16 v[124:127], v[36:39], v[44:47], v[124:127]
ds_read_b64_tr_b16 v[32:33], v218 offset:12288
v_mfma_f32_16x16x32_bf16 v[156:159], v[36:39], v[48:51], v[156:159]
v_mfma_f32_16x16x32_bf16 v[188:191], v[36:39], v[52:55], v[188:191]
ds_read_b64_tr_b16 v[34:35], v218 offset:12800
s_waitcnt lgkmcnt(4)
v_mfma_f32_16x16x32_bf16 v[96:99], v[40:43], v[24:27], v[96:99]
ds_read_b64_tr_b16 v[36:37], v219 offset:12288
v_mfma_f32_16x16x32_bf16 v[128:131], v[44:47], v[24:27], v[128:131]
ds_read_b64_tr_b16 v[38:39], v219 offset:12800
v_mfma_f32_16x16x32_bf16 v[160:163], v[48:51], v[24:27], v[160:163]
s_add_u32 s20, s20, 34816
v_mfma_f32_16x16x32_bf16 v[192:195], v[52:55], v[24:27], v[192:195]
s_cmp_ge_u32 s20, 143360
v_mfma_f32_16x16x32_bf16 v[208:211], v[56:59], v[24:27], v[208:211]
s_cselect_b32 s20, 0, s20
s_waitcnt lgkmcnt(4)
v_mfma_f32_16x16x32_bf16 v[100:103], v[40:43], v[28:31], v[100:103]
s_barrier
v_mfma_f32_16x16x32_bf16 v[132:135], v[44:47], v[28:31], v[132:135]
v_add_u32 v222, s20, v221
ds_read_b128 v[60:63], v222 offset:0
v_mfma_f32_16x16x32_bf16 v[164:167], v[48:51], v[28:31], v[164:167]
ds_read_b128 v[64:67], v222 offset:2048
v_mfma_f32_16x16x32_bf16 v[196:199], v[52:55], v[28:31], v[196:199]
ds_read_b128 v[68:71], v222 offset:4096
v_add_u32 v218, s20, v216
v_mfma_f32_16x16x32_bf16 v[212:215], v[56:59], v[28:31], v[212:215]
ds_read_b64_tr_b16 v[24:25], v218 offset:0
ds_read_b64_tr_b16 v[26:27], v218 offset:512
s_waitcnt lgkmcnt(7)
v_mfma_f32_16x16x32_bf16 v[104:107], v[32:35], v[40:43], v[104:107]
ds_read_b128 v[72:75], v222 offset:6144
v_mfma_f32_16x16x32_bf16 v[136:139], v[32:35], v[44:47], v[136:139]
ds_read_b128 v[76:79], v222 offset:8192
v_mfma_f32_16x16x32_bf16 v[168:171], v[32:35], v[48:51], v[168:171]
v_add_u32 v219, s20, v217
v_mfma_f32_16x16x32_bf16 v[200:203], v[32:35], v[52:55], v[200:203]
ds_read_b64_tr_b16 v[28:29], v219 offset:0
ds_read_b64_tr_b16 v[30:31], v219 offset:512
s_waitcnt lgkmcnt(9)
v_mfma_f32_16x16x32_bf16 v[108:111], v[36:39], v[40:43], v[108:111]
v_mfma_f32_16x16x32_bf16 v[140:143], v[36:39], v[44:47], v[140:143]
ds_read_b64_tr_b16 v[32:33], v218 offset:4096
v_mfma_f32_16x16x32_bf16 v[172:175], v[36:39], v[48:51], v[172:175]
v_mfma_f32_16x16x32_bf16 v[204:207], v[36:39], v[52:55], v[204:207]
ds_read_b64_tr_b16 v[34:35], v218 offset:4608
s_waitcnt lgkmcnt(6)
v_mfma_f32_16x16x32_bf16 v[80:83], v[24:27], v[60:63], v[80:83]
v_mfma_f32_16x16x32_bf16 v[112:115], v[24:27], v[64:67], v[112:115]
ds_read_b64_tr_b16 v[36:37], v219 offset:4096
v_mfma_f32_16x16x32_bf16 v[144:147], v[24:27], v[68:71], v[144:147]
s_waitcnt lgkmcnt(6)
v_mfma_f32_16x16x32_bf16 v[176:179], v[24:27], v[72:75], v[176:179]
ds_read_b64_tr_b16 v[38:39], v219 offset:4608
s_waitcnt lgkmcnt(4)
v_mfma_f32_16x16x32_bf16 v[84:87], v[28:31], v[60:63], v[84:87]
v_mfma_f32_16x16x32_bf16 v[116:119], v[28:31], v[64:67], v[116:119]
ds_read_b64_tr_b16 v[24:25], v218 offset:8192
v_mfma_f32_16x16x32_bf16 v[148:151], v[28:31], v[68:71], v[148:151]
v_mfma_f32_16x16x32_bf16 v[180:183], v[28:31], v[72:75], v[180:183]
ds_read_b64_tr_b16 v[26:27], v218 offset:8704
s_waitcnt lgkmcnt(4)
v_mfma_f32_16x16x32_bf16 v[88:91], v[32:35], v[60:63], v[88:91]
v_mfma_f32_16x16x32_bf16 v[120:123], v[32:35], v[64:67], v[120:123]
ds_read_b64_tr_b16 v[28:29], v219 offset:8192
v_mfma_f32_16x16x32_bf16 v[152:155], v[32:35], v[68:71], v[152:155]
v_mfma_f32_16x16x32_bf16 v[184:187], v[32:35], v[72:75], v[184:187]
ds_read_b64_tr_b16 v[30:31], v219 offset:8704
s_waitcnt lgkmcnt(4)
v_mfma_f32_16x16x32_bf16 v[92:95], v[36:39], v[60:63], v[92:95]
v_mfma_f32_16x16x32_bf16 v[124:127], v[36:39], v[64:67], v[124:127]
ds_read_b64_tr_b16 v[32:33], v218 offset:12288
v_mfma_f32_16x16x32_bf16 v[156:159], v[36:39], v[68:71], v[156:159]
v_mfma_f32_16x16x32_bf16 v[188:191], v[36:39], v[72:75], v[188:191]
ds_read_b64_tr_b16 v[34:35], v218 offset:12800
s_waitcnt lgkmcnt(4)
v_mfma_f32_16x16x32_bf16 v[96:99], v[60:63], v[24:27], v[96:99]
ds_read_b64_tr_b16 v[36:37], v219 offset:12288
v_mfma_f32_16x16x32_bf16 v[128:131], v[64:67], v[24:27], v[128:131]
ds_read_b64_tr_b16 v[38:39], v219 offset:12800
v_mfma_f32_16x16x32_bf16 v[160:163], v[68:71], v[24:27], v[160:163]
s_add_u32 s20, s20, 16384
v_mfma_f32_16x16x32_bf16 v[192:195], v[72:75], v[24:27], v[192:195]
s_cmp_ge_u32 s20, 143360
v_mfma_f32_16x16x32_bf16 v[208:211], v[76:79], v[24:27], v[208:211]
s_cselect_b32 s20, 0, s20
s_waitcnt lgkmcnt(4)
v_mfma_f32_16x16x32_bf16 v[100:103], v[60:63], v[28:31], v[100:103]
s_barrier
v_mfma_f32_16x16x32_bf16 v[132:135], v[64:67], v[28:31], v[132:135]
v_add_u32 v222, s20, v220
ds_read_b128 v[40:43], v222 offset:0
v_mfma_f32_16x16x32_bf16 v[164:167], v[68:71], v[28:31], v[164:167]
ds_read_b128 v[44:47], v222 offset:2048
v_mfma_f32_16x16x32_bf16 v[196:199], v[72:75], v[28:31], v[196:199]
ds_read_b128 v[48:51], v222 offset:4096
v_add_u32 v218, s20, v216
v_mfma_f32_16x16x32_bf16 v[212:215], v[76:79], v[28:31], v[212:215]
ds_read_b64_tr_b16 v[24:25], v218 offset:0
ds_read_b64_tr_b16 v[26:27], v218 offset:512
s_waitcnt lgkmcnt(7)
v_mfma_f32_16x16x32_bf16 v[104:107], v[32:35], v[60:63], v[104:107]
ds_read_b128 v[52:55], v222 offset:6144
v_mfma_f32_16x16x32_bf16 v[136:139], v[32:35], v[64:67], v[136:139]
ds_read_b128 v[56:59], v222 offset:8192
v_mfma_f32_16x16x32_bf16 v[168:171], v[32:35], v[68:71], v[168:171]
v_add_u32 v219, s20, v217
v_mfma_f32_16x16x32_bf16 v[200:203], v[32:35], v[72:75], v[200:203]
ds_read_b64_tr_b16 v[28:29], v219 offset:0
ds_read_b64_tr_b16 v[30:31], v219 offset:512
s_waitcnt lgkmcnt(9)
v_mfma_f32_16x16x32_bf16 v[108:111], v[36:39], v[60:63], v[108:111]
ds_read_b64_tr_b16 v[32:33], v218 offset:4096
v_mfma_f32_16x16x32_bf16 v[140:143], v[36:39], v[64:67], v[140:143]
ds_read_b64_tr_b16 v[34:35], v218 offset:4608
v_mfma_f32_16x16x32_bf16 v[172:175], v[36:39], v[68:71], v[172:175]
s_sub_u32 s24, s24, 1
v_mfma_f32_16x16x32_bf16 v[204:207], v[36:39], v[72:75], v[204:207]
s_cmp_lg_u32 s24, 0
s_cbranch_scc1 CL_p11_0
v_and_b32 v4, 15, v0
v_lshlrev_b32 v4, 2, v4
v_and_b32 v5, 48, v0
s_lshl_b32 s19, s33, 7
s_add_u32 s19, s19, 159744
v_add_u32 v3, s19, v5
v_add_u32 v6, s19, v4
s_lshl_b32 s19, s32, 8
s_add_u32 s19, s19, 160768
v_add_u32 v13, s19, v5
v_add_u32 v4, s19, v4
v_add_u32 v5, 576, v4
ds_read_b128 v[236:239], v3 offset:768
ds_read_b128 v[240:243], v3 offset:832
ds_read2_b32 v[244:245], v5 offset0:16 offset1:160
ds_read2_b32 v[246:247], v5 offset0:32 offset1:176
ds_read2_b32 v[248:249], v5 offset0:48 offset1:192
ds_read2_b32 v[250:251], v5 offset0:64 offset1:208
s_waitcnt lgkmcnt(6)
v_mfma_f32_16x16x32_bf16 v[80:83], v[24:27], v[40:43], v[80:83]
v_mfma_f32_16x16x32_bf16 v[112:115], v[24:27], v[44:47], v[112:115]
ds_read_b64_tr_b16 v[36:37], v219 offset:4096
v_mfma_f32_16x16x32_bf16 v[144:147], v[24:27], v[48:51], v[144:147]
s_waitcnt lgkmcnt(6)
v_mfma_f32_16x16x32_bf16 v[176:179], v[24:27], v[52:55], v[176:179]
ds_read_b64_tr_b16 v[38:39], v219 offset:4608
s_waitcnt lgkmcnt(4)
v_mfma_f32_16x16x32_bf16 v[84:87], v[28:31], v[40:43], v[84:87]
v_mfma_f32_16x16x32_bf16 v[116:119], v[28:31], v[44:47], v[116:119]
ds_read_b64_tr_b16 v[24:25], v218 offset:8192
v_mfma_f32_16x16x32_bf16 v[148:151], v[28:31], v[48:51], v[148:151]
v_mfma_f32_16x16x32_bf16 v[180:183], v[28:31], v[52:55], v[180:183]
ds_read_b64_tr_b16 v[26:27], v218 offset:8704
s_waitcnt lgkmcnt(4)
v_mfma_f32_16x16x32_bf16 v[88:91], v[32:35], v[40:43], v[88:91]
v_mfma_f32_16x16x32_bf16 v[120:123], v[32:35], v[44:47], v[120:123]
ds_read_b64_tr_b16 v[28:29], v219 offset:8192
v_mfma_f32_16x16x32_bf16 v[152:155], v[32:35], v[48:51], v[152:155]
v_mfma_f32_16x16x32_bf16 v[184:187], v[32:35], v[52:55], v[184:187]
ds_read_b64_tr_b16 v[30:31], v219 offset:8704
s_waitcnt lgkmcnt(4)
v_mfma_f32_16x16x32_bf16 v[92:95], v[36:39], v[40:43], v[92:95]
v_mfma_f32_16x16x32_bf16 v[124:127], v[36:39], v[44:47], v[124:127]
ds_read_b64_tr_b16 v[32:33], v218 offset:12288
v_mfma_f32_16x16x32_bf16 v[156:159], v[36:39], v[48:51], v[156:159]
v_mfma_f32_16x16x32_bf16 v[188:191], v[36:39], v[52:55], v[188:191]
ds_read_b64_tr_b16 v[34:35], v218 offset:12800
s_waitcnt lgkmcnt(4)
v_mfma_f32_16x16x32_bf16 v[96:99], v[40:43], v[24:27], v[96:99]
ds_read_b64_tr_b16 v[36:37], v219 offset:12288
v_mfma_f32_16x16x32_bf16 v[128:131], v[44:47], v[24:27], v[128:131]
ds_read_b64_tr_b16 v[38:39], v219 offset:12800
v_mfma_f32_16x16x32_bf16 v[160:163], v[48:51], v[24:27], v[160:163]
s_add_u32 s20, s20, 34816
v_mfma_f32_16x16x32_bf16 v[192:195], v[52:55], v[24:27], v[192:195]
s_cmp_ge_u32 s20, 143360
v_mfma_f32_16x16x32_bf16 v[208:211], v[56:59], v[24:27], v[208:211]
s_cselect_b32 s20, 0, s20
s_waitcnt lgkmcnt(4)
v_mfma_f32_16x16x32_bf16 v[100:103], v[40:43], v[28:31], v[100:103]
s_barrier
v_mfma_f32_16x16x32_bf16 v[132:135], v[44:47], v[28:31], v[132:135]
v_add_u32 v222, s20, v221
ds_read_b128 v[60:63], v222 offset:0
v_mfma_f32_16x16x32_bf16 v[164:167], v[48:51], v[28:31], v[164:167]
ds_read_b128 v[64:67], v222 offset:2048
v_mfma_f32_16x16x32_bf16 v[196:199], v[52:55], v[28:31], v[196:199]
ds_read_b128 v[68:71], v222 offset:4096
v_add_u32 v218, s20, v216
v_mfma_f32_16x16x32_bf16 v[212:215], v[56:59], v[28:31], v[212:215]
ds_read_b64_tr_b16 v[24:25], v218 offset:0
ds_read_b64_tr_b16 v[26:27], v218 offset:512
s_waitcnt lgkmcnt(7)
v_mfma_f32_16x16x32_bf16 v[104:107], v[32:35], v[40:43], v[104:107]
ds_read_b128 v[72:75], v222 offset:6144
v_mfma_f32_16x16x32_bf16 v[136:139], v[32:35], v[44:47], v[136:139]
ds_read_b128 v[76:79], v222 offset:8192
v_mfma_f32_16x16x32_bf16 v[168:171], v[32:35], v[48:51], v[168:171]
v_add_u32 v219, s20, v217
v_mfma_f32_16x16x32_bf16 v[200:203], v[32:35], v[52:55], v[200:203]
ds_read_b64_tr_b16 v[28:29], v219 offset:0
ds_read_b64_tr_b16 v[30:31], v219 offset:512
s_waitcnt lgkmcnt(9)
v_mfma_f32_16x16x32_bf16 v[108:111], v[36:39], v[40:43], v[108:111]
v_mfma_f32_16x16x32_bf16 v[140:143], v[36:39], v[44:47], v[140:143]
ds_read_b64_tr_b16 v[32:33], v218 offset:4096
v_mfma_f32_16x16x32_bf16 v[172:175], v[36:39], v[48:51], v[172:175]
v_mfma_f32_16x16x32_bf16 v[204:207], v[36:39], v[52:55], v[204:207]
ds_read_b64_tr_b16 v[34:35], v218 offset:4608
s_waitcnt lgkmcnt(6)
v_mfma_f32_16x16x32_bf16 v[80:83], v[24:27], v[60:63], v[80:83]
v_mfma_f32_16x16x32_bf16 v[112:115], v[24:27], v[64:67], v[112:115]
ds_read_b64_tr_b16 v[36:37], v219 offset:4096
v_mfma_f32_16x16x32_bf16 v[144:147], v[24:27], v[68:71], v[144:147]
s_waitcnt lgkmcnt(6)
v_mfma_f32_16x16x32_bf16 v[176:179], v[24:27], v[72:75], v[176:179]
ds_read_b64_tr_b16 v[38:39], v219 offset:4608
s_waitcnt lgkmcnt(4)
v_mfma_f32_16x16x32_bf16 v[84:87], v[28:31], v[60:63], v[84:87]
v_mfma_f32_16x16x32_bf16 v[116:119], v[28:31], v[64:67], v[116:119]
ds_read_b64_tr_b16 v[24:25], v218 offset:8192
v_mfma_f32_16x16x32_bf16 v[148:151], v[28:31], v[68:71], v[148:151]
v_mfma_f32_16x16x32_bf16 v[180:183], v[28:31], v[72:75], v[180:183]
ds_read_b64_tr_b16 v[26:27], v218 offset:8704
s_waitcnt lgkmcnt(4)
v_mfma_f32_16x16x32_bf16 v[88:91], v[32:35], v[60:63], v[88:91]
v_mfma_f32_16x16x32_bf16 v[120:123], v[32:35], v[64:67], v[120:123]
ds_read_b64_tr_b16 v[28:29], v219 offset:8192
v_mfma_f32_16x16x32_bf16 v[152:155], v[32:35], v[68:71], v[152:155]
v_mfma_f32_16x16x32_bf16 v[184:187], v[32:35], v[72:75], v[184:187]
ds_read_b64_tr_b16 v[30:31], v219 offset:8704
s_waitcnt lgkmcnt(4)
v_mfma_f32_16x16x32_bf16 v[92:95], v[36:39], v[60:63], v[92:95]
v_mfma_f32_16x16x32_bf16 v[124:127], v[36:39], v[64:67], v[124:127]
ds_read_b64_tr_b16 v[32:33], v218 offset:12288
v_mfma_f32_16x16x32_bf16 v[156:159], v[36:39], v[68:71], v[156:159]
v_mfma_f32_16x16x32_bf16 v[188:191], v[36:39], v[72:75], v[188:191]
ds_read_b64_tr_b16 v[34:35], v218 offset:12800
s_waitcnt lgkmcnt(4)
v_mfma_f32_16x16x32_bf16 v[96:99], v[60:63], v[24:27], v[96:99]
ds_read_b64_tr_b16 v[36:37], v219 offset:12288
v_mfma_f32_16x16x32_bf16 v[128:131], v[64:67], v[24:27], v[128:131]
ds_read_b64_tr_b16 v[38:39], v219 offset:12800
v_mfma_f32_16x16x32_bf16 v[160:163], v[68:71], v[24:27], v[160:163]
s_add_u32 s20, s20, 16384
v_mfma_f32_16x16x32_bf16 v[192:195], v[72:75], v[24:27], v[192:195]
s_cmp_ge_u32 s20, 143360
v_mfma_f32_16x16x32_bf16 v[208:211], v[76:79], v[24:27], v[208:211]
s_cselect_b32 s20, 0, s20
s_waitcnt lgkmcnt(4)
v_mfma_f32_16x16x32_bf16 v[100:103], v[60:63], v[28:31], v[100:103]
v_mfma_f32_16x16x32_bf16 v[132:135], v[64:67], v[28:31], v[132:135]
v_mfma_f32_16x16x32_bf16 v[164:167], v[68:71], v[28:31], v[164:167]
v_mfma_f32_16x16x32_bf16 v[196:199], v[72:75], v[28:31], v[196:199]
v_mfma_f32_16x16x32_bf16 v[212:215], v[76:79], v[28:31], v[212:215]
s_waitcnt lgkmcnt(2)
v_mfma_f32_16x16x32_bf16 v[104:107], v[32:35], v[60:63], v[104:107]
v_mfma_f32_16x16x32_bf16 v[136:139], v[32:35], v[64:67], v[136:139]
v_mfma_f32_16x16x32_bf16 v[168:171], v[32:35], v[68:71], v[168:171]
v_mfma_f32_16x16x32_bf16 v[200:203], v[32:35], v[72:75], v[200:203]
s_waitcnt lgkmcnt(0)
v_mfma_f32_16x16x32_bf16 v[108:111], v[36:39], v[60:63], v[108:111]
v_mfma_f32_16x16x32_bf16 v[140:143], v[36:39], v[64:67], v[140:143]
v_mfma_f32_16x16x32_bf16 v[172:175], v[36:39], v[68:71], v[172:175]
v_mfma_f32_16x16x32_bf16 v[204:207], v[36:39], v[72:75], v[204:207]
s_waitcnt vmcnt(0)
ds_read_b128 v[40:43], v3 offset:0
ds_read_b128 v[44:47], v3 offset:64
ds_read_b128 v[48:51], v3 offset:256
ds_read_b128 v[52:55], v3 offset:320
ds_read2_b32 v[16:17], v4 offset0:160 offset1:16
ds_read2_b32 v[18:19], v4 offset0:176 offset1:32
ds_read2_b32 v[20:21], v4 offset0:192 offset1:48
ds_read2_b32 v[22:23], v4 offset0:208 offset1:64
ds_read2_b32 v[218:219], v6 offset0:128 offset1:144
ds_read_b128 v[56:59], v13 offset:640
ds_read_b128 v[60:63], v13 offset:64
ds_read_b128 v[64:67], v13 offset:704
ds_read_b128 v[68:71], v13 offset:128
ds_read_b128 v[72:75], v13 offset:768
ds_read_b128 v[76:79], v13 offset:192
ds_read_b128 v[220:223], v13 offset:832
ds_read_b128 v[252:255], v13 offset:256
v_pk_fma_f32 v[200:201], v[236:237], v[250:251], v[200:201] op_sel_hi:[1,0,1]
v_pk_fma_f32 v[202:203], v[238:239], v[250:251], v[202:203] op_sel_hi:[1,0,1]
v_pk_fma_f32 v[204:205], v[240:241], v[250:251], v[204:205] op_sel_hi:[1,0,1]
v_pk_fma_f32 v[206:207], v[242:243], v[250:251], v[206:207] op_sel_hi:[1,0,1]
v_pk_mul_f32 v[200:201], v[200:201], v[250:251] op_sel:[0,1] op_sel_hi:[1,1]
v_pk_mul_f32 v[202:203], v[202:203], v[250:251] op_sel:[0,1] op_sel_hi:[1,1]
v_pk_mul_f32 v[204:205], v[204:205], v[250:251] op_sel:[0,1] op_sel_hi:[1,1]
v_pk_mul_f32 v[206:207], v[206:207], v[250:251] op_sel:[0,1] op_sel_hi:[1,1]
v_pk_fma_f32 v[168:169], v[236:237], v[248:249], v[168:169] op_sel_hi:[1,0,1]
v_pk_fma_f32 v[170:171], v[238:239], v[248:249], v[170:171] op_sel_hi:[1,0,1]
v_pk_fma_f32 v[172:173], v[240:241], v[248:249], v[172:173] op_sel_hi:[1,0,1]
v_pk_fma_f32 v[174:175], v[242:243], v[248:249], v[174:175] op_sel_hi:[1,0,1]
v_pk_mul_f32 v[168:169], v[168:169], v[248:249] op_sel:[0,1] op_sel_hi:[1,1]
v_pk_mul_f32 v[170:171], v[170:171], v[248:249] op_sel:[0,1] op_sel_hi:[1,1]
v_pk_mul_f32 v[172:173], v[172:173], v[248:249] op_sel:[0,1] op_sel_hi:[1,1]
v_pk_mul_f32 v[174:175], v[174:175], v[248:249] op_sel:[0,1] op_sel_hi:[1,1]
v_pk_mul_f32 v[24:25], v[200:201], v[200:201]
v_pk_mul_f32 v[26:27], v[202:203], v[202:203]
v_pk_mul_f32 v[28:29], v[204:205], v[204:205]
v_pk_mul_f32 v[30:31], v[206:207], v[206:207]
v_pk_mul_f32 v[32:33], v[168:169], v[168:169]
v_pk_mul_f32 v[34:35], v[170:171], v[170:171]
v_pk_mul_f32 v[36:37], v[172:173], v[172:173]
v_pk_mul_f32 v[38:39], v[174:175], v[174:175]
v_pk_fma_f32 v[24:25], v[24:25], s[42:43], v[14:15]
v_pk_fma_f32 v[26:27], v[26:27], s[42:43], v[14:15]
v_pk_fma_f32 v[28:29], v[28:29], s[42:43], v[14:15]
v_pk_fma_f32 v[30:31], v[30:31], s[42:43], v[14:15]
v_pk_fma_f32 v[32:33], v[32:33], s[42:43], v[14:15]
v_pk_fma_f32 v[34:35], v[34:35], s[42:43], v[14:15]
v_pk_fma_f32 v[36:37], v[36:37], s[42:43], v[14:15]
v_pk_fma_f32 v[38:39], v[38:39], s[42:43], v[14:15]
v_pk_mul_f32 v[24:25], v[24:25], v[200:201]
v_pk_mul_f32 v[26:27], v[26:27], v[202:203]
v_pk_mul_f32 v[28:29], v[28:29], v[204:205]
v_pk_mul_f32 v[30:31], v[30:31], v[206:207]
v_pk_mul_f32 v[32:33], v[32:33], v[168:169]
v_pk_mul_f32 v[34:35], v[34:35], v[170:171]
v_pk_mul_f32 v[36:37], v[36:37], v[172:173]
v_pk_mul_f32 v[38:39], v[38:39], v[174:175]
v_exp_f32 v24, v24
v_exp_f32 v25, v25
v_exp_f32 v26, v26
v_exp_f32 v27, v27
v_exp_f32 v28, v28
v_exp_f32 v29, v29
v_exp_f32 v30, v30
v_exp_f32 v31, v31
v_exp_f32 v32, v32
v_exp_f32 v33, v33
v_exp_f32 v34, v34
v_exp_f32 v35, v35
v_exp_f32 v36, v36
v_exp_f32 v37, v37
v_exp_f32 v38, v38
v_exp_f32 v39, v39
v_pk_add_f32 v[24:25], v[24:25], 1.0 op_sel_hi:[1,0]
v_pk_add_f32 v[26:27], v[26:27], 1.0 op_sel_hi:[1,0]
v_pk_add_f32 v[28:29], v[28:29], 1.0 op_sel_hi:[1,0]
v_pk_add_f32 v[30:31], v[30:31], 1.0 op_sel_hi:[1,0]
v_pk_add_f32 v[32:33], v[32:33], 1.0 op_sel_hi:[1,0]
v_pk_add_f32 v[34:35], v[34:35], 1.0 op_sel_hi:[1,0]
v_pk_add_f32 v[36:37], v[36:37], 1.0 op_sel_hi:[1,0]
v_pk_add_f32 v[38:39], v[38:39], 1.0 op_sel_hi:[1,0]
v_rcp_f32 v24, v24
v_rcp_f32 v25, v25
v_rcp_f32 v26, v26
v_rcp_f32 v27, v27
v_rcp_f32 v28, v28
v_rcp_f32 v29, v29
v_rcp_f32 v30, v30
v_rcp_f32 v31, v31
v_rcp_f32 v32, v32
v_rcp_f32 v33, v33
v_rcp_f32 v34, v34
v_rcp_f32 v35, v35
v_rcp_f32 v36, v36
v_rcp_f32 v37, v37
v_rcp_f32 v38, v38
v_rcp_f32 v39, v39
v_pk_mul_f32 v[200:201], v[200:201], v[24:25]
v_pk_mul_f32 v[202:203], v[202:203], v[26:27]
v_pk_mul_f32 v[204:205], v[204:205], v[28:29]
v_pk_mul_f32 v[206:207], v[206:207], v[30:31]
v_pk_mul_f32 v[168:169], v[168:169], v[32:33]
v_pk_mul_f32 v[170:171], v[170:171], v[34:35]
v_pk_mul_f32 v[172:173], v[172:173], v[36:37]
v_pk_mul_f32 v[174:175], v[174:175], v[38:39]
v_cvt_pk_bf16_f32 v200, v200, v201
v_cvt_pk_bf16_f32 v201, v202, v203
v_cvt_pk_bf16_f32 v202, v204, v205
v_cvt_pk_bf16_f32 v203, v206, v207
v_cndmask_b32 v200, 0, v200, s[30:31]
v_cndmask_b32 v201, 0, v201, s[30:31]
v_cndmask_b32 v202, 0, v202, s[30:31]
v_cndmask_b32 v203, 0, v203, s[30:31]
buffer_store_dwordx4 v[200:203], v11, s[4:7], s39 offen sc1
v_cvt_pk_bf16_f32 v168, v168, v169
v_cvt_pk_bf16_f32 v169, v170, v171
v_cvt_pk_bf16_f32 v170, v172, v173
v_cvt_pk_bf16_f32 v171, v174, v175
buffer_store_dwordx4 v[168:171], v10, s[4:7], s39 offen sc1
v_pk_fma_f32 v[136:137], v[236:237], v[246:247], v[136:137] op_sel_hi:[1,0,1]
v_pk_fma_f32 v[138:139], v[238:239], v[246:247], v[138:139] op_sel_hi:[1,0,1]
v_pk_fma_f32 v[140:141], v[240:241], v[246:247], v[140:141] op_sel_hi:[1,0,1]
v_pk_fma_f32 v[142:143], v[242:243], v[246:247], v[142:143] op_sel_hi:[1,0,1]
v_pk_mul_f32 v[136:137], v[136:137], v[246:247] op_sel:[0,1] op_sel_hi:[1,1]
v_pk_mul_f32 v[138:139], v[138:139], v[246:247] op_sel:[0,1] op_sel_hi:[1,1]
v_pk_mul_f32 v[140:141], v[140:141], v[246:247] op_sel:[0,1] op_sel_hi:[1,1]
v_pk_mul_f32 v[142:143], v[142:143], v[246:247] op_sel:[0,1] op_sel_hi:[1,1]
v_pk_fma_f32 v[104:105], v[236:237], v[244:245], v[104:105] op_sel_hi:[1,0,1]
v_pk_fma_f32 v[106:107], v[238:239], v[244:245], v[106:107] op_sel_hi:[1,0,1]
v_pk_fma_f32 v[108:109], v[240:241], v[244:245], v[108:109] op_sel_hi:[1,0,1]
v_pk_fma_f32 v[110:111], v[242:243], v[244:245], v[110:111] op_sel_hi:[1,0,1]
v_pk_mul_f32 v[104:105], v[104:105], v[244:245] op_sel:[0,1] op_sel_hi:[1,1]
v_pk_mul_f32 v[106:107], v[106:107], v[244:245] op_sel:[0,1] op_sel_hi:[1,1]
v_pk_mul_f32 v[108:109], v[108:109], v[244:245] op_sel:[0,1] op_sel_hi:[1,1]
v_pk_mul_f32 v[110:111], v[110:111], v[244:245] op_sel:[0,1] op_sel_hi:[1,1]
v_subrev_u32 v13, 256, v13
ds_read_b128 v[236:239], v13 offset:576
ds_read_b128 v[240:243], v13
v_pk_mul_f32 v[24:25], v[136:137], v[136:137]
v_pk_mul_f32 v[26:27], v[138:139], v[138:139]
v_pk_mul_f32 v[28:29], v[140:141], v[140:141]
v_pk_mul_f32 v[30:31], v[142:143], v[142:143]
v_pk_mul_f32 v[32:33], v[104:105], v[104:105]
v_pk_mul_f32 v[34:35], v[106:107], v[106:107]
v_pk_mul_f32 v[36:37], v[108:109], v[108:109]
v_pk_mul_f32 v[38:39], v[110:111], v[110:111]
v_pk_fma_f32 v[24:25], v[24:25], s[42:43], v[14:15]
v_pk_fma_f32 v[26:27], v[26:27], s[42:43], v[14:15]
v_pk_fma_f32 v[28:29], v[28:29], s[42:43], v[14:15]
v_pk_fma_f32 v[30:31], v[30:31], s[42:43], v[14:15]
v_pk_fma_f32 v[32:33], v[32:33], s[42:43], v[14:15]
v_pk_fma_f32 v[34:35], v[34:35], s[42:43], v[14:15]
v_pk_fma_f32 v[36:37], v[36:37], s[42:43], v[14:15]
v_pk_fma_f32 v[38:39], v[38:39], s[42:43], v[14:15]
v_pk_mul_f32 v[24:25], v[24:25], v[136:137]
v_pk_mul_f32 v[26:27], v[26:27], v[138:139]
v_pk_mul_f32 v[28:29], v[28:29], v[140:141]
v_pk_mul_f32 v[30:31], v[30:31], v[142:143]
v_pk_mul_f32 v[32:33], v[32:33], v[104:105]
v_pk_mul_f32 v[34:35], v[34:35], v[106:107]
v_pk_mul_f32 v[36:37], v[36:37], v[108:109]
v_pk_mul_f32 v[38:39], v[38:39], v[110:111]
v_exp_f32 v24, v24
v_exp_f32 v25, v25
v_exp_f32 v26, v26
v_exp_f32 v27, v27
v_exp_f32 v28, v28
v_exp_f32 v29, v29
v_exp_f32 v30, v30
v_exp_f32 v31, v31
v_exp_f32 v32, v32
v_exp_f32 v33, v33
v_exp_f32 v34, v34
v_exp_f32 v35, v35
v_exp_f32 v36, v36
v_exp_f32 v37, v37
v_exp_f32 v38, v38
v_exp_f32 v39, v39
v_pk_add_f32 v[24:25], v[24:25], 1.0 op_sel_hi:[1,0]
v_pk_add_f32 v[26:27], v[26:27], 1.0 op_sel_hi:[1,0]
v_pk_add_f32 v[28:29], v[28:29], 1.0 op_sel_hi:[1,0]
v_pk_add_f32 v[30:31], v[30:31], 1.0 op_sel_hi:[1,0]
v_pk_add_f32 v[32:33], v[32:33], 1.0 op_sel_hi:[1,0]
v_pk_add_f32 v[34:35], v[34:35], 1.0 op_sel_hi:[1,0]
v_pk_add_f32 v[36:37], v[36:37], 1.0 op_sel_hi:[1,0]
v_pk_add_f32 v[38:39], v[38:39], 1.0 op_sel_hi:[1,0]
v_rcp_f32 v24, v24
v_rcp_f32 v25, v25
v_rcp_f32 v26, v26
v_rcp_f32 v27, v27
v_rcp_f32 v28, v28
v_rcp_f32 v29, v29
v_rcp_f32 v30, v30
v_rcp_f32 v31, v31
v_rcp_f32 v32, v32
v_rcp_f32 v33, v33
v_rcp_f32 v34, v34
v_rcp_f32 v35, v35
v_rcp_f32 v36, v36
v_rcp_f32 v37, v37
v_rcp_f32 v38, v38
v_rcp_f32 v39, v39
v_pk_mul_f32 v[136:137], v[136:137], v[24:25]
v_pk_mul_f32 v[138:139], v[138:139], v[26:27]
v_pk_mul_f32 v[140:141], v[140:141], v[28:29]
v_pk_mul_f32 v[142:143], v[142:143], v[30:31]
v_pk_mul_f32 v[104:105], v[104:105], v[32:33]
v_pk_mul_f32 v[106:107], v[106:107], v[34:35]
v_pk_mul_f32 v[108:109], v[108:109], v[36:37]
v_pk_mul_f32 v[110:111], v[110:111], v[38:39]
v_cvt_pk_bf16_f32 v136, v136, v137
v_cvt_pk_bf16_f32 v137, v138, v139
v_cvt_pk_bf16_f32 v138, v140, v141
v_cvt_pk_bf16_f32 v139, v142, v143
buffer_store_dwordx4 v[136:139], v9, s[4:7], s39 offen sc1
v_cvt_pk_bf16_f32 v104, v104, v105
v_cvt_pk_bf16_f32 v105, v106, v107
v_cvt_pk_bf16_f32 v106, v108, v109
v_cvt_pk_bf16_f32 v107, v110, v111
buffer_store_dwordx4 v[104:107], v8, s[4:7], s39 offen sc1
s_waitcnt lgkmcnt(0)
v_pk_fma_f32 v[80:81], v[40:41], v[16:17], v[80:81] op_sel_hi:[1,0,1]
v_pk_fma_f32 v[82:83], v[42:43], v[16:17], v[82:83] op_sel_hi:[1,0,1]
v_pk_fma_f32 v[84:85], v[44:45], v[16:17], v[84:85] op_sel_hi:[1,0,1]
v_pk_fma_f32 v[86:87], v[46:47], v[16:17], v[86:87] op_sel_hi:[1,0,1]
v_pk_fma_f32 v[88:89], v[48:49], v[16:17], v[88:89] op_sel_hi:[1,0,1]
v_pk_fma_f32 v[90:91], v[50:51], v[16:17], v[90:91] op_sel_hi:[1,0,1]
v_pk_fma_f32 v[92:93], v[52:53], v[16:17], v[92:93] op_sel_hi:[1,0,1]
v_pk_fma_f32 v[94:95], v[54:55], v[16:17], v[94:95] op_sel_hi:[1,0,1]
v_pk_mul_f32 v[80:81], v[80:81], v[16:17] op_sel:[0,1] op_sel_hi:[1,1]
v_pk_mul_f32 v[82:83], v[82:83], v[16:17] op_sel:[0,1] op_sel_hi:[1,1]
v_pk_mul_f32 v[84:85], v[84:85], v[16:17] op_sel:[0,1] op_sel_hi:[1,1]
v_pk_mul_f32 v[86:87], v[86:87], v[16:17] op_sel:[0,1] op_sel_hi:[1,1]
v_pk_mul_f32 v[88:89], v[88:89], v[16:17] op_sel:[0,1] op_sel_hi:[1,1]
v_pk_mul_f32 v[90:91], v[90:91], v[16:17] op_sel:[0,1] op_sel_hi:[1,1]
v_pk_mul_f32 v[92:93], v[92:93], v[16:17] op_sel:[0,1] op_sel_hi:[1,1]
v_pk_mul_f32 v[94:95], v[94:95], v[16:17] op_sel:[0,1] op_sel_hi:[1,1]
v_pk_fma_f32 v[96:97], v[56:57], v[218:219], v[96:97] op_sel:[0,0,0] op_sel_hi:[1,0,1]
v_pk_fma_f32 v[98:99], v[58:59], v[218:219], v[98:99] op_sel:[0,0,0] op_sel_hi:[1,0,1]
v_pk_fma_f32 v[100:101], v[56:57], v[218:219], v[100:101] op_sel:[0,1,0] op_sel_hi:[1,1,1]
v_pk_fma_f32 v[102:103], v[58:59], v[218:219], v[102:103] op_sel:[0,1,0] op_sel_hi:[1,1,1]
v_pk_mul_f32 v[96:97], v[96:97], v[60:61]
v_pk_mul_f32 v[98:99], v[98:99], v[62:63]
v_pk_mul_f32 v[100:101], v[100:101], v[60:61]
v_pk_mul_f32 v[102:103], v[102:103], v[62:63]
v_pk_fma_f32 v[112:113], v[40:41], v[18:19], v[112:113] op_sel_hi:[1,0,1]
v_pk_fma_f32 v[114:115], v[42:43], v[18:19], v[114:115] op_sel_hi:[1,0,1]
v_pk_fma_f32 v[116:117], v[44:45], v[18:19], v[116:117] op_sel_hi:[1,0,1]
v_pk_fma_f32 v[118:119], v[46:47], v[18:19], v[118:119] op_sel_hi:[1,0,1]
v_pk_fma_f32 v[120:121], v[48:49], v[18:19], v[120:121] op_sel_hi:[1,0,1]
v_pk_fma_f32 v[122:123], v[50:51], v[18:19], v[122:123] op_sel_hi:[1,0,1]
v_pk_fma_f32 v[124:125], v[52:53], v[18:19], v[124:125] op_sel_hi:[1,0,1]
v_pk_fma_f32 v[126:127], v[54:55], v[18:19], v[126:127] op_sel_hi:[1,0,1]
v_pk_mul_f32 v[112:113], v[112:113], v[18:19] op_sel:[0,1] op_sel_hi:[1,1]
v_pk_mul_f32 v[114:115], v[114:115], v[18:19] op_sel:[0,1] op_sel_hi:[1,1]
v_pk_mul_f32 v[116:117], v[116:117], v[18:19] op_sel:[0,1] op_sel_hi:[1,1]
v_pk_mul_f32 v[118:119], v[118:119], v[18:19] op_sel:[0,1] op_sel_hi:[1,1]
v_pk_mul_f32 v[120:121], v[120:121], v[18:19] op_sel:[0,1] op_sel_hi:[1,1]
v_pk_mul_f32 v[122:123], v[122:123], v[18:19] op_sel:[0,1] op_sel_hi:[1,1]
v_pk_mul_f32 v[124:125], v[124:125], v[18:19] op_sel:[0,1] op_sel_hi:[1,1]
v_pk_mul_f32 v[126:127], v[126:127], v[18:19] op_sel:[0,1] op_sel_hi:[1,1]
v_pk_fma_f32 v[128:129], v[64:65], v[218:219], v[128:129] op_sel:[0,0,0] op_sel_hi:[1,0,1]
v_pk_fma_f32 v[130:131], v[66:67], v[218:219], v[130:131] op_sel:[0,0,0] op_sel_hi:[1,0,1]
v_pk_fma_f32 v[132:133], v[64:65], v[218:219], v[132:133] op_sel:[0,1,0] op_sel_hi:[1,1,1]
v_pk_fma_f32 v[134:135], v[66:67], v[218:219], v[134:135] op_sel:[0,1,0] op_sel_hi:[1,1,1]
v_pk_mul_f32 v[128:129], v[128:129], v[68:69]
v_pk_mul_f32 v[130:131], v[130:131], v[70:71]
v_pk_mul_f32 v[132:133], v[132:133], v[68:69]
v_pk_mul_f32 v[134:135], v[134:135], v[70:71]
v_pk_fma_f32 v[144:145], v[40:41], v[20:21], v[144:145] op_sel_hi:[1,0,1]
v_pk_fma_f32 v[146:147], v[42:43], v[20:21], v[146:147] op_sel_hi:[1,0,1]
v_pk_fma_f32 v[148:149], v[44:45], v[20:21], v[148:149] op_sel_hi:[1,0,1]
v_pk_fma_f32 v[150:151], v[46:47], v[20:21], v[150:151] op_sel_hi:[1,0,1]
v_pk_fma_f32 v[152:153], v[48:49], v[20:21], v[152:153] op_sel_hi:[1,0,1]
v_pk_fma_f32 v[154:155], v[50:51], v[20:21], v[154:155] op_sel_hi:[1,0,1]
v_pk_fma_f32 v[156:157], v[52:53], v[20:21], v[156:157] op_sel_hi:[1,0,1]
v_pk_fma_f32 v[158:159], v[54:55], v[20:21], v[158:159] op_sel_hi:[1,0,1]
v_pk_mul_f32 v[144:145], v[144:145], v[20:21] op_sel:[0,1] op_sel_hi:[1,1]
v_pk_mul_f32 v[146:147], v[146:147], v[20:21] op_sel:[0,1] op_sel_hi:[1,1]
v_pk_mul_f32 v[148:149], v[148:149], v[20:21] op_sel:[0,1] op_sel_hi:[1,1]
v_pk_mul_f32 v[150:151], v[150:151], v[20:21] op_sel:[0,1] op_sel_hi:[1,1]
v_pk_mul_f32 v[152:153], v[152:153], v[20:21] op_sel:[0,1] op_sel_hi:[1,1]
v_pk_mul_f32 v[154:155], v[154:155], v[20:21] op_sel:[0,1] op_sel_hi:[1,1]
v_pk_mul_f32 v[156:157], v[156:157], v[20:21] op_sel:[0,1] op_sel_hi:[1,1]
v_pk_mul_f32 v[158:159], v[158:159], v[20:21] op_sel:[0,1] op_sel_hi:[1,1]
v_pk_fma_f32 v[160:161], v[72:73], v[218:219], v[160:161] op_sel:[0,0,0] op_sel_hi:[1,0,1]
v_pk_fma_f32 v[162:163], v[74:75], v[218:219], v[162:163] op_sel:[0,0,0] op_sel_hi:[1,0,1]
v_pk_fma_f32 v[164:165], v[72:73], v[218:219], v[164:165] op_sel:[0,1,0] op_sel_hi:[1,1,1]
v_pk_fma_f32 v[166:167], v[74:75], v[218:219], v[166:167] op_sel:[0,1,0] op_sel_hi:[1,1,1]
v_pk_mul_f32 v[160:161], v[160:161], v[76:77]
v_pk_mul_f32 v[162:163], v[162:163], v[78:79]
v_pk_mul_f32 v[164:165], v[164:165], v[76:77]
v_pk_mul_f32 v[166:167], v[166:167], v[78:79]
v_pk_fma_f32 v[176:177], v[40:41], v[22:23], v[176:177] op_sel_hi:[1,0,1]
v_pk_fma_f32 v[178:179], v[42:43], v[22:23], v[178:179] op_sel_hi:[1,0,1]
v_pk_fma_f32 v[180:181], v[44:45], v[22:23], v[180:181] op_sel_hi:[1,0,1]
v_pk_fma_f32 v[182:183], v[46:47], v[22:23], v[182:183] op_sel_hi:[1,0,1]
v_pk_fma_f32 v[184:185], v[48:49], v[22:23], v[184:185] op_sel_hi:[1,0,1]
v_pk_fma_f32 v[186:187], v[50:51], v[22:23], v[186:187] op_sel_hi:[1,0,1]
v_pk_fma_f32 v[188:189], v[52:53], v[22:23], v[188:189] op_sel_hi:[1,0,1]
v_pk_fma_f32 v[190:191], v[54:55], v[22:23], v[190:191] op_sel_hi:[1,0,1]
v_pk_mul_f32 v[176:177], v[176:177], v[22:23] op_sel:[0,1] op_sel_hi:[1,1]
v_pk_mul_f32 v[178:179], v[178:179], v[22:23] op_sel:[0,1] op_sel_hi:[1,1]
v_pk_mul_f32 v[180:181], v[180:181], v[22:23] op_sel:[0,1] op_sel_hi:[1,1]
v_pk_mul_f32 v[182:183], v[182:183], v[22:23] op_sel:[0,1] op_sel_hi:[1,1]
v_pk_mul_f32 v[184:185], v[184:185], v[22:23] op_sel:[0,1] op_sel_hi:[1,1]
v_pk_mul_f32 v[186:187], v[186:187], v[22:23] op_sel:[0,1] op_sel_hi:[1,1]
v_pk_mul_f32 v[188:189], v[188:189], v[22:23] op_sel:[0,1] op_sel_hi:[1,1]
v_pk_mul_f32 v[190:191], v[190:191], v[22:23] op_sel:[0,1] op_sel_hi:[1,1]
v_pk_fma_f32 v[192:193], v[220:221], v[218:219], v[192:193] op_sel:[0,0,0] op_sel_hi:[1,0,1]
v_pk_fma_f32 v[194:195], v[222:223], v[218:219], v[194:195] op_sel:[0,0,0] op_sel_hi:[1,0,1]
v_pk_fma_f32 v[196:197], v[220:221], v[218:219], v[196:197] op_sel:[0,1,0] op_sel_hi:[1,1,1]
v_pk_fma_f32 v[198:199], v[222:223], v[218:219], v[198:199] op_sel:[0,1,0] op_sel_hi:[1,1,1]
v_pk_mul_f32 v[192:193], v[192:193], v[252:253]
v_pk_mul_f32 v[194:195], v[194:195], v[254:255]
v_pk_mul_f32 v[196:197], v[196:197], v[252:253]
v_pk_mul_f32 v[198:199], v[198:199], v[254:255]
v_pk_fma_f32 v[208:209], v[236:237], v[218:219], v[208:209] op_sel:[0,0,0] op_sel_hi:[1,0,1]
v_pk_fma_f32 v[210:211], v[238:239], v[218:219], v[210:211] op_sel:[0,0,0] op_sel_hi:[1,0,1]
v_pk_fma_f32 v[212:213], v[236:237], v[218:219], v[212:213] op_sel:[0,1,0] op_sel_hi:[1,1,1]
v_pk_fma_f32 v[214:215], v[238:239], v[218:219], v[214:215] op_sel:[0,1,0] op_sel_hi:[1,1,1]
v_pk_mul_f32 v[208:209], v[208:209], v[240:241]
v_pk_mul_f32 v[210:211], v[210:211], v[242:243]
v_pk_mul_f32 v[212:213], v[212:213], v[240:241]
v_pk_mul_f32 v[214:215], v[214:215], v[242:243]
v_cvt_pk_bf16_f32 v4, v208, v209
v_cvt_pk_bf16_f32 v5, v210, v211
v_cvt_pk_bf16_f32 v6, v212, v213
v_cvt_pk_bf16_f32 v7, v214, v215
ds_write_b128 v2, v[4:7] offset:2048
v_cvt_pk_bf16_f32 v56, v184, v185
v_cvt_pk_bf16_f32 v57, v186, v187
v_cvt_pk_bf16_f32 v58, v188, v189
v_cvt_pk_bf16_f32 v59, v190, v191
v_cvt_pk_bf16_f32 v24, v80, v81
v_cvt_pk_bf16_f32 v25, v82, v83
v_cvt_pk_bf16_f32 v26, v84, v85
v_cvt_pk_bf16_f32 v27, v86, v87
v_cvt_pk_bf16_f32 v44, v88, v89
v_cvt_pk_bf16_f32 v45, v90, v91
v_cvt_pk_bf16_f32 v46, v92, v93
v_cvt_pk_bf16_f32 v47, v94, v95
v_cvt_pk_bf16_f32 v62, v96, v97
v_cvt_pk_bf16_f32 v63, v98, v99
v_cvt_pk_bf16_f32 v72, v100, v101
v_cvt_pk_bf16_f32 v73, v102, v103
v_cvt_pk_bf16_f32 v28, v112, v113
v_cvt_pk_bf16_f32 v29, v114, v115
v_cvt_pk_bf16_f32 v30, v116, v117
v_cvt_pk_bf16_f32 v31, v118, v119
v_cvt_pk_bf16_f32 v48, v120, v121
v_cvt_pk_bf16_f32 v49, v122, v123
v_cvt_pk_bf16_f32 v50, v124, v125
v_cvt_pk_bf16_f32 v51, v126, v127
v_cvt_pk_bf16_f32 v64, v128, v129
v_cvt_pk_bf16_f32 v65, v130, v131
v_cvt_pk_bf16_f32 v74, v132, v133
v_cvt_pk_bf16_f32 v75, v134, v135
v_cvt_pk_bf16_f32 v32, v144, v145
v_cvt_pk_bf16_f32 v33, v146, v147
v_cvt_pk_bf16_f32 v34, v148, v149
v_cvt_pk_bf16_f32 v35, v150, v151
v_cvt_pk_bf16_f32 v52, v152, v153
v_cvt_pk_bf16_f32 v53, v154, v155
v_cvt_pk_bf16_f32 v54, v156, v157
v_cvt_pk_bf16_f32 v55, v158, v159
v_cvt_pk_bf16_f32 v66, v160, v161
v_cvt_pk_bf16_f32 v67, v162, v163
v_cvt_pk_bf16_f32 v76, v164, v165
v_cvt_pk_bf16_f32 v77, v166, v167
v_cvt_pk_bf16_f32 v36, v176, v177
v_cvt_pk_bf16_f32 v37, v178, v179
v_cvt_pk_bf16_f32 v38, v180, v181
v_cvt_pk_bf16_f32 v39, v182, v183
v_cvt_pk_bf16_f32 v68, v192, v193
v_cvt_pk_bf16_f32 v69, v194, v195
v_cvt_pk_bf16_f32 v78, v196, v197
v_cvt_pk_bf16_f32 v79, v198, v199
s_waitcnt lgkmcnt(0)
s_barrier
ds_read_b128 v[40:43], v2
ds_read_b64 v[60:61], v2 offset:1024
ds_read_b64 v[70:71], v2 offset:1032
v_mfma_f32_16x16x32_bf16 v[180:183], v[56:59], v[36:39], v[228:231]
v_mfma_f32_16x16x32_bf16 v[176:179], v[52:55], v[36:39], v[224:227]
v_mfma_f32_16x16x32_bf16 v[148:151], v[52:55], v[32:35], v[228:231]
v_mfma_f32_16x16x32_bf16 v[144:147], v[48:51], v[32:35], v[224:227]
v_mfma_f32_16x16x32_bf16 v[116:119], v[48:51], v[28:31], v[228:231]
v_mfma_f32_16x16x32_bf16 v[112:115], v[44:47], v[28:31], v[224:227]
v_mfma_f32_16x16x32_bf16 v[84:87], v[44:47], v[24:27], v[228:231]
s_waitcnt lgkmcnt(0)
v_mfma_f32_16x16x32_bf16 v[80:83], v[40:43], v[24:27], v[232:235]
s_nop 0
v_max3_f32 v184, v176, v177, v178
v_max3_f32 v185, v179, v180, v181
v_max3_f32 v152, v144, v145, v146
v_max3_f32 v153, v147, v148, v149
v_max3_f32 v120, v112, v113, v114
v_max3_f32 v121, v115, v116, v117
s_nop 0
v_max3_f32 v88, v80, v81, v82
v_max3_f32 v89, v83, v84, v85
v_max3_f32 v184, v184, v182, v183
v_max3_f32 v152, v152, v150, v151
v_max3_f32 v120, v120, v118, v119
v_max3_f32 v88, v88, v86, v87
v_max_f32 v184, v184, v185
v_max_f32 v152, v152, v153
v_max_f32 v120, v120, v121
v_max_f32 v88, v88, v89
v_mov_b32 v185, v184
v_mov_b32 v153, v152
v_mov_b32 v121, v120
v_mov_b32 v89, v88
v_permlane16_swap_b32 v184, v185
v_permlane16_swap_b32 v152, v153
v_permlane16_swap_b32 v120, v121
v_permlane16_swap_b32 v88, v89
v_max_f32 v184, v184, v185
v_max_f32 v152, v152, v153
v_max_f32 v120, v120, v121
v_max_f32 v88, v88, v89
v_mov_b32 v185, v184
v_mov_b32 v153, v152
v_mov_b32 v121, v120
v_mov_b32 v89, v88
v_permlane32_swap_b32 v184, v185
v_permlane32_swap_b32 v152, v153
v_permlane32_swap_b32 v120, v121
v_permlane32_swap_b32 v88, v89
v_max_f32 v184, v184, v185
v_max_f32 v152, v152, v153
v_max_f32 v120, v120, v121
v_max_f32 v88, v88, v89
s_mov_b32 s44, 0x3e8293ee
s_mov_b32 s45, 0x3e8293ee
v_mul_f32 v184, 0xbe8293ee, v184
v_mul_f32 v152, 0xbe8293ee, v152
v_mul_f32 v120, 0xbe8293ee, v120
v_mul_f32 v88, 0xbe8293ee, v88
v_pk_fma_f32 v[176:177], v[176:177], s[44:45], v[184:185] op_sel_hi:[1,1,0]
v_pk_fma_f32 v[178:179], v[178:179], s[44:45], v[184:185] op_sel_hi:[1,1,0]
v_pk_fma_f32 v[180:181], v[180:181], s[44:45], v[184:185] op_sel_hi:[1,1,0]
v_pk_fma_f32 v[182:183], v[182:183], s[44:45], v[184:185] op_sel_hi:[1,1,0]
v_pk_fma_f32 v[144:145], v[144:145], s[44:45], v[152:153] op_sel_hi:[1,1,0]
v_pk_fma_f32 v[146:147], v[146:147], s[44:45], v[152:153] op_sel_hi:[1,1,0]
v_pk_fma_f32 v[148:149], v[148:149], s[44:45], v[152:153] op_sel_hi:[1,1,0]
v_pk_fma_f32 v[150:151], v[150:151], s[44:45], v[152:153] op_sel_hi:[1,1,0]
v_pk_fma_f32 v[112:113], v[112:113], s[44:45], v[120:121] op_sel_hi:[1,1,0]
v_pk_fma_f32 v[114:115], v[114:115], s[44:45], v[120:121] op_sel_hi:[1,1,0]
v_pk_fma_f32 v[116:117], v[116:117], s[44:45], v[120:121] op_sel_hi:[1,1,0]
v_pk_fma_f32 v[118:119], v[118:119], s[44:45], v[120:121] op_sel_hi:[1,1,0]
v_pk_fma_f32 v[80:81], v[80:81], s[44:45], v[88:89] op_sel_hi:[1,1,0]
v_pk_fma_f32 v[82:83], v[82:83], s[44:45], v[88:89] op_sel_hi:[1,1,0]
v_pk_fma_f32 v[84:85], v[84:85], s[44:45], v[88:89] op_sel_hi:[1,1,0]
v_pk_fma_f32 v[86:87], v[86:87], s[44:45], v[88:89] op_sel_hi:[1,1,0]
v_exp_f32 v176, v176
v_exp_f32 v177, v177
v_exp_f32 v178, v178
v_exp_f32 v179, v179
v_exp_f32 v180, v180
v_exp_f32 v181, v181
v_exp_f32 v182, v182
v_exp_f32 v183, v183
v_exp_f32 v144, v144
v_exp_f32 v145, v145
v_exp_f32 v146, v146
v_exp_f32 v147, v147
v_exp_f32 v148, v148
v_exp_f32 v149, v149
v_exp_f32 v150, v150
v_exp_f32 v151, v151
v_exp_f32 v112, v112
v_exp_f32 v113, v113
v_exp_f32 v114, v114
v_exp_f32 v115, v115
v_exp_f32 v116, v116
v_exp_f32 v117, v117
v_exp_f32 v118, v118
v_exp_f32 v119, v119
v_exp_f32 v80, v80
v_exp_f32 v81, v81
v_exp_f32 v82, v82
v_exp_f32 v83, v83
v_exp_f32 v84, v84
v_exp_f32 v85, v85
v_exp_f32 v86, v86
v_exp_f32 v87, v87
s_waitcnt vmcnt(0)
s_barrier
v_pk_add_f32 v[184:185], v[176:177], v[178:179]
v_pk_add_f32 v[186:187], v[180:181], v[182:183]
v_pk_add_f32 v[152:153], v[144:145], v[146:147]
v_pk_add_f32 v[154:155], v[148:149], v[150:151]
v_pk_add_f32 v[120:121], v[112:113], v[114:115]
v_pk_add_f32 v[122:123], v[116:117], v[118:119]
v_pk_add_f32 v[88:89], v[80:81], v[82:83]
v_pk_add_f32 v[90:91], v[84:85], v[86:87]
v_pk_add_f32 v[184:185], v[184:185], v[186:187]
v_pk_add_f32 v[152:153], v[152:153], v[154:155]
v_pk_add_f32 v[120:121], v[120:121], v[122:123]
v_pk_add_f32 v[88:89], v[88:89], v[90:91]
v_add_f32 v184, v184, v185
v_add_f32 v152, v152, v153
v_add_f32 v120, v120, v121
v_add_f32 v88, v88, v89
v_mov_b32 v185, v184
v_mov_b32 v153, v152
v_mov_b32 v121, v120
v_mov_b32 v89, v88
v_permlane16_swap_b32 v184, v185
v_permlane16_swap_b32 v152, v153
v_permlane16_swap_b32 v120, v121
v_permlane16_swap_b32 v88, v89
v_add_f32 v184, v184, v185
v_add_f32 v152, v152, v153
v_add_f32 v120, v120, v121
v_add_f32 v88, v88, v89
v_mov_b32 v185, v184
v_mov_b32 v153, v152
v_mov_b32 v121, v120
v_mov_b32 v89, v88
v_permlane32_swap_b32 v184, v185
v_permlane32_swap_b32 v152, v153
v_permlane32_swap_b32 v120, v121
v_permlane32_swap_b32 v88, v89
v_add_f32 v184, v184, v185
v_add_f32 v152, v152, v153
v_add_f32 v120, v120, v121
v_add_f32 v88, v88, v89
v_rcp_f32 v184, v184
v_rcp_f32 v152, v152
v_rcp_f32 v120, v120
v_rcp_f32 v88, v88
v_pk_mul_f32 v[176:177], v[176:177], v[184:185] op_sel_hi:[1,0]
v_pk_mul_f32 v[178:179], v[178:179], v[184:185] op_sel_hi:[1,0]
v_pk_mul_f32 v[180:181], v[180:181], v[184:185] op_sel_hi:[1,0]
v_pk_mul_f32 v[182:183], v[182:183], v[184:185] op_sel_hi:[1,0]
v_pk_mul_f32 v[144:145], v[144:145], v[152:153] op_sel_hi:[1,0]
v_pk_mul_f32 v[146:147], v[146:147], v[152:153] op_sel_hi:[1,0]
v_pk_mul_f32 v[148:149], v[148:149], v[152:153] op_sel_hi:[1,0]
v_pk_mul_f32 v[150:151], v[150:151], v[152:153] op_sel_hi:[1,0]
v_pk_mul_f32 v[112:113], v[112:113], v[120:121] op_sel_hi:[1,0]
v_pk_mul_f32 v[114:115], v[114:115], v[120:121] op_sel_hi:[1,0]
v_pk_mul_f32 v[116:117], v[116:117], v[120:121] op_sel_hi:[1,0]
v_pk_mul_f32 v[118:119], v[118:119], v[120:121] op_sel_hi:[1,0]
v_pk_mul_f32 v[80:81], v[80:81], v[88:89] op_sel_hi:[1,0]
v_pk_mul_f32 v[82:83], v[82:83], v[88:89] op_sel_hi:[1,0]
v_pk_mul_f32 v[84:85], v[84:85], v[88:89] op_sel_hi:[1,0]
v_pk_mul_f32 v[86:87], v[86:87], v[88:89] op_sel_hi:[1,0]
v_cvt_pk_bf16_f32 v36, v176, v177
v_cvt_pk_bf16_f32 v37, v178, v179
v_cvt_pk_bf16_f32 v38, v180, v181
v_cvt_pk_bf16_f32 v39, v182, v183
v_cvt_pk_bf16_f32 v32, v144, v145
v_cvt_pk_bf16_f32 v33, v146, v147
v_cvt_pk_bf16_f32 v34, v148, v149
v_cvt_pk_bf16_f32 v35, v150, v151
v_cvt_pk_bf16_f32 v28, v112, v113
v_cvt_pk_bf16_f32 v29, v114, v115
v_cvt_pk_bf16_f32 v30, v116, v117
v_cvt_pk_bf16_f32 v31, v118, v119
v_cvt_pk_bf16_f32 v24, v80, v81
v_cvt_pk_bf16_f32 v25, v82, v83
v_cvt_pk_bf16_f32 v26, v84, v85
v_cvt_pk_bf16_f32 v27, v86, v87
v_mfma_f32_16x16x32_bf16 v[176:179], v[66:69], v[36:39], 0
v_mfma_f32_16x16x32_bf16 v[180:183], v[76:79], v[36:39], 0
v_mfma_f32_16x16x32_bf16 v[144:147], v[64:67], v[32:35], 0
v_mfma_f32_16x16x32_bf16 v[148:151], v[74:77], v[32:35], 0
v_mfma_f32_16x16x32_bf16 v[112:115], v[62:65], v[28:31], 0
v_mfma_f32_16x16x32_bf16 v[116:119], v[72:75], v[28:31], 0
v_mfma_f32_16x16x32_bf16 v[80:83], v[60:63], v[24:27], 0
v_mfma_f32_16x16x32_bf16 v[84:87], v[70:73], v[24:27], 0
s_nop 0
v_cvt_pk_bf16_f32 v36, v176, v177
v_cvt_pk_bf16_f32 v37, v178, v179
v_cvt_pk_bf16_f32 v38, v180, v181
v_cvt_pk_bf16_f32 v39, v182, v183
buffer_store_dwordx4 v[36:39], v12, s[4:7], s46 offen offset:3072 sc1
v_cvt_pk_bf16_f32 v32, v144, v145
v_cvt_pk_bf16_f32 v33, v146, v147
v_cvt_pk_bf16_f32 v34, v148, v149
v_cvt_pk_bf16_f32 v35, v150, v151
buffer_store_dwordx4 v[32:35], v12, s[4:7], s46 offen offset:2048 sc1
v_cvt_pk_bf16_f32 v28, v112, v113
v_cvt_pk_bf16_f32 v29, v114, v115
v_cvt_pk_bf16_f32 v30, v116, v117
v_cvt_pk_bf16_f32 v31, v118, v119
buffer_store_dwordx4 v[28:31], v12, s[4:7], s46 offen offset:1024 sc1
v_cvt_pk_bf16_f32 v24, v80, v81
v_cvt_pk_bf16_f32 v25, v82, v83
v_cvt_pk_bf16_f32 v26, v84, v85
v_cvt_pk_bf16_f32 v27, v86, v87
buffer_store_dwordx4 v[24:27], v12, s[4:7], s46 offen offset:0 sc1
P2:
s_lshl_b32 s21, s16, 1
v_lshrrev_b32 v2, 2, v0
v_lshlrev_b32 v3, 7, v2
v_and_b32 v4, 3, v0
v_lshl_add_u32 v3, v4, 3, v3
v_bfe_u32 v2, v0, 3, 2
s_and_b32 s19, 0, 3
v_xor_b32 v4, s19, v2
v_lshl_add_u32 v4, v4, 5, v3
s_lshr_b32 s19, 0, 2
s_mul_i32 s19, s19, 8192
v_add_u32 v16, s19, v4
s_and_b32 s19, 1, 3
v_xor_b32 v4, s19, v2
v_lshl_add_u32 v4, v4, 5, v3
s_lshr_b32 s19, 1, 2
s_mul_i32 s19, s19, 8192
v_add_u32 v17, s19, v4
s_and_b32 s19, 2, 3
v_xor_b32 v4, s19, v2
v_lshl_add_u32 v4, v4, 5, v3
s_lshr_b32 s19, 2, 2
s_mul_i32 s19, s19, 8192
v_add_u32 v18, s19, v4
s_and_b32 s19, 3, 3
v_xor_b32 v4, s19, v2
v_lshl_add_u32 v4, v4, 5, v3
s_lshr_b32 s19, 3, 2
s_mul_i32 s19, s19, 8192
v_add_u32 v19, s19, v4
s_lshl_b32 s19, s21, 10
s_add_u32 s19, s19, 8192
v_lshl_add_u32 v6, v0, 4, s19
s_lshl_b32 s37, s17, 7
s_lshl_b32 s19, s16, 5
s_add_u32 s37, s37, s19
s_lshl_b32 s39, s18, 18
s_lshl_b32 s19, s37, 6
s_add_u32 s39, s39, s19
s_add_u32 s36, s39, 131072
v_and_b32 v13, 15, v0
v_lshlrev_b32 v13, 11, v13
v_bfe_u32 v1, v0, 4, 1
v_lshl_add_u32 v13, v1, 5, v13
v_lshrrev_b32 v1, 5, v0
v_lshl_add_u32 v13, v1, 4, v13
s_lshl_b32 s48, s37, 11
s_lshl_b32 s19, s18, 7
s_add_u32 s48, s48, s19
s_add_u32 s49, s48, 32768
v_and_b32 v4, 15, v0
s_lshl_b32 s19, s16, 7
s_add_u32 s19, s19, 160768
v_lshl_add_u32 v4, v4, 2, s19
ds_read2_b32 v[8:9], v4 offset0:160 offset1:16
ds_read2_b32 v[10:11], v4 offset0:176 offset1:32
s_mov_b32 s8, s64
s_mov_b32 s9, s65
s_mov_b32 s10, 4194304
s_mov_b32 s11, 0x20000
v_mov_b32 v188, 0
v_mov_b32 v189, 0
v_mov_b32 v190, 0
v_mov_b32 v191, 0
v_mov_b32 v192, 0
v_mov_b32 v193, 0
v_mov_b32 v194, 0
v_mov_b32 v195, 0
v_mov_b32 v196, 0
v_mov_b32 v197, 0
v_mov_b32 v198, 0
v_mov_b32 v199, 0
v_mov_b32 v200, 0
v_mov_b32 v201, 0
v_mov_b32 v202, 0
v_mov_b32 v203, 0
v_mov_b32 v204, 0
v_mov_b32 v205, 0
v_mov_b32 v206, 0
v_mov_b32 v207, 0
v_mov_b32 v208, 0
v_mov_b32 v209, 0
v_mov_b32 v210, 0
v_mov_b32 v211, 0
v_mov_b32 v212, 0
v_mov_b32 v213, 0
v_mov_b32 v214, 0
v_mov_b32 v215, 0
v_mov_b32 v216, 0
v_mov_b32 v217, 0
v_mov_b32 v218, 0
v_mov_b32 v219, 0
s_waitcnt vmcnt(0)
s_waitcnt lgkmcnt(0)
s_barrier
v_add_u32 v7, s20, v6
ds_read_b128 v[60:63], v7 offset:0
v_add_u32 v20, s20, v16
ds_read_b64_tr_b16 v[44:45], v20 offset:0
ds_read_b64_tr_b16 v[46:47], v20 offset:2048
ds_read_b128 v[64:67], v7 offset:1024
v_add_u32 v21, s20, v17
ds_read_b64_tr_b16 v[48:49], v21 offset:0
ds_read_b64_tr_b16 v[50:51], v21 offset:2048
v_add_u32 v22, s20, v18
ds_read_b64_tr_b16 v[52:53], v22 offset:0
ds_read_b64_tr_b16 v[54:55], v22 offset:2048
buffer_load_dwordx4 v[236:239], v13, s[8:11], s48 offen offset:0
buffer_load_dwordx4 v[240:243], v13, s[8:11], s48 offen offset:64
buffer_load_dwordx4 v[244:247], v13, s[8:11], s49 offen offset:0
buffer_load_dwordx4 v[248:251], v13, s[8:11], s49 offen offset:64
s_mov_b32 s24, 7
.p2align 3
CL_p2a_0:
s_waitcnt lgkmcnt(5)
v_mfma_f32_16x16x32_bf16 v[188:191], v[44:47], v[60:63], v[188:191]
v_add_u32 v23, s20, v19
s_waitcnt lgkmcnt(4)
v_mfma_f32_16x16x32_bf16 v[204:207], v[44:47], v[64:67], v[204:207]
ds_read_b64_tr_b16 v[56:57], v23 offset:0
ds_read_b64_tr_b16 v[58:59], v23 offset:2048
s_waitcnt lgkmcnt(4)
v_mfma_f32_16x16x32_bf16 v[192:195], v[48:51], v[60:63], v[192:195]
ds_read_b128 v[68:71], v7 offset:8192
v_mfma_f32_16x16x32_bf16 v[208:211], v[48:51], v[64:67], v[208:211]
ds_read_b64_tr_b16 v[44:45], v20 offset:4096
ds_read_b64_tr_b16 v[46:47], v20 offset:6144
s_waitcnt lgkmcnt(5)
v_mfma_f32_16x16x32_bf16 v[196:199], v[52:55], v[60:63], v[196:199]
ds_read_b128 v[72:75], v7 offset:9216
v_mfma_f32_16x16x32_bf16 v[212:215], v[52:55], v[64:67], v[212:215]
ds_read_b64_tr_b16 v[48:49], v21 offset:4096
ds_read_b64_tr_b16 v[50:51], v21 offset:6144
s_waitcnt lgkmcnt(6)
v_mfma_f32_16x16x32_bf16 v[200:203], v[56:59], v[60:63], v[200:203]
ds_read_b64_tr_b16 v[52:53], v22 offset:4096
v_mfma_f32_16x16x32_bf16 v[216:219], v[56:59], v[64:67], v[216:219]
ds_read_b64_tr_b16 v[54:55], v22 offset:6144
s_waitcnt lgkmcnt(5)
v_mfma_f32_16x16x32_bf16 v[188:191], v[44:47], v[68:71], v[188:191]
ds_read_b64_tr_b16 v[56:57], v23 offset:4096
ds_read_b64_tr_b16 v[58:59], v23 offset:6144
s_waitcnt lgkmcnt(6)
v_mfma_f32_16x16x32_bf16 v[204:207], v[44:47], v[72:75], v[204:207]
s_add_u32 s20, s20, 25600
s_cmp_ge_u32 s20, 143360
s_cselect_b32 s20, 0, s20
s_waitcnt lgkmcnt(4)
v_mfma_f32_16x16x32_bf16 v[192:195], v[48:51], v[68:71], v[192:195]
s_waitcnt lgkmcnt(0)
s_barrier
v_add_u32 v7, s20, v6
v_mfma_f32_16x16x32_bf16 v[208:211], v[48:51], v[72:75], v[208:211]
ds_read_b128 v[60:63], v7 offset:0
v_add_u32 v20, s20, v16
ds_read_b64_tr_b16 v[44:45], v20 offset:0
ds_read_b64_tr_b16 v[46:47], v20 offset:2048
s_waitcnt lgkmcnt(5)
v_mfma_f32_16x16x32_bf16 v[196:199], v[52:55], v[68:71], v[196:199]
ds_read_b128 v[64:67], v7 offset:1024
v_add_u32 v21, s20, v17
v_mfma_f32_16x16x32_bf16 v[212:215], v[52:55], v[72:75], v[212:215]
ds_read_b64_tr_b16 v[48:49], v21 offset:0
ds_read_b64_tr_b16 v[50:51], v21 offset:2048
s_waitcnt lgkmcnt(6)
v_mfma_f32_16x16x32_bf16 v[200:203], v[56:59], v[68:71], v[200:203]
v_add_u32 v22, s20, v18
v_mfma_f32_16x16x32_bf16 v[216:219], v[56:59], v[72:75], v[216:219]
ds_read_b64_tr_b16 v[52:53], v22 offset:0
ds_read_b64_tr_b16 v[54:55], v22 offset:2048
s_waitcnt lgkmcnt(5)
v_mfma_f32_16x16x32_bf16 v[188:191], v[44:47], v[60:63], v[188:191]
v_add_u32 v23, s20, v19
s_waitcnt lgkmcnt(4)
v_mfma_f32_16x16x32_bf16 v[204:207], v[44:47], v[64:67], v[204:207]
ds_read_b64_tr_b16 v[56:57], v23 offset:0
ds_read_b64_tr_b16 v[58:59], v23 offset:2048
s_waitcnt lgkmcnt(4)
v_mfma_f32_16x16x32_bf16 v[192:195], v[48:51], v[60:63], v[192:195]
ds_read_b128 v[68:71], v7 offset:8192
v_mfma_f32_16x16x32_bf16 v[208:211], v[48:51], v[64:67], v[208:211]
ds_read_b64_tr_b16 v[44:45], v20 offset:4096
ds_read_b64_tr_b16 v[46:47], v20 offset:6144
s_waitcnt lgkmcnt(5)
v_mfma_f32_16x16x32_bf16 v[196:199], v[52:55], v[60:63], v[196:199]
ds_read_b128 v[72:75], v7 offset:9216
v_mfma_f32_16x16x32_bf16 v[212:215], v[52:55], v[64:67], v[212:215]
ds_read_b64_tr_b16 v[48:49], v21 offset:4096
ds_read_b64_tr_b16 v[50:51], v21 offset:6144
s_waitcnt lgkmcnt(6)
v_mfma_f32_16x16x32_bf16 v[200:203], v[56:59], v[60:63], v[200:203]
ds_read_b64_tr_b16 v[52:53], v22 offset:4096
v_mfma_f32_16x16x32_bf16 v[216:219], v[56:59], v[64:67], v[216:219]
ds_read_b64_tr_b16 v[54:55], v22 offset:6144
s_waitcnt lgkmcnt(5)
v_mfma_f32_16x16x32_bf16 v[188:191], v[44:47], v[68:71], v[188:191]
ds_read_b64_tr_b16 v[56:57], v23 offset:4096
ds_read_b64_tr_b16 v[58:59], v23 offset:6144
s_waitcnt lgkmcnt(6)
v_mfma_f32_16x16x32_bf16 v[204:207], v[44:47], v[72:75], v[204:207]
s_add_u32 s20, s20, 25600
s_cmp_ge_u32 s20, 143360
s_cselect_b32 s20, 0, s20
s_waitcnt lgkmcnt(4)
v_mfma_f32_16x16x32_bf16 v[192:195], v[48:51], v[68:71], v[192:195]
s_waitcnt lgkmcnt(0)
s_barrier
v_add_u32 v7, s20, v6
v_mfma_f32_16x16x32_bf16 v[208:211], v[48:51], v[72:75], v[208:211]
ds_read_b128 v[60:63], v7 offset:0
v_add_u32 v20, s20, v16
ds_read_b64_tr_b16 v[44:45], v20 offset:0
ds_read_b64_tr_b16 v[46:47], v20 offset:2048
s_waitcnt lgkmcnt(5)
v_mfma_f32_16x16x32_bf16 v[196:199], v[52:55], v[68:71], v[196:199]
ds_read_b128 v[64:67], v7 offset:1024
v_add_u32 v21, s20, v17
v_mfma_f32_16x16x32_bf16 v[212:215], v[52:55], v[72:75], v[212:215]
ds_read_b64_tr_b16 v[48:49], v21 offset:0
ds_read_b64_tr_b16 v[50:51], v21 offset:2048
s_waitcnt lgkmcnt(6)
v_mfma_f32_16x16x32_bf16 v[200:203], v[56:59], v[68:71], v[200:203]
v_add_u32 v22, s20, v18
ds_read_b64_tr_b16 v[52:53], v22 offset:0
v_mfma_f32_16x16x32_bf16 v[216:219], v[56:59], v[72:75], v[216:219]
ds_read_b64_tr_b16 v[54:55], v22 offset:2048
s_sub_u32 s24, s24, 1
s_cmp_lg_u32 s24, 0
s_cbranch_scc1 CL_p2a_0
s_waitcnt lgkmcnt(5)
v_mfma_f32_16x16x32_bf16 v[188:191], v[44:47], v[60:63], v[188:191]
v_add_u32 v23, s20, v19
s_waitcnt lgkmcnt(4)
v_mfma_f32_16x16x32_bf16 v[204:207], v[44:47], v[64:67], v[204:207]
ds_read_b64_tr_b16 v[56:57], v23 offset:0
ds_read_b64_tr_b16 v[58:59], v23 offset:2048
s_waitcnt lgkmcnt(4)
v_mfma_f32_16x16x32_bf16 v[192:195], v[48:51], v[60:63], v[192:195]
ds_read_b128 v[68:71], v7 offset:8192
v_mfma_f32_16x16x32_bf16 v[208:211], v[48:51], v[64:67], v[208:211]
ds_read_b64_tr_b16 v[44:45], v20 offset:4096
ds_read_b64_tr_b16 v[46:47], v20 offset:6144
s_waitcnt lgkmcnt(5)
v_mfma_f32_16x16x32_bf16 v[196:199], v[52:55], v[60:63], v[196:199]
ds_read_b128 v[72:75], v7 offset:9216
v_mfma_f32_16x16x32_bf16 v[212:215], v[52:55], v[64:67], v[212:215]
ds_read_b64_tr_b16 v[48:49], v21 offset:4096
ds_read_b64_tr_b16 v[50:51], v21 offset:6144
s_waitcnt lgkmcnt(6)
v_mfma_f32_16x16x32_bf16 v[200:203], v[56:59], v[60:63], v[200:203]
ds_read_b64_tr_b16 v[52:53], v22 offset:4096
v_mfma_f32_16x16x32_bf16 v[216:219], v[56:59], v[64:67], v[216:219]
ds_read_b64_tr_b16 v[54:55], v22 offset:6144
s_waitcnt lgkmcnt(5)
v_mfma_f32_16x16x32_bf16 v[188:191], v[44:47], v[68:71], v[188:191]
ds_read_b64_tr_b16 v[56:57], v23 offset:4096
ds_read_b64_tr_b16 v[58:59], v23 offset:6144
s_waitcnt lgkmcnt(6)
v_mfma_f32_16x16x32_bf16 v[204:207], v[44:47], v[72:75], v[204:207]
s_add_u32 s20, s20, 25600
s_cmp_ge_u32 s20, 143360
s_cselect_b32 s20, 0, s20
s_waitcnt lgkmcnt(4)
v_mfma_f32_16x16x32_bf16 v[192:195], v[48:51], v[68:71], v[192:195]
s_waitcnt lgkmcnt(0)
s_barrier
v_add_u32 v7, s20, v6
v_mfma_f32_16x16x32_bf16 v[208:211], v[48:51], v[72:75], v[208:211]
ds_read_b128 v[60:63], v7 offset:0
v_add_u32 v20, s20, v16
ds_read_b64_tr_b16 v[44:45], v20 offset:0
ds_read_b64_tr_b16 v[46:47], v20 offset:2048
s_waitcnt lgkmcnt(5)
v_mfma_f32_16x16x32_bf16 v[196:199], v[52:55], v[68:71], v[196:199]
ds_read_b128 v[64:67], v7 offset:1024
v_add_u32 v21, s20, v17
v_mfma_f32_16x16x32_bf16 v[212:215], v[52:55], v[72:75], v[212:215]
ds_read_b64_tr_b16 v[48:49], v21 offset:0
ds_read_b64_tr_b16 v[50:51], v21 offset:2048
s_waitcnt lgkmcnt(6)
v_mfma_f32_16x16x32_bf16 v[200:203], v[56:59], v[68:71], v[200:203]
v_add_u32 v22, s20, v18
v_mfma_f32_16x16x32_bf16 v[216:219], v[56:59], v[72:75], v[216:219]
ds_read_b64_tr_b16 v[52:53], v22 offset:0
ds_read_b64_tr_b16 v[54:55], v22 offset:2048
s_waitcnt lgkmcnt(5)
v_mfma_f32_16x16x32_bf16 v[188:191], v[44:47], v[60:63], v[188:191]
v_add_u32 v23, s20, v19
s_waitcnt lgkmcnt(4)
v_mfma_f32_16x16x32_bf16 v[204:207], v[44:47], v[64:67], v[204:207]
ds_read_b64_tr_b16 v[56:57], v23 offset:0
ds_read_b64_tr_b16 v[58:59], v23 offset:2048
s_waitcnt lgkmcnt(4)
v_mfma_f32_16x16x32_bf16 v[192:195], v[48:51], v[60:63], v[192:195]
ds_read_b128 v[68:71], v7 offset:8192
v_mfma_f32_16x16x32_bf16 v[208:211], v[48:51], v[64:67], v[208:211]
ds_read_b64_tr_b16 v[44:45], v20 offset:4096
ds_read_b64_tr_b16 v[46:47], v20 offset:6144
s_waitcnt lgkmcnt(5)
v_mfma_f32_16x16x32_bf16 v[196:199], v[52:55], v[60:63], v[196:199]
ds_read_b128 v[72:75], v7 offset:9216
v_mfma_f32_16x16x32_bf16 v[212:215], v[52:55], v[64:67], v[212:215]
ds_read_b64_tr_b16 v[48:49], v21 offset:4096
ds_read_b64_tr_b16 v[50:51], v21 offset:6144
s_waitcnt lgkmcnt(6)
v_mfma_f32_16x16x32_bf16 v[200:203], v[56:59], v[60:63], v[200:203]
ds_read_b64_tr_b16 v[52:53], v22 offset:4096
v_mfma_f32_16x16x32_bf16 v[216:219], v[56:59], v[64:67], v[216:219]
ds_read_b64_tr_b16 v[54:55], v22 offset:6144
s_waitcnt lgkmcnt(5)
v_mfma_f32_16x16x32_bf16 v[188:191], v[44:47], v[68:71], v[188:191]
ds_read_b64_tr_b16 v[56:57], v23 offset:4096
ds_read_b64_tr_b16 v[58:59], v23 offset:6144
s_waitcnt lgkmcnt(6)
v_mfma_f32_16x16x32_bf16 v[204:207], v[44:47], v[72:75], v[204:207]
s_add_u32 s20, s20, 25600
s_cmp_ge_u32 s20, 143360
s_cselect_b32 s20, 0, s20
s_waitcnt lgkmcnt(4)
v_mfma_f32_16x16x32_bf16 v[192:195], v[48:51], v[68:71], v[192:195]
v_mfma_f32_16x16x32_bf16 v[208:211], v[48:51], v[72:75], v[208:211]
s_waitcnt lgkmcnt(2)
v_mfma_f32_16x16x32_bf16 v[196:199], v[52:55], v[68:71], v[196:199]
v_mfma_f32_16x16x32_bf16 v[212:215], v[52:55], v[72:75], v[212:215]
s_waitcnt lgkmcnt(0)
v_mfma_f32_16x16x32_bf16 v[200:203], v[56:59], v[68:71], v[200:203]
v_mfma_f32_16x16x32_bf16 v[216:219], v[56:59], v[72:75], v[216:219]
s_waitcnt vmcnt(0)
s_add_u32 s39, s39, 12582912
s_add_u32 s36, s36, 12582912
v_permlane16_swap_b32 v236, v238
v_permlane16_swap_b32 v237, v239
v_and_b32 v77, 0xffff0000, v236
v_lshlrev_b32 v76, 16, v236
v_and_b32 v79, 0xffff0000, v237
v_lshlrev_b32 v78, 16, v237
v_and_b32 v81, 0xffff0000, v238
v_lshlrev_b32 v80, 16, v238
v_and_b32 v83, 0xffff0000, v239
v_lshlrev_b32 v82, 16, v239
v_pk_add_f32 v[28:29], v[76:77], v[8:9] op_sel_hi:[1,0]
v_pk_add_f32 v[30:31], v[78:79], v[8:9] op_sel_hi:[1,0]
v_pk_add_f32 v[32:33], v[80:81], v[8:9] op_sel_hi:[1,0]
v_pk_add_f32 v[34:35], v[82:83], v[8:9] op_sel_hi:[1,0]
v_pk_fma_f32 v[188:189], v[28:29], v[8:9], v[188:189] op_sel:[0,1,0] op_sel_hi:[1,1,1]
v_pk_fma_f32 v[190:191], v[30:31], v[8:9], v[190:191] op_sel:[0,1,0] op_sel_hi:[1,1,1]
v_pk_fma_f32 v[192:193], v[32:33], v[8:9], v[192:193] op_sel:[0,1,0] op_sel_hi:[1,1,1]
v_pk_fma_f32 v[194:195], v[34:35], v[8:9], v[194:195] op_sel:[0,1,0] op_sel_hi:[1,1,1]
v_cvt_pk_bf16_f32 v220, v188, v189
v_cvt_pk_bf16_f32 v221, v190, v191
v_cvt_pk_bf16_f32 v222, v192, v193
v_cvt_pk_bf16_f32 v223, v194, v195
buffer_store_dwordx4 v[220:223], v12, s[4:7], s39 offen offset:0 sc1
v_permlane16_swap_b32 v240, v242
v_permlane16_swap_b32 v241, v243
v_and_b32 v85, 0xffff0000, v240
v_lshlrev_b32 v84, 16, v240
v_and_b32 v87, 0xffff0000, v241
v_lshlrev_b32 v86, 16, v241
v_and_b32 v89, 0xffff0000, v242
v_lshlrev_b32 v88, 16, v242
v_and_b32 v91, 0xffff0000, v243
v_lshlrev_b32 v90, 16, v243
v_pk_add_f32 v[28:29], v[84:85], v[8:9] op_sel_hi:[1,0]
v_pk_add_f32 v[30:31], v[86:87], v[8:9] op_sel_hi:[1,0]
v_pk_add_f32 v[32:33], v[88:89], v[8:9] op_sel_hi:[1,0]
v_pk_add_f32 v[34:35], v[90:91], v[8:9] op_sel_hi:[1,0]
v_pk_fma_f32 v[196:197], v[28:29], v[8:9], v[196:197] op_sel:[0,1,0] op_sel_hi:[1,1,1]
v_pk_fma_f32 v[198:199], v[30:31], v[8:9], v[198:199] op_sel:[0,1,0] op_sel_hi:[1,1,1]
v_pk_fma_f32 v[200:201], v[32:33], v[8:9], v[200:201] op_sel:[0,1,0] op_sel_hi:[1,1,1]
v_pk_fma_f32 v[202:203], v[34:35], v[8:9], v[202:203] op_sel:[0,1,0] op_sel_hi:[1,1,1]
v_cvt_pk_bf16_f32 v224, v196, v197
v_cvt_pk_bf16_f32 v225, v198, v199
v_cvt_pk_bf16_f32 v226, v200, v201
v_cvt_pk_bf16_f32 v227, v202, v203
buffer_store_dwordx4 v[224:227], v12, s[4:7], s36 offen offset:0 sc1
v_permlane16_swap_b32 v244, v246
v_permlane16_swap_b32 v245, v247
v_and_b32 v93, 0xffff0000, v244
v_lshlrev_b32 v92, 16, v244
v_and_b32 v95, 0xffff0000, v245
v_lshlrev_b32 v94, 16, v245
v_and_b32 v97, 0xffff0000, v246
v_lshlrev_b32 v96, 16, v246
v_and_b32 v99, 0xffff0000, v247
v_lshlrev_b32 v98, 16, v247
v_pk_add_f32 v[28:29], v[92:93], v[10:11] op_sel_hi:[1,0]
v_pk_add_f32 v[30:31], v[94:95], v[10:11] op_sel_hi:[1,0]
v_pk_add_f32 v[32:33], v[96:97], v[10:11] op_sel_hi:[1,0]
v_pk_add_f32 v[34:35], v[98:99], v[10:11] op_sel_hi:[1,0]
v_pk_fma_f32 v[204:205], v[28:29], v[10:11], v[204:205] op_sel:[0,1,0] op_sel_hi:[1,1,1]
v_pk_fma_f32 v[206:207], v[30:31], v[10:11], v[206:207] op_sel:[0,1,0] op_sel_hi:[1,1,1]
v_pk_fma_f32 v[208:209], v[32:33], v[10:11], v[208:209] op_sel:[0,1,0] op_sel_hi:[1,1,1]
v_pk_fma_f32 v[210:211], v[34:35], v[10:11], v[210:211] op_sel:[0,1,0] op_sel_hi:[1,1,1]
v_cvt_pk_bf16_f32 v228, v204, v205
v_cvt_pk_bf16_f32 v229, v206, v207
v_cvt_pk_bf16_f32 v230, v208, v209
v_cvt_pk_bf16_f32 v231, v210, v211
buffer_store_dwordx4 v[228:231], v12, s[4:7], s39 offen offset:1024 sc1
v_permlane16_swap_b32 v248, v250
v_permlane16_swap_b32 v249, v251
v_and_b32 v101, 0xffff0000, v248
v_lshlrev_b32 v100, 16, v248
v_and_b32 v103, 0xffff0000, v249
v_lshlrev_b32 v102, 16, v249
v_and_b32 v105, 0xffff0000, v250
v_lshlrev_b32 v104, 16, v250
v_and_b32 v107, 0xffff0000, v251
v_lshlrev_b32 v106, 16, v251
v_pk_add_f32 v[28:29], v[100:101], v[10:11] op_sel_hi:[1,0]
v_pk_add_f32 v[30:31], v[102:103], v[10:11] op_sel_hi:[1,0]
v_pk_add_f32 v[32:33], v[104:105], v[10:11] op_sel_hi:[1,0]
v_pk_add_f32 v[34:35], v[106:107], v[10:11] op_sel_hi:[1,0]
v_pk_fma_f32 v[212:213], v[28:29], v[10:11], v[212:213] op_sel:[0,1,0] op_sel_hi:[1,1,1]
v_pk_fma_f32 v[214:215], v[30:31], v[10:11], v[214:215] op_sel:[0,1,0] op_sel_hi:[1,1,1]
v_pk_fma_f32 v[216:217], v[32:33], v[10:11], v[216:217] op_sel:[0,1,0] op_sel_hi:[1,1,1]
v_pk_fma_f32 v[218:219], v[34:35], v[10:11], v[218:219] op_sel:[0,1,0] op_sel_hi:[1,1,1]
v_cvt_pk_bf16_f32 v232, v212, v213
v_cvt_pk_bf16_f32 v233, v214, v215
v_cvt_pk_bf16_f32 v234, v216, v217
v_cvt_pk_bf16_f32 v235, v218, v219
buffer_store_dwordx4 v[232:235], v12, s[4:7], s36 offen offset:1024 sc1
v_pk_add_f32 v[28:29], v[188:189], v[190:191]
v_pk_mul_f32 v[30:31], v[188:189], v[188:189]
v_pk_add_f32 v[32:33], v[204:205], v[206:207]
v_pk_mul_f32 v[34:35], v[204:205], v[204:205]
v_pk_fma_f32 v[30:31], v[190:191], v[190:191], v[30:31]
v_pk_fma_f32 v[34:35], v[206:207], v[206:207], v[34:35]
v_pk_add_f32 v[28:29], v[28:29], v[192:193]
v_pk_fma_f32 v[30:31], v[192:193], v[192:193], v[30:31]
v_pk_add_f32 v[32:33], v[32:33], v[208:209]
v_pk_fma_f32 v[34:35], v[208:209], v[208:209], v[34:35]
v_pk_add_f32 v[28:29], v[28:29], v[194:195]
v_pk_fma_f32 v[30:31], v[194:195], v[194:195], v[30:31]
v_pk_add_f32 v[32:33], v[32:33], v[210:211]
v_pk_fma_f32 v[34:35], v[210:211], v[210:211], v[34:35]
v_pk_add_f32 v[28:29], v[28:29], v[196:197]
v_pk_fma_f32 v[30:31], v[196:197], v[196:197], v[30:31]
v_pk_add_f32 v[32:33], v[32:33], v[212:213]
v_pk_fma_f32 v[34:35], v[212:213], v[212:213], v[34:35]
v_pk_add_f32 v[28:29], v[28:29], v[198:199]
v_pk_fma_f32 v[30:31], v[198:199], v[198:199], v[30:31]
v_pk_add_f32 v[32:33], v[32:33], v[214:215]
v_pk_fma_f32 v[34:35], v[214:215], v[214:215], v[34:35]
v_pk_add_f32 v[28:29], v[28:29], v[200:201]
v_pk_fma_f32 v[30:31], v[200:201], v[200:201], v[30:31]
v_pk_add_f32 v[32:33], v[32:33], v[216:217]
v_pk_fma_f32 v[34:35], v[216:217], v[216:217], v[34:35]
v_pk_add_f32 v[28:29], v[28:29], v[202:203]
v_pk_fma_f32 v[30:31], v[202:203], v[202:203], v[30:31]
v_pk_add_f32 v[32:33], v[32:33], v[218:219]
v_pk_fma_f32 v[34:35], v[218:219], v[218:219], v[34:35]
v_add_f32 v28, v28, v29
v_add_f32 v30, v30, v31
v_add_f32 v32, v32, v33
v_add_f32 v34, v34, v35
v_and_b32 v4, 31, v0
v_lshlrev_b32 v4, 3, v4
v_lshrrev_b32 v5, 5, v0
v_lshl_add_u32 v4, v5, 2, v4
s_lshl_b32 s19, s18, 14
s_lshl_b32 s37, s37, 3
s_add_u32 s19, s19, s37
s_add_u32 s19, s19, 38797312
v_permlane16_swap_b32 v28, v32
v_permlane16_swap_b32 v30, v34
v_add_f32 v28, v28, v32
v_add_f32 v30, v30, v34
s_nop 1
v_permlane32_swap_b32 v28, v30
v_add_f32 v5, v28, v30
buffer_store_dword v5, v4, s[4:7], s19 offen sc1
v_pk_add_f32 v[188:189], v[188:189], v[76:77]
v_pk_add_f32 v[190:191], v[190:191], v[78:79]
v_pk_add_f32 v[192:193], v[192:193], v[80:81]
v_pk_add_f32 v[194:195], v[194:195], v[82:83]
v_pk_add_f32 v[196:197], v[196:197], v[84:85]
v_pk_add_f32 v[198:199], v[198:199], v[86:87]
v_pk_add_f32 v[200:201], v[200:201], v[88:89]
v_pk_add_f32 v[202:203], v[202:203], v[90:91]
v_pk_add_f32 v[204:205], v[204:205], v[92:93]
v_pk_add_f32 v[206:207], v[206:207], v[94:95]
v_pk_add_f32 v[208:209], v[208:209], v[96:97]
v_pk_add_f32 v[210:211], v[210:211], v[98:99]
v_pk_add_f32 v[212:213], v[212:213], v[100:101]
v_pk_add_f32 v[214:215], v[214:215], v[102:103]
v_pk_add_f32 v[216:217], v[216:217], v[104:105]
v_pk_add_f32 v[218:219], v[218:219], v[106:107]
v_mov_b32 v76, 0
v_mov_b32 v77, 0
v_mov_b32 v78, 0
v_mov_b32 v79, 0
v_mov_b32 v80, 0
v_mov_b32 v81, 0
v_mov_b32 v82, 0
v_mov_b32 v83, 0
v_mov_b32 v84, 0
v_mov_b32 v85, 0
v_mov_b32 v86, 0
v_mov_b32 v87, 0
v_mov_b32 v88, 0
v_mov_b32 v89, 0
v_mov_b32 v90, 0
v_mov_b32 v91, 0
v_mov_b32 v92, 0
v_mov_b32 v93, 0
v_mov_b32 v94, 0
v_mov_b32 v95, 0
v_mov_b32 v96, 0
v_mov_b32 v97, 0
v_mov_b32 v98, 0
v_mov_b32 v99, 0
v_mov_b32 v100, 0
v_mov_b32 v101, 0
v_mov_b32 v102, 0
v_mov_b32 v103, 0
v_mov_b32 v104, 0
v_mov_b32 v105, 0
v_mov_b32 v106, 0
v_mov_b32 v107, 0
v_mov_b32 v108, 0
v_mov_b32 v109, 0
v_mov_b32 v110, 0
v_mov_b32 v111, 0
v_mov_b32 v112, 0
v_mov_b32 v113, 0
v_mov_b32 v114, 0
v_mov_b32 v115, 0
v_mov_b32 v116, 0
v_mov_b32 v117, 0
v_mov_b32 v118, 0
v_mov_b32 v119, 0
v_mov_b32 v120, 0
v_mov_b32 v121, 0
v_mov_b32 v122, 0
v_mov_b32 v123, 0
v_mov_b32 v124, 0
v_mov_b32 v125, 0
v_mov_b32 v126, 0
v_mov_b32 v127, 0
v_mov_b32 v128, 0
v_mov_b32 v129, 0
v_mov_b32 v130, 0
v_mov_b32 v131, 0
v_mov_b32 v132, 0
v_mov_b32 v133, 0
v_mov_b32 v134, 0
v_mov_b32 v135, 0
v_mov_b32 v136, 0
v_mov_b32 v137, 0
v_mov_b32 v138, 0
v_mov_b32 v139, 0
v_mov_b32 v140, 0
v_mov_b32 v141, 0
v_mov_b32 v142, 0
v_mov_b32 v143, 0
v_mov_b32 v144, 0
v_mov_b32 v145, 0
v_mov_b32 v146, 0
v_mov_b32 v147, 0
v_mov_b32 v148, 0
v_mov_b32 v149, 0
v_mov_b32 v150, 0
v_mov_b32 v151, 0
v_mov_b32 v152, 0
v_mov_b32 v153, 0
v_mov_b32 v154, 0
v_mov_b32 v155, 0
v_mov_b32 v156, 0
v_mov_b32 v157, 0
v_mov_b32 v158, 0
v_mov_b32 v159, 0
v_mov_b32 v160, 0
v_mov_b32 v161, 0
v_mov_b32 v162, 0
v_mov_b32 v163, 0
v_mov_b32 v164, 0
v_mov_b32 v165, 0
v_mov_b32 v166, 0
v_mov_b32 v167, 0
v_mov_b32 v168, 0
v_mov_b32 v169, 0
v_mov_b32 v170, 0
v_mov_b32 v171, 0
v_mov_b32 v172, 0
v_mov_b32 v173, 0
v_mov_b32 v174, 0
v_mov_b32 v175, 0
v_mov_b32 v176, 0
v_mov_b32 v177, 0
v_mov_b32 v178, 0
v_mov_b32 v179, 0
v_mov_b32 v180, 0
v_mov_b32 v181, 0
v_mov_b32 v182, 0
v_mov_b32 v183, 0
v_mov_b32 v184, 0
v_mov_b32 v185, 0
v_mov_b32 v186, 0
v_mov_b32 v187, 0
s_waitcnt lgkmcnt(0)
s_barrier
v_add_u32 v7, s20, v6
ds_read_b128 v[60:63], v7 offset:0
v_add_u32 v20, s20, v16
ds_read_b64_tr_b16 v[44:45], v20 offset:0
ds_read_b64_tr_b16 v[46:47], v20 offset:2048
ds_read_b128 v[64:67], v7 offset:1024
v_add_u32 v21, s20, v17
ds_read_b64_tr_b16 v[48:49], v21 offset:0
ds_read_b64_tr_b16 v[50:51], v21 offset:2048
v_add_u32 v22, s20, v18
ds_read_b64_tr_b16 v[52:53], v22 offset:0
ds_read_b64_tr_b16 v[54:55], v22 offset:2048
s_waitcnt lgkmcnt(5)
v_mfma_f32_16x16x32_bf16 v[188:191], v[44:47], v[60:63], v[188:191]
v_add_u32 v23, s20, v19
s_waitcnt lgkmcnt(4)
v_mfma_f32_16x16x32_bf16 v[204:207], v[44:47], v[64:67], v[204:207]
ds_read_b64_tr_b16 v[56:57], v23 offset:0
ds_read_b64_tr_b16 v[58:59], v23 offset:2048
s_waitcnt lgkmcnt(4)
v_mfma_f32_16x16x32_bf16 v[192:195], v[48:51], v[60:63], v[192:195]
ds_read_b128 v[68:71], v7 offset:8192
v_mfma_f32_16x16x32_bf16 v[208:211], v[48:51], v[64:67], v[208:211]
ds_read_b64_tr_b16 v[44:45], v20 offset:4096
ds_read_b64_tr_b16 v[46:47], v20 offset:6144
s_waitcnt lgkmcnt(5)
v_mfma_f32_16x16x32_bf16 v[196:199], v[52:55], v[60:63], v[196:199]
ds_read_b128 v[72:75], v7 offset:9216
v_mfma_f32_16x16x32_bf16 v[212:215], v[52:55], v[64:67], v[212:215]
ds_read_b64_tr_b16 v[48:49], v21 offset:4096
ds_read_b64_tr_b16 v[50:51], v21 offset:6144
s_waitcnt lgkmcnt(6)
v_mfma_f32_16x16x32_bf16 v[200:203], v[56:59], v[60:63], v[200:203]
ds_read_b64_tr_b16 v[52:53], v22 offset:4096
v_mfma_f32_16x16x32_bf16 v[216:219], v[56:59], v[64:67], v[216:219]
ds_read_b64_tr_b16 v[54:55], v22 offset:6144
s_waitcnt lgkmcnt(5)
v_mfma_f32_16x16x32_bf16 v[188:191], v[44:47], v[68:71], v[188:191]
ds_read_b64_tr_b16 v[56:57], v23 offset:4096
ds_read_b64_tr_b16 v[58:59], v23 offset:6144
s_waitcnt lgkmcnt(6)
v_mfma_f32_16x16x32_bf16 v[204:207], v[44:47], v[72:75], v[204:207]
s_add_u32 s20, s20, 25600
s_cmp_ge_u32 s20, 143360
s_cselect_b32 s20, 0, s20
s_waitcnt lgkmcnt(4)
v_mfma_f32_16x16x32_bf16 v[192:195], v[48:51], v[68:71], v[192:195]
s_waitcnt lgkmcnt(0)
s_barrier
v_add_u32 v7, s20, v6
v_mfma_f32_16x16x32_bf16 v[208:211], v[48:51], v[72:75], v[208:211]
ds_read_b128 v[60:63], v7 offset:0
v_add_u32 v20, s20, v16
ds_read_b64_tr_b16 v[44:45], v20 offset:0
ds_read_b64_tr_b16 v[46:47], v20 offset:2048
s_waitcnt lgkmcnt(5)
v_mfma_f32_16x16x32_bf16 v[196:199], v[52:55], v[68:71], v[196:199]
ds_read_b128 v[64:67], v7 offset:1024
v_add_u32 v21, s20, v17
v_mfma_f32_16x16x32_bf16 v[212:215], v[52:55], v[72:75], v[212:215]
ds_read_b64_tr_b16 v[48:49], v21 offset:0
ds_read_b64_tr_b16 v[50:51], v21 offset:2048
s_waitcnt lgkmcnt(6)
v_mfma_f32_16x16x32_bf16 v[200:203], v[56:59], v[68:71], v[200:203]
v_add_u32 v22, s20, v18
v_mfma_f32_16x16x32_bf16 v[216:219], v[56:59], v[72:75], v[216:219]
ds_read_b64_tr_b16 v[52:53], v22 offset:0
ds_read_b64_tr_b16 v[54:55], v22 offset:2048
s_waitcnt lgkmcnt(5)
v_mfma_f32_16x16x32_bf16 v[188:191], v[44:47], v[60:63], v[188:191]
v_add_u32 v23, s20, v19
s_waitcnt lgkmcnt(4)
v_mfma_f32_16x16x32_bf16 v[204:207], v[44:47], v[64:67], v[204:207]
ds_read_b64_tr_b16 v[56:57], v23 offset:0
ds_read_b64_tr_b16 v[58:59], v23 offset:2048
s_waitcnt lgkmcnt(4)
v_mfma_f32_16x16x32_bf16 v[192:195], v[48:51], v[60:63], v[192:195]
ds_read_b128 v[68:71], v7 offset:8192
v_mfma_f32_16x16x32_bf16 v[208:211], v[48:51], v[64:67], v[208:211]
ds_read_b64_tr_b16 v[44:45], v20 offset:4096
ds_read_b64_tr_b16 v[46:47], v20 offset:6144
s_waitcnt lgkmcnt(5)
v_mfma_f32_16x16x32_bf16 v[196:199], v[52:55], v[60:63], v[196:199]
ds_read_b128 v[72:75], v7 offset:9216
v_mfma_f32_16x16x32_bf16 v[212:215], v[52:55], v[64:67], v[212:215]
ds_read_b64_tr_b16 v[48:49], v21 offset:4096
ds_read_b64_tr_b16 v[50:51], v21 offset:6144
s_waitcnt lgkmcnt(6)
v_mfma_f32_16x16x32_bf16 v[200:203], v[56:59], v[60:63], v[200:203]
ds_read_b64_tr_b16 v[52:53], v22 offset:4096
v_mfma_f32_16x16x32_bf16 v[216:219], v[56:59], v[64:67], v[216:219]
ds_read_b64_tr_b16 v[54:55], v22 offset:6144
s_waitcnt lgkmcnt(5)
v_mfma_f32_16x16x32_bf16 v[188:191], v[44:47], v[68:71], v[188:191]
ds_read_b64_tr_b16 v[56:57], v23 offset:4096
ds_read_b64_tr_b16 v[58:59], v23 offset:6144
s_waitcnt lgkmcnt(6)
v_mfma_f32_16x16x32_bf16 v[204:207], v[44:47], v[72:75], v[204:207]
s_add_u32 s20, s20, 25600
s_cmp_ge_u32 s20, 143360
s_cselect_b32 s20, 0, s20
s_waitcnt lgkmcnt(4)
v_mfma_f32_16x16x32_bf16 v[192:195], v[48:51], v[68:71], v[192:195]
s_waitcnt lgkmcnt(0)
s_barrier
v_add_u32 v7, s20, v6
v_mfma_f32_16x16x32_bf16 v[208:211], v[48:51], v[72:75], v[208:211]
ds_read_b128 v[60:63], v7 offset:0
v_add_u32 v20, s20, v16
ds_read_b64_tr_b16 v[44:45], v20 offset:0
ds_read_b64_tr_b16 v[46:47], v20 offset:2048
s_waitcnt lgkmcnt(5)
v_mfma_f32_16x16x32_bf16 v[196:199], v[52:55], v[68:71], v[196:199]
ds_read_b128 v[64:67], v7 offset:1024
v_add_u32 v21, s20, v17
v_mfma_f32_16x16x32_bf16 v[212:215], v[52:55], v[72:75], v[212:215]
ds_read_b64_tr_b16 v[48:49], v21 offset:0
ds_read_b64_tr_b16 v[50:51], v21 offset:2048
s_waitcnt lgkmcnt(6)
v_mfma_f32_16x16x32_bf16 v[200:203], v[56:59], v[68:71], v[200:203]
v_add_u32 v22, s20, v18
v_mfma_f32_16x16x32_bf16 v[216:219], v[56:59], v[72:75], v[216:219]
ds_read_b64_tr_b16 v[52:53], v22 offset:0
ds_read_b64_tr_b16 v[54:55], v22 offset:2048
s_waitcnt vmcnt(0)
s_mov_b32 s24, 2
.p2align 3
CL_p2b_1:
s_waitcnt lgkmcnt(5)
v_mfma_f32_16x16x32_bf16 v[188:191], v[44:47], v[60:63], v[188:191]
v_add_u32 v23, s20, v19
s_waitcnt lgkmcnt(4)
v_mfma_f32_16x16x32_bf16 v[204:207], v[44:47], v[64:67], v[204:207]
ds_read_b64_tr_b16 v[56:57], v23 offset:0
ds_read_b64_tr_b16 v[58:59], v23 offset:2048
s_waitcnt lgkmcnt(4)
v_mfma_f32_16x16x32_bf16 v[192:195], v[48:51], v[60:63], v[192:195]
ds_read_b128 v[68:71], v7 offset:8192
v_mfma_f32_16x16x32_bf16 v[208:211], v[48:51], v[64:67], v[208:211]
ds_read_b64_tr_b16 v[44:45], v20 offset:4096
ds_read_b64_tr_b16 v[46:47], v20 offset:6144
s_waitcnt lgkmcnt(5)
v_mfma_f32_16x16x32_bf16 v[196:199], v[52:55], v[60:63], v[196:199]
ds_read_b128 v[72:75], v7 offset:9216
v_mfma_f32_16x16x32_bf16 v[212:215], v[52:55], v[64:67], v[212:215]
ds_read_b64_tr_b16 v[48:49], v21 offset:4096
ds_read_b64_tr_b16 v[50:51], v21 offset:6144
s_waitcnt lgkmcnt(6)
v_mfma_f32_16x16x32_bf16 v[200:203], v[56:59], v[60:63], v[200:203]
ds_read_b64_tr_b16 v[52:53], v22 offset:4096
v_mfma_f32_16x16x32_bf16 v[216:219], v[56:59], v[64:67], v[216:219]
ds_read_b64_tr_b16 v[54:55], v22 offset:6144
s_waitcnt lgkmcnt(5)
v_mfma_f32_16x16x32_bf16 v[188:191], v[44:47], v[68:71], v[188:191]
ds_read_b64_tr_b16 v[56:57], v23 offset:4096
ds_read_b64_tr_b16 v[58:59], v23 offset:6144
s_waitcnt lgkmcnt(6)
v_mfma_f32_16x16x32_bf16 v[204:207], v[44:47], v[72:75], v[204:207]
s_add_u32 s20, s20, 25600
s_cmp_ge_u32 s20, 143360
s_cselect_b32 s20, 0, s20
s_waitcnt lgkmcnt(4)
v_mfma_f32_16x16x32_bf16 v[192:195], v[48:51], v[68:71], v[192:195]
s_waitcnt lgkmcnt(0)
s_barrier
v_add_u32 v7, s20, v6
v_mfma_f32_16x16x32_bf16 v[208:211], v[48:51], v[72:75], v[208:211]
ds_read_b128 v[60:63], v7 offset:0
v_add_u32 v20, s20, v16
ds_read_b64_tr_b16 v[44:45], v20 offset:0
ds_read_b64_tr_b16 v[46:47], v20 offset:2048
s_waitcnt lgkmcnt(5)
v_mfma_f32_16x16x32_bf16 v[196:199], v[52:55], v[68:71], v[196:199]
ds_read_b128 v[64:67], v7 offset:1024
v_add_u32 v21, s20, v17
v_mfma_f32_16x16x32_bf16 v[212:215], v[52:55], v[72:75], v[212:215]
ds_read_b64_tr_b16 v[48:49], v21 offset:0
ds_read_b64_tr_b16 v[50:51], v21 offset:2048
s_waitcnt lgkmcnt(6)
v_mfma_f32_16x16x32_bf16 v[200:203], v[56:59], v[68:71], v[200:203]
v_add_u32 v22, s20, v18
v_mfma_f32_16x16x32_bf16 v[216:219], v[56:59], v[72:75], v[216:219]
ds_read_b64_tr_b16 v[52:53], v22 offset:0
ds_read_b64_tr_b16 v[54:55], v22 offset:2048
s_waitcnt lgkmcnt(5)
v_mfma_f32_16x16x32_bf16 v[188:191], v[44:47], v[60:63], v[188:191]
v_add_u32 v23, s20, v19
s_waitcnt lgkmcnt(4)
v_mfma_f32_16x16x32_bf16 v[204:207], v[44:47], v[64:67], v[204:207]
ds_read_b64_tr_b16 v[56:57], v23 offset:0
ds_read_b64_tr_b16 v[58:59], v23 offset:2048
s_waitcnt lgkmcnt(4)
v_mfma_f32_16x16x32_bf16 v[192:195], v[48:51], v[60:63], v[192:195]
ds_read_b128 v[68:71], v7 offset:8192
v_mfma_f32_16x16x32_bf16 v[208:211], v[48:51], v[64:67], v[208:211]
ds_read_b64_tr_b16 v[44:45], v20 offset:4096
ds_read_b64_tr_b16 v[46:47], v20 offset:6144
s_waitcnt lgkmcnt(5)
v_mfma_f32_16x16x32_bf16 v[196:199], v[52:55], v[60:63], v[196:199]
ds_read_b128 v[72:75], v7 offset:9216
v_mfma_f32_16x16x32_bf16 v[212:215], v[52:55], v[64:67], v[212:215]
ds_read_b64_tr_b16 v[48:49], v21 offset:4096
ds_read_b64_tr_b16 v[50:51], v21 offset:6144
s_waitcnt lgkmcnt(6)
v_mfma_f32_16x16x32_bf16 v[200:203], v[56:59], v[60:63], v[200:203]
ds_read_b64_tr_b16 v[52:53], v22 offset:4096
v_mfma_f32_16x16x32_bf16 v[216:219], v[56:59], v[64:67], v[216:219]
ds_read_b64_tr_b16 v[54:55], v22 offset:6144
s_waitcnt lgkmcnt(5)
v_mfma_f32_16x16x32_bf16 v[188:191], v[44:47], v[68:71], v[188:191]
ds_read_b64_tr_b16 v[56:57], v23 offset:4096
ds_read_b64_tr_b16 v[58:59], v23 offset:6144
s_waitcnt lgkmcnt(6)
v_mfma_f32_16x16x32_bf16 v[204:207], v[44:47], v[72:75], v[204:207]
s_add_u32 s20, s20, 25600
s_cmp_ge_u32 s20, 143360
s_cselect_b32 s20, 0, s20
s_waitcnt lgkmcnt(4)
v_mfma_f32_16x16x32_bf16 v[192:195], v[48:51], v[68:71], v[192:195]
s_waitcnt lgkmcnt(0)
s_barrier
v_add_u32 v7, s20, v6
v_mfma_f32_16x16x32_bf16 v[208:211], v[48:51], v[72:75], v[208:211]
ds_read_b128 v[60:63], v7 offset:0
v_add_u32 v20, s20, v16
ds_read_b64_tr_b16 v[44:45], v20 offset:0
ds_read_b64_tr_b16 v[46:47], v20 offset:2048
s_waitcnt lgkmcnt(5)
v_mfma_f32_16x16x32_bf16 v[196:199], v[52:55], v[68:71], v[196:199]
ds_read_b128 v[64:67], v7 offset:1024
v_add_u32 v21, s20, v17
v_mfma_f32_16x16x32_bf16 v[212:215], v[52:55], v[72:75], v[212:215]
ds_read_b64_tr_b16 v[48:49], v21 offset:0
ds_read_b64_tr_b16 v[50:51], v21 offset:2048
s_waitcnt lgkmcnt(6)
v_mfma_f32_16x16x32_bf16 v[200:203], v[56:59], v[68:71], v[200:203]
v_add_u32 v22, s20, v18
ds_read_b64_tr_b16 v[52:53], v22 offset:0
v_mfma_f32_16x16x32_bf16 v[216:219], v[56:59], v[72:75], v[216:219]
ds_read_b64_tr_b16 v[54:55], v22 offset:2048
s_sub_u32 s24, s24, 1
s_cmp_lg_u32 s24, 0
s_cbranch_scc1 CL_p2b_1
s_waitcnt lgkmcnt(5)
v_mfma_f32_16x16x32_bf16 v[188:191], v[44:47], v[60:63], v[188:191]
v_add_u32 v23, s20, v19
s_waitcnt lgkmcnt(4)
v_mfma_f32_16x16x32_bf16 v[204:207], v[44:47], v[64:67], v[204:207]
ds_read_b64_tr_b16 v[56:57], v23 offset:0
ds_read_b64_tr_b16 v[58:59], v23 offset:2048
s_waitcnt lgkmcnt(4)
v_mfma_f32_16x16x32_bf16 v[192:195], v[48:51], v[60:63], v[192:195]
ds_read_b128 v[68:71], v7 offset:8192
v_mfma_f32_16x16x32_bf16 v[208:211], v[48:51], v[64:67], v[208:211]
ds_read_b64_tr_b16 v[44:45], v20 offset:4096
ds_read_b64_tr_b16 v[46:47], v20 offset:6144
s_waitcnt lgkmcnt(5)
v_mfma_f32_16x16x32_bf16 v[196:199], v[52:55], v[60:63], v[196:199]
ds_read_b128 v[72:75], v7 offset:9216
v_mfma_f32_16x16x32_bf16 v[212:215], v[52:55], v[64:67], v[212:215]
ds_read_b64_tr_b16 v[48:49], v21 offset:4096
ds_read_b64_tr_b16 v[50:51], v21 offset:6144
s_waitcnt lgkmcnt(6)
v_mfma_f32_16x16x32_bf16 v[200:203], v[56:59], v[60:63], v[200:203]
ds_read_b64_tr_b16 v[52:53], v22 offset:4096
v_mfma_f32_16x16x32_bf16 v[216:219], v[56:59], v[64:67], v[216:219]
ds_read_b64_tr_b16 v[54:55], v22 offset:6144
s_waitcnt lgkmcnt(5)
v_mfma_f32_16x16x32_bf16 v[188:191], v[44:47], v[68:71], v[188:191]
ds_read_b64_tr_b16 v[56:57], v23 offset:4096
ds_read_b64_tr_b16 v[58:59], v23 offset:6144
s_waitcnt lgkmcnt(6)
v_mfma_f32_16x16x32_bf16 v[204:207], v[44:47], v[72:75], v[204:207]
s_add_u32 s20, s20, 25600
s_cmp_ge_u32 s20, 143360
s_cselect_b32 s20, 0, s20
s_waitcnt lgkmcnt(4)
v_mfma_f32_16x16x32_bf16 v[192:195], v[48:51], v[68:71], v[192:195]
s_waitcnt lgkmcnt(0)
s_barrier
v_add_u32 v7, s20, v6
v_mfma_f32_16x16x32_bf16 v[208:211], v[48:51], v[72:75], v[208:211]
ds_read_b128 v[60:63], v7 offset:0
v_add_u32 v20, s20, v16
ds_read_b64_tr_b16 v[44:45], v20 offset:0
ds_read_b64_tr_b16 v[46:47], v20 offset:2048
s_waitcnt lgkmcnt(5)
v_mfma_f32_16x16x32_bf16 v[196:199], v[52:55], v[68:71], v[196:199]
ds_read_b128 v[64:67], v7 offset:1024
v_add_u32 v21, s20, v17
v_mfma_f32_16x16x32_bf16 v[212:215], v[52:55], v[72:75], v[212:215]
ds_read_b64_tr_b16 v[48:49], v21 offset:0
ds_read_b64_tr_b16 v[50:51], v21 offset:2048
s_waitcnt lgkmcnt(6)
v_mfma_f32_16x16x32_bf16 v[200:203], v[56:59], v[68:71], v[200:203]
v_add_u32 v22, s20, v18
v_mfma_f32_16x16x32_bf16 v[216:219], v[56:59], v[72:75], v[216:219]
ds_read_b64_tr_b16 v[52:53], v22 offset:0
ds_read_b64_tr_b16 v[54:55], v22 offset:2048
s_waitcnt lgkmcnt(5)
v_mfma_f32_16x16x32_bf16 v[188:191], v[44:47], v[60:63], v[188:191]
v_add_u32 v23, s20, v19
s_waitcnt lgkmcnt(4)
v_mfma_f32_16x16x32_bf16 v[204:207], v[44:47], v[64:67], v[204:207]
ds_read_b64_tr_b16 v[56:57], v23 offset:0
ds_read_b64_tr_b16 v[58:59], v23 offset:2048
s_waitcnt lgkmcnt(4)
v_mfma_f32_16x16x32_bf16 v[192:195], v[48:51], v[60:63], v[192:195]
ds_read_b128 v[68:71], v7 offset:8192
v_mfma_f32_16x16x32_bf16 v[208:211], v[48:51], v[64:67], v[208:211]
ds_read_b64_tr_b16 v[44:45], v20 offset:4096
ds_read_b64_tr_b16 v[46:47], v20 offset:6144
s_waitcnt lgkmcnt(5)
v_mfma_f32_16x16x32_bf16 v[196:199], v[52:55], v[60:63], v[196:199]
ds_read_b128 v[72:75], v7 offset:9216
v_mfma_f32_16x16x32_bf16 v[212:215], v[52:55], v[64:67], v[212:215]
ds_read_b64_tr_b16 v[48:49], v21 offset:4096
ds_read_b64_tr_b16 v[50:51], v21 offset:6144
s_waitcnt lgkmcnt(6)
v_mfma_f32_16x16x32_bf16 v[200:203], v[56:59], v[60:63], v[200:203]
ds_read_b64_tr_b16 v[52:53], v22 offset:4096
v_mfma_f32_16x16x32_bf16 v[216:219], v[56:59], v[64:67], v[216:219]
ds_read_b64_tr_b16 v[54:55], v22 offset:6144
s_waitcnt lgkmcnt(5)
v_mfma_f32_16x16x32_bf16 v[188:191], v[44:47], v[68:71], v[188:191]
ds_read_b64_tr_b16 v[56:57], v23 offset:4096
ds_read_b64_tr_b16 v[58:59], v23 offset:6144
s_waitcnt lgkmcnt(6)
v_mfma_f32_16x16x32_bf16 v[204:207], v[44:47], v[72:75], v[204:207]
s_add_u32 s20, s20, 25600
s_cmp_ge_u32 s20, 143360
s_cselect_b32 s20, 0, s20
s_waitcnt lgkmcnt(4)
v_mfma_f32_16x16x32_bf16 v[192:195], v[48:51], v[68:71], v[192:195]
v_mfma_f32_16x16x32_bf16 v[208:211], v[48:51], v[72:75], v[208:211]
s_waitcnt lgkmcnt(2)
v_mfma_f32_16x16x32_bf16 v[196:199], v[52:55], v[68:71], v[196:199]
v_mfma_f32_16x16x32_bf16 v[212:215], v[52:55], v[72:75], v[212:215]
s_waitcnt lgkmcnt(0)
v_mfma_f32_16x16x32_bf16 v[200:203], v[56:59], v[68:71], v[200:203]
v_mfma_f32_16x16x32_bf16 v[216:219], v[56:59], v[72:75], v[216:219]
s_and_b32 s47, s18, 1
s_lshl_b32 s47, s47, 1
s_lshl_b32 s34, s33, 3
s_add_u32 s34, s34, s47
s_add_u32 s35, s34, 1
s_add_u32 s36, s34, 2
s_add_u32 s37, s34, 3
s_add_u32 s38, s47, s33
s_add_u32 s38, s38, 6
s_lshl_b32 s39, s32, 2
v_lshrrev_b32 v2, 2, v0
v_lshlrev_b32 v3, 7, v2
v_and_b32 v4, 3, v0
v_lshl_add_u32 v3, v4, 3, v3
v_bfe_u32 v2, v0, 3, 2
s_and_b32 s19, s34, 3
v_xor_b32 v4, s19, v2
v_lshl_add_u32 v4, v4, 5, v3
s_lshr_b32 s19, s34, 2
s_mul_i32 s19, s19, 4096
v_add_u32 v16, s19, v4
s_and_b32 s19, s35, 3
v_xor_b32 v4, s19, v2
v_lshl_add_u32 v4, v4, 5, v3
s_lshr_b32 s19, s35, 2
s_mul_i32 s19, s19, 4096
v_add_u32 v17, s19, v4
s_and_b32 s19, s36, 3
v_xor_b32 v4, s19, v2
v_lshl_add_u32 v4, v4, 5, v3
s_lshr_b32 s19, s36, 2
s_mul_i32 s19, s19, 4096
v_add_u32 v18, s19, v4
s_and_b32 s19, s37, 3
v_xor_b32 v4, s19, v2
v_lshl_add_u32 v4, v4, 5, v3
s_lshr_b32 s19, s37, 2
s_mul_i32 s19, s19, 4096
v_add_u32 v19, s19, v4
s_and_b32 s19, s38, 3
v_xor_b32 v4, s19, v2
v_lshl_add_u32 v4, v4, 5, v3
s_lshr_b32 s19, s38, 2
s_mul_i32 s19, s19, 4096
v_add_u32 v20, s19, v4
s_lshl_b32 s19, s39, 10
s_add_u32 s19, s19, 16384
v_lshl_add_u32 v26, v0, 4, s19
v_and_b32 v2, 48, v0
s_lshl_b32 s19, s34, 6
s_add_u32 s19, s19, 153600
v_add_u32 v3, s19, v2
s_lshl_b32 s19, s38, 6
s_add_u32 s19, s19, 153600
v_add_u32 v4, s19, v2
v_and_b32 v5, 15, v0
s_lshl_b32 s19, s32, 9
s_add_u32 s19, s19, 154624
v_lshl_add_u32 v5, v5, 3, s19
s_mul_i32 s34, s18, 917504
s_lshl_b32 s19, s17, 13
s_add_u32 s34, s34, s19
s_lshl_b32 s19, s32, 12
s_add_u32 s34, s34, s19
s_add_u32 s34, s34, 20971520
s_lshl_b32 s19, s33, 3
s_add_u32 s38, s34, s19
s_add_u32 s38, s38, 393216
s_lshl_b32 s19, s33, 19
s_add_u32 s34, s34, s19
s_add_u32 s35, s34, 131072
s_add_u32 s36, s34, 262144
s_barrier
v_add_u32 v27, s20, v26
ds_read_b128 v[44:47], v27 offset:0
ds_read_b128 v[48:51], v27 offset:1024
v_add_u32 v21, s20, v16
ds_read_b64_tr_b16 v[28:29], v21 offset:0
ds_read_b64_tr_b16 v[30:31], v21 offset:2048
ds_read_b128 v[52:55], v27 offset:2048
ds_read_b128 v[56:59], v27 offset:3072
v_add_u32 v22, s20, v17
ds_read_b64_tr_b16 v[32:33], v22 offset:0
ds_read_b64_tr_b16 v[34:35], v22 offset:2048
v_add_u32 v23, s20, v18
ds_read_b64_tr_b16 v[36:37], v23 offset:0
ds_read_b64_tr_b16 v[38:39], v23 offset:2048
s_mov_b32 s24, 7
.p2align 3
CL_p3_0:
s_waitcnt lgkmcnt(6)
v_mfma_f32_16x16x32_bf16 v[76:79], v[28:31], v[44:47], v[76:79]
v_mfma_f32_16x16x32_bf16 v[104:107], v[28:31], v[48:51], v[104:107]
v_add_u32 v24, s20, v19
s_waitcnt lgkmcnt(5)
v_mfma_f32_16x16x32_bf16 v[132:135], v[28:31], v[52:55], v[132:135]
ds_read_b64_tr_b16 v[40:41], v24 offset:0
s_waitcnt lgkmcnt(5)
v_mfma_f32_16x16x32_bf16 v[160:163], v[28:31], v[56:59], v[160:163]
ds_read_b64_tr_b16 v[42:43], v24 offset:2048
s_waitcnt lgkmcnt(4)
v_mfma_f32_16x16x32_bf16 v[80:83], v[32:35], v[44:47], v[80:83]
v_mfma_f32_16x16x32_bf16 v[108:111], v[32:35], v[48:51], v[108:111]
ds_read_b64_tr_b16 v[28:29], v21 offset:4096
v_mfma_f32_16x16x32_bf16 v[136:139], v[32:35], v[52:55], v[136:139]
v_mfma_f32_16x16x32_bf16 v[164:167], v[32:35], v[56:59], v[164:167]
ds_read_b64_tr_b16 v[30:31], v21 offset:6144
s_waitcnt lgkmcnt(4)
v_mfma_f32_16x16x32_bf16 v[84:87], v[36:39], v[44:47], v[84:87]
v_mfma_f32_16x16x32_bf16 v[112:115], v[36:39], v[48:51], v[112:115]
ds_read_b64_tr_b16 v[32:33], v22 offset:4096
v_mfma_f32_16x16x32_bf16 v[140:143], v[36:39], v[52:55], v[140:143]
v_mfma_f32_16x16x32_bf16 v[168:171], v[36:39], v[56:59], v[168:171]
ds_read_b64_tr_b16 v[34:35], v22 offset:6144
s_waitcnt lgkmcnt(4)
v_mfma_f32_16x16x32_bf16 v[88:91], v[40:43], v[44:47], v[88:91]
v_add_u32 v25, s20, v20
v_mfma_f32_16x16x32_bf16 v[116:119], v[40:43], v[48:51], v[116:119]
ds_read_b64_tr_b16 v[36:37], v25 offset:0
ds_read_b64_tr_b16 v[38:39], v25 offset:2048
v_mfma_f32_16x16x32_bf16 v[144:147], v[40:43], v[52:55], v[144:147]
s_add_u32 s20, s20, 25600
v_mfma_f32_16x16x32_bf16 v[172:175], v[40:43], v[56:59], v[172:175]
s_cmp_ge_u32 s20, 143360
s_cselect_b32 s20, 0, s20
s_waitcnt lgkmcnt(4)
v_mfma_f32_16x16x32_bf16 v[92:95], v[28:31], v[44:47], v[92:95]
s_barrier
v_mfma_f32_16x16x32_bf16 v[120:123], v[28:31], v[48:51], v[120:123]
v_add_u32 v27, s20, v26
ds_read_b128 v[60:63], v27 offset:0
v_mfma_f32_16x16x32_bf16 v[148:151], v[28:31], v[52:55], v[148:151]
ds_read_b128 v[64:67], v27 offset:1024
v_add_u32 v21, s20, v16
v_mfma_f32_16x16x32_bf16 v[176:179], v[28:31], v[56:59], v[176:179]
ds_read_b64_tr_b16 v[40:41], v21 offset:0
ds_read_b64_tr_b16 v[42:43], v21 offset:2048
s_waitcnt lgkmcnt(6)
v_mfma_f32_16x16x32_bf16 v[96:99], v[32:35], v[44:47], v[96:99]
ds_read_b128 v[68:71], v27 offset:2048
v_mfma_f32_16x16x32_bf16 v[124:127], v[32:35], v[48:51], v[124:127]
ds_read_b128 v[72:75], v27 offset:3072
v_mfma_f32_16x16x32_bf16 v[152:155], v[32:35], v[52:55], v[152:155]
v_add_u32 v22, s20, v17
v_mfma_f32_16x16x32_bf16 v[180:183], v[32:35], v[56:59], v[180:183]
ds_read_b64_tr_b16 v[28:29], v22 offset:0
ds_read_b64_tr_b16 v[30:31], v22 offset:2048
s_waitcnt lgkmcnt(8)
v_mfma_f32_16x16x32_bf16 v[100:103], v[36:39], v[44:47], v[100:103]
v_mfma_f32_16x16x32_bf16 v[128:131], v[36:39], v[48:51], v[128:131]
v_add_u32 v23, s20, v18
v_mfma_f32_16x16x32_bf16 v[156:159], v[36:39], v[52:55], v[156:159]
ds_read_b64_tr_b16 v[32:33], v23 offset:0
v_mfma_f32_16x16x32_bf16 v[184:187], v[36:39], v[56:59], v[184:187]
ds_read_b64_tr_b16 v[34:35], v23 offset:2048
s_waitcnt lgkmcnt(6)
v_mfma_f32_16x16x32_bf16 v[76:79], v[40:43], v[60:63], v[76:79]
v_mfma_f32_16x16x32_bf16 v[104:107], v[40:43], v[64:67], v[104:107]
v_add_u32 v24, s20, v19
s_waitcnt lgkmcnt(5)
v_mfma_f32_16x16x32_bf16 v[132:135], v[40:43], v[68:71], v[132:135]
ds_read_b64_tr_b16 v[36:37], v24 offset:0
s_waitcnt lgkmcnt(5)
v_mfma_f32_16x16x32_bf16 v[160:163], v[40:43], v[72:75], v[160:163]
ds_read_b64_tr_b16 v[38:39], v24 offset:2048
s_waitcnt lgkmcnt(4)
v_mfma_f32_16x16x32_bf16 v[80:83], v[28:31], v[60:63], v[80:83]
v_mfma_f32_16x16x32_bf16 v[108:111], v[28:31], v[64:67], v[108:111]
ds_read_b64_tr_b16 v[40:41], v21 offset:4096
v_mfma_f32_16x16x32_bf16 v[136:139], v[28:31], v[68:71], v[136:139]
v_mfma_f32_16x16x32_bf16 v[164:167], v[28:31], v[72:75], v[164:167]
ds_read_b64_tr_b16 v[42:43], v21 offset:6144
s_waitcnt lgkmcnt(4)
v_mfma_f32_16x16x32_bf16 v[84:87], v[32:35], v[60:63], v[84:87]
v_mfma_f32_16x16x32_bf16 v[112:115], v[32:35], v[64:67], v[112:115]
ds_read_b64_tr_b16 v[28:29], v22 offset:4096
v_mfma_f32_16x16x32_bf16 v[140:143], v[32:35], v[68:71], v[140:143]
v_mfma_f32_16x16x32_bf16 v[168:171], v[32:35], v[72:75], v[168:171]
ds_read_b64_tr_b16 v[30:31], v22 offset:6144
s_waitcnt lgkmcnt(4)
v_mfma_f32_16x16x32_bf16 v[88:91], v[36:39], v[60:63], v[88:91]
v_add_u32 v25, s20, v20
v_mfma_f32_16x16x32_bf16 v[116:119], v[36:39], v[64:67], v[116:119]
ds_read_b64_tr_b16 v[32:33], v25 offset:0
ds_read_b64_tr_b16 v[34:35], v25 offset:2048
v_mfma_f32_16x16x32_bf16 v[144:147], v[36:39], v[68:71], v[144:147]
s_add_u32 s20, s20, 25600
v_mfma_f32_16x16x32_bf16 v[172:175], v[36:39], v[72:75], v[172:175]
s_cmp_ge_u32 s20, 143360
s_cselect_b32 s20, 0, s20
s_waitcnt lgkmcnt(4)
v_mfma_f32_16x16x32_bf16 v[92:95], v[40:43], v[60:63], v[92:95]
s_barrier
v_mfma_f32_16x16x32_bf16 v[120:123], v[40:43], v[64:67], v[120:123]
v_add_u32 v27, s20, v26
ds_read_b128 v[44:47], v27 offset:0
v_mfma_f32_16x16x32_bf16 v[148:151], v[40:43], v[68:71], v[148:151]
ds_read_b128 v[48:51], v27 offset:1024
v_add_u32 v21, s20, v16
v_mfma_f32_16x16x32_bf16 v[176:179], v[40:43], v[72:75], v[176:179]
ds_read_b64_tr_b16 v[36:37], v21 offset:0
ds_read_b64_tr_b16 v[38:39], v21 offset:2048
s_waitcnt lgkmcnt(6)
v_mfma_f32_16x16x32_bf16 v[96:99], v[28:31], v[60:63], v[96:99]
ds_read_b128 v[52:55], v27 offset:2048
v_mfma_f32_16x16x32_bf16 v[124:127], v[28:31], v[64:67], v[124:127]
ds_read_b128 v[56:59], v27 offset:3072
v_mfma_f32_16x16x32_bf16 v[152:155], v[28:31], v[68:71], v[152:155]
v_add_u32 v22, s20, v17
v_mfma_f32_16x16x32_bf16 v[180:183], v[28:31], v[72:75], v[180:183]
ds_read_b64_tr_b16 v[40:41], v22 offset:0
ds_read_b64_tr_b16 v[42:43], v22 offset:2048
s_waitcnt lgkmcnt(8)
v_mfma_f32_16x16x32_bf16 v[100:103], v[32:35], v[60:63], v[100:103]
v_mfma_f32_16x16x32_bf16 v[128:131], v[32:35], v[64:67], v[128:131]
v_add_u32 v23, s20, v18
v_mfma_f32_16x16x32_bf16 v[156:159], v[32:35], v[68:71], v[156:159]
ds_read_b64_tr_b16 v[28:29], v23 offset:0
v_mfma_f32_16x16x32_bf16 v[184:187], v[32:35], v[72:75], v[184:187]
ds_read_b64_tr_b16 v[30:31], v23 offset:2048
s_waitcnt lgkmcnt(6)
v_mfma_f32_16x16x32_bf16 v[76:79], v[36:39], v[44:47], v[76:79]
v_mfma_f32_16x16x32_bf16 v[104:107], v[36:39], v[48:51], v[104:107]
v_add_u32 v24, s20, v19
s_waitcnt lgkmcnt(5)
v_mfma_f32_16x16x32_bf16 v[132:135], v[36:39], v[52:55], v[132:135]
ds_read_b64_tr_b16 v[32:33], v24 offset:0
s_waitcnt lgkmcnt(5)
v_mfma_f32_16x16x32_bf16 v[160:163], v[36:39], v[56:59], v[160:163]
ds_read_b64_tr_b16 v[34:35], v24 offset:2048
s_waitcnt lgkmcnt(4)
v_mfma_f32_16x16x32_bf16 v[80:83], v[40:43], v[44:47], v[80:83]
v_mfma_f32_16x16x32_bf16 v[108:111], v[40:43], v[48:51], v[108:111]
ds_read_b64_tr_b16 v[36:37], v21 offset:4096
v_mfma_f32_16x16x32_bf16 v[136:139], v[40:43], v[52:55], v[136:139]
v_mfma_f32_16x16x32_bf16 v[164:167], v[40:43], v[56:59], v[164:167]
ds_read_b64_tr_b16 v[38:39], v21 offset:6144
s_waitcnt lgkmcnt(4)
v_mfma_f32_16x16x32_bf16 v[84:87], v[28:31], v[44:47], v[84:87]
v_mfma_f32_16x16x32_bf16 v[112:115], v[28:31], v[48:51], v[112:115]
ds_read_b64_tr_b16 v[40:41], v22 offset:4096
v_mfma_f32_16x16x32_bf16 v[140:143], v[28:31], v[52:55], v[140:143]
v_mfma_f32_16x16x32_bf16 v[168:171], v[28:31], v[56:59], v[168:171]
ds_read_b64_tr_b16 v[42:43], v22 offset:6144
s_waitcnt lgkmcnt(4)
v_mfma_f32_16x16x32_bf16 v[88:91], v[32:35], v[44:47], v[88:91]
v_add_u32 v25, s20, v20
v_mfma_f32_16x16x32_bf16 v[116:119], v[32:35], v[48:51], v[116:119]
ds_read_b64_tr_b16 v[28:29], v25 offset:0
ds_read_b64_tr_b16 v[30:31], v25 offset:2048
v_mfma_f32_16x16x32_bf16 v[144:147], v[32:35], v[52:55], v[144:147]
s_add_u32 s20, s20, 25600
v_mfma_f32_16x16x32_bf16 v[172:175], v[32:35], v[56:59], v[172:175]
s_cmp_ge_u32 s20, 143360
s_cselect_b32 s20, 0, s20
s_waitcnt lgkmcnt(4)
v_mfma_f32_16x16x32_bf16 v[92:95], v[36:39], v[44:47], v[92:95]
s_barrier
v_mfma_f32_16x16x32_bf16 v[120:123], v[36:39], v[48:51], v[120:123]
v_add_u32 v27, s20, v26
ds_read_b128 v[60:63], v27 offset:0
v_mfma_f32_16x16x32_bf16 v[148:151], v[36:39], v[52:55], v[148:151]
ds_read_b128 v[64:67], v27 offset:1024
v_add_u32 v21, s20, v16
v_mfma_f32_16x16x32_bf16 v[176:179], v[36:39], v[56:59], v[176:179]
ds_read_b64_tr_b16 v[32:33], v21 offset:0
ds_read_b64_tr_b16 v[34:35], v21 offset:2048
s_waitcnt lgkmcnt(6)
v_mfma_f32_16x16x32_bf16 v[96:99], v[40:43], v[44:47], v[96:99]
ds_read_b128 v[68:71], v27 offset:2048
v_mfma_f32_16x16x32_bf16 v[124:127], v[40:43], v[48:51], v[124:127]
ds_read_b128 v[72:75], v27 offset:3072
v_mfma_f32_16x16x32_bf16 v[152:155], v[40:43], v[52:55], v[152:155]
v_add_u32 v22, s20, v17
v_mfma_f32_16x16x32_bf16 v[180:183], v[40:43], v[56:59], v[180:183]
ds_read_b64_tr_b16 v[36:37], v22 offset:0
ds_read_b64_tr_b16 v[38:39], v22 offset:2048
s_waitcnt lgkmcnt(8)
v_mfma_f32_16x16x32_bf16 v[100:103], v[28:31], v[44:47], v[100:103]
v_mfma_f32_16x16x32_bf16 v[128:131], v[28:31], v[48:51], v[128:131]
v_add_u32 v23, s20, v18
v_mfma_f32_16x16x32_bf16 v[156:159], v[28:31], v[52:55], v[156:159]
ds_read_b64_tr_b16 v[40:41], v23 offset:0
v_mfma_f32_16x16x32_bf16 v[184:187], v[28:31], v[56:59], v[184:187]
ds_read_b64_tr_b16 v[42:43], v23 offset:2048
s_waitcnt lgkmcnt(6)
v_mfma_f32_16x16x32_bf16 v[76:79], v[32:35], v[60:63], v[76:79]
v_mfma_f32_16x16x32_bf16 v[104:107], v[32:35], v[64:67], v[104:107]
v_add_u32 v24, s20, v19
s_waitcnt lgkmcnt(5)
v_mfma_f32_16x16x32_bf16 v[132:135], v[32:35], v[68:71], v[132:135]
ds_read_b64_tr_b16 v[28:29], v24 offset:0
s_waitcnt lgkmcnt(5)
v_mfma_f32_16x16x32_bf16 v[160:163], v[32:35], v[72:75], v[160:163]
ds_read_b64_tr_b16 v[30:31], v24 offset:2048
s_waitcnt lgkmcnt(4)
v_mfma_f32_16x16x32_bf16 v[80:83], v[36:39], v[60:63], v[80:83]
v_mfma_f32_16x16x32_bf16 v[108:111], v[36:39], v[64:67], v[108:111]
ds_read_b64_tr_b16 v[32:33], v21 offset:4096
v_mfma_f32_16x16x32_bf16 v[136:139], v[36:39], v[68:71], v[136:139]
v_mfma_f32_16x16x32_bf16 v[164:167], v[36:39], v[72:75], v[164:167]
ds_read_b64_tr_b16 v[34:35], v21 offset:6144
s_waitcnt lgkmcnt(4)
v_mfma_f32_16x16x32_bf16 v[84:87], v[40:43], v[60:63], v[84:87]
v_mfma_f32_16x16x32_bf16 v[112:115], v[40:43], v[64:67], v[112:115]
ds_read_b64_tr_b16 v[36:37], v22 offset:4096
v_mfma_f32_16x16x32_bf16 v[140:143], v[40:43], v[68:71], v[140:143]
v_mfma_f32_16x16x32_bf16 v[168:171], v[40:43], v[72:75], v[168:171]
ds_read_b64_tr_b16 v[38:39], v22 offset:6144
s_waitcnt lgkmcnt(4)
v_mfma_f32_16x16x32_bf16 v[88:91], v[28:31], v[60:63], v[88:91]
v_add_u32 v25, s20, v20
v_mfma_f32_16x16x32_bf16 v[116:119], v[28:31], v[64:67], v[116:119]
ds_read_b64_tr_b16 v[40:41], v25 offset:0
ds_read_b64_tr_b16 v[42:43], v25 offset:2048
v_mfma_f32_16x16x32_bf16 v[144:147], v[28:31], v[68:71], v[144:147]
s_add_u32 s20, s20, 25600
v_mfma_f32_16x16x32_bf16 v[172:175], v[28:31], v[72:75], v[172:175]
s_cmp_ge_u32 s20, 143360
s_cselect_b32 s20, 0, s20
s_waitcnt lgkmcnt(4)
v_mfma_f32_16x16x32_bf16 v[92:95], v[32:35], v[60:63], v[92:95]
s_barrier
v_mfma_f32_16x16x32_bf16 v[120:123], v[32:35], v[64:67], v[120:123]
v_add_u32 v27, s20, v26
ds_read_b128 v[44:47], v27 offset:0
v_mfma_f32_16x16x32_bf16 v[148:151], v[32:35], v[68:71], v[148:151]
ds_read_b128 v[48:51], v27 offset:1024
v_add_u32 v21, s20, v16
v_mfma_f32_16x16x32_bf16 v[176:179], v[32:35], v[72:75], v[176:179]
ds_read_b64_tr_b16 v[28:29], v21 offset:0
ds_read_b64_tr_b16 v[30:31], v21 offset:2048
s_waitcnt lgkmcnt(6)
v_mfma_f32_16x16x32_bf16 v[96:99], v[36:39], v[60:63], v[96:99]
ds_read_b128 v[52:55], v27 offset:2048
v_mfma_f32_16x16x32_bf16 v[124:127], v[36:39], v[64:67], v[124:127]
ds_read_b128 v[56:59], v27 offset:3072
v_mfma_f32_16x16x32_bf16 v[152:155], v[36:39], v[68:71], v[152:155]
v_add_u32 v22, s20, v17
v_mfma_f32_16x16x32_bf16 v[180:183], v[36:39], v[72:75], v[180:183]
ds_read_b64_tr_b16 v[32:33], v22 offset:0
ds_read_b64_tr_b16 v[34:35], v22 offset:2048
s_waitcnt lgkmcnt(8)
v_mfma_f32_16x16x32_bf16 v[100:103], v[40:43], v[60:63], v[100:103]
v_add_u32 v23, s20, v18
v_mfma_f32_16x16x32_bf16 v[128:131], v[40:43], v[64:67], v[128:131]
ds_read_b64_tr_b16 v[36:37], v23 offset:0
v_mfma_f32_16x16x32_bf16 v[156:159], v[40:43], v[68:71], v[156:159]
ds_read_b64_tr_b16 v[38:39], v23 offset:2048
v_mfma_f32_16x16x32_bf16 v[184:187], v[40:43], v[72:75], v[184:187]
s_sub_u32 s24, s24, 1
s_cmp_lg_u32 s24, 0
s_cbranch_scc1 CL_p3_0
s_waitcnt lgkmcnt(6)
v_mfma_f32_16x16x32_bf16 v[76:79], v[28:31], v[44:47], v[76:79]
v_mfma_f32_16x16x32_bf16 v[104:107], v[28:31], v[48:51], v[104:107]
v_add_u32 v24, s20, v19
s_waitcnt lgkmcnt(5)
v_mfma_f32_16x16x32_bf16 v[132:135], v[28:31], v[52:55], v[132:135]
ds_read_b64_tr_b16 v[40:41], v24 offset:0
s_waitcnt lgkmcnt(5)
v_mfma_f32_16x16x32_bf16 v[160:163], v[28:31], v[56:59], v[160:163]
ds_read_b64_tr_b16 v[42:43], v24 offset:2048
s_waitcnt lgkmcnt(4)
v_mfma_f32_16x16x32_bf16 v[80:83], v[32:35], v[44:47], v[80:83]
v_mfma_f32_16x16x32_bf16 v[108:111], v[32:35], v[48:51], v[108:111]
ds_read_b64_tr_b16 v[28:29], v21 offset:4096
v_mfma_f32_16x16x32_bf16 v[136:139], v[32:35], v[52:55], v[136:139]
v_mfma_f32_16x16x32_bf16 v[164:167], v[32:35], v[56:59], v[164:167]
ds_read_b64_tr_b16 v[30:31], v21 offset:6144
s_waitcnt lgkmcnt(4)
v_mfma_f32_16x16x32_bf16 v[84:87], v[36:39], v[44:47], v[84:87]
v_mfma_f32_16x16x32_bf16 v[112:115], v[36:39], v[48:51], v[112:115]
ds_read_b64_tr_b16 v[32:33], v22 offset:4096
v_mfma_f32_16x16x32_bf16 v[140:143], v[36:39], v[52:55], v[140:143]
v_mfma_f32_16x16x32_bf16 v[168:171], v[36:39], v[56:59], v[168:171]
ds_read_b64_tr_b16 v[34:35], v22 offset:6144
s_waitcnt lgkmcnt(4)
v_mfma_f32_16x16x32_bf16 v[88:91], v[40:43], v[44:47], v[88:91]
v_add_u32 v25, s20, v20
v_mfma_f32_16x16x32_bf16 v[116:119], v[40:43], v[48:51], v[116:119]
ds_read_b64_tr_b16 v[36:37], v25 offset:0
ds_read_b64_tr_b16 v[38:39], v25 offset:2048
v_mfma_f32_16x16x32_bf16 v[144:147], v[40:43], v[52:55], v[144:147]
s_add_u32 s20, s20, 25600
v_mfma_f32_16x16x32_bf16 v[172:175], v[40:43], v[56:59], v[172:175]
s_cmp_ge_u32 s20, 143360
s_cselect_b32 s20, 0, s20
s_waitcnt lgkmcnt(4)
v_mfma_f32_16x16x32_bf16 v[92:95], v[28:31], v[44:47], v[92:95]
s_barrier
v_mfma_f32_16x16x32_bf16 v[120:123], v[28:31], v[48:51], v[120:123]
v_add_u32 v27, s20, v26
ds_read_b128 v[60:63], v27 offset:0
v_mfma_f32_16x16x32_bf16 v[148:151], v[28:31], v[52:55], v[148:151]
ds_read_b128 v[64:67], v27 offset:1024
v_add_u32 v21, s20, v16
v_mfma_f32_16x16x32_bf16 v[176:179], v[28:31], v[56:59], v[176:179]
ds_read_b64_tr_b16 v[40:41], v21 offset:0
ds_read_b64_tr_b16 v[42:43], v21 offset:2048
s_waitcnt lgkmcnt(6)
v_mfma_f32_16x16x32_bf16 v[96:99], v[32:35], v[44:47], v[96:99]
ds_read_b128 v[68:71], v27 offset:2048
v_mfma_f32_16x16x32_bf16 v[124:127], v[32:35], v[48:51], v[124:127]
ds_read_b128 v[72:75], v27 offset:3072
v_mfma_f32_16x16x32_bf16 v[152:155], v[32:35], v[52:55], v[152:155]
v_add_u32 v22, s20, v17
v_mfma_f32_16x16x32_bf16 v[180:183], v[32:35], v[56:59], v[180:183]
ds_read_b64_tr_b16 v[28:29], v22 offset:0
ds_read_b64_tr_b16 v[30:31], v22 offset:2048
s_waitcnt lgkmcnt(8)
v_mfma_f32_16x16x32_bf16 v[100:103], v[36:39], v[44:47], v[100:103]
v_mfma_f32_16x16x32_bf16 v[128:131], v[36:39], v[48:51], v[128:131]
v_add_u32 v23, s20, v18
v_mfma_f32_16x16x32_bf16 v[156:159], v[36:39], v[52:55], v[156:159]
ds_read_b64_tr_b16 v[32:33], v23 offset:0
v_mfma_f32_16x16x32_bf16 v[184:187], v[36:39], v[56:59], v[184:187]
ds_read_b64_tr_b16 v[34:35], v23 offset:2048
s_waitcnt lgkmcnt(6)
v_mfma_f32_16x16x32_bf16 v[76:79], v[40:43], v[60:63], v[76:79]
v_mfma_f32_16x16x32_bf16 v[104:107], v[40:43], v[64:67], v[104:107]
v_add_u32 v24, s20, v19
s_waitcnt lgkmcnt(5)
v_mfma_f32_16x16x32_bf16 v[132:135], v[40:43], v[68:71], v[132:135]
ds_read_b64_tr_b16 v[36:37], v24 offset:0
s_waitcnt lgkmcnt(5)
v_mfma_f32_16x16x32_bf16 v[160:163], v[40:43], v[72:75], v[160:163]
ds_read_b64_tr_b16 v[38:39], v24 offset:2048
s_waitcnt lgkmcnt(4)
v_mfma_f32_16x16x32_bf16 v[80:83], v[28:31], v[60:63], v[80:83]
v_mfma_f32_16x16x32_bf16 v[108:111], v[28:31], v[64:67], v[108:111]
ds_read_b64_tr_b16 v[40:41], v21 offset:4096
v_mfma_f32_16x16x32_bf16 v[136:139], v[28:31], v[68:71], v[136:139]
v_mfma_f32_16x16x32_bf16 v[164:167], v[28:31], v[72:75], v[164:167]
ds_read_b64_tr_b16 v[42:43], v21 offset:6144
s_waitcnt lgkmcnt(4)
v_mfma_f32_16x16x32_bf16 v[84:87], v[32:35], v[60:63], v[84:87]
v_mfma_f32_16x16x32_bf16 v[112:115], v[32:35], v[64:67], v[112:115]
ds_read_b64_tr_b16 v[28:29], v22 offset:4096
v_mfma_f32_16x16x32_bf16 v[140:143], v[32:35], v[68:71], v[140:143]
v_mfma_f32_16x16x32_bf16 v[168:171], v[32:35], v[72:75], v[168:171]
ds_read_b64_tr_b16 v[30:31], v22 offset:6144
s_waitcnt lgkmcnt(4)
v_mfma_f32_16x16x32_bf16 v[88:91], v[36:39], v[60:63], v[88:91]
v_add_u32 v25, s20, v20
v_mfma_f32_16x16x32_bf16 v[116:119], v[36:39], v[64:67], v[116:119]
ds_read_b64_tr_b16 v[32:33], v25 offset:0
ds_read_b64_tr_b16 v[34:35], v25 offset:2048
v_mfma_f32_16x16x32_bf16 v[144:147], v[36:39], v[68:71], v[144:147]
s_add_u32 s20, s20, 25600
v_mfma_f32_16x16x32_bf16 v[172:175], v[36:39], v[72:75], v[172:175]
s_cmp_ge_u32 s20, 143360
s_cselect_b32 s20, 0, s20
s_waitcnt lgkmcnt(4)
v_mfma_f32_16x16x32_bf16 v[92:95], v[40:43], v[60:63], v[92:95]
s_barrier
v_mfma_f32_16x16x32_bf16 v[120:123], v[40:43], v[64:67], v[120:123]
v_add_u32 v27, s20, v26
ds_read_b128 v[44:47], v27 offset:0
v_mfma_f32_16x16x32_bf16 v[148:151], v[40:43], v[68:71], v[148:151]
ds_read_b128 v[48:51], v27 offset:1024
v_add_u32 v21, s20, v16
v_mfma_f32_16x16x32_bf16 v[176:179], v[40:43], v[72:75], v[176:179]
ds_read_b64_tr_b16 v[36:37], v21 offset:0
ds_read_b64_tr_b16 v[38:39], v21 offset:2048
s_waitcnt lgkmcnt(6)
v_mfma_f32_16x16x32_bf16 v[96:99], v[28:31], v[60:63], v[96:99]
ds_read_b128 v[52:55], v27 offset:2048
v_mfma_f32_16x16x32_bf16 v[124:127], v[28:31], v[64:67], v[124:127]
ds_read_b128 v[56:59], v27 offset:3072
v_mfma_f32_16x16x32_bf16 v[152:155], v[28:31], v[68:71], v[152:155]
v_add_u32 v22, s20, v17
v_mfma_f32_16x16x32_bf16 v[180:183], v[28:31], v[72:75], v[180:183]
ds_read_b64_tr_b16 v[40:41], v22 offset:0
ds_read_b64_tr_b16 v[42:43], v22 offset:2048
s_waitcnt lgkmcnt(8)
v_mfma_f32_16x16x32_bf16 v[100:103], v[32:35], v[60:63], v[100:103]
v_mfma_f32_16x16x32_bf16 v[128:131], v[32:35], v[64:67], v[128:131]
v_add_u32 v23, s20, v18
v_mfma_f32_16x16x32_bf16 v[156:159], v[32:35], v[68:71], v[156:159]
ds_read_b64_tr_b16 v[28:29], v23 offset:0
v_mfma_f32_16x16x32_bf16 v[184:187], v[32:35], v[72:75], v[184:187]
ds_read_b64_tr_b16 v[30:31], v23 offset:2048
s_waitcnt lgkmcnt(6)
v_mfma_f32_16x16x32_bf16 v[76:79], v[36:39], v[44:47], v[76:79]
v_mfma_f32_16x16x32_bf16 v[104:107], v[36:39], v[48:51], v[104:107]
v_add_u32 v24, s20, v19
s_waitcnt lgkmcnt(5)
v_mfma_f32_16x16x32_bf16 v[132:135], v[36:39], v[52:55], v[132:135]
ds_read_b64_tr_b16 v[32:33], v24 offset:0
s_waitcnt lgkmcnt(5)
v_mfma_f32_16x16x32_bf16 v[160:163], v[36:39], v[56:59], v[160:163]
ds_read_b64_tr_b16 v[34:35], v24 offset:2048
s_waitcnt lgkmcnt(4)
v_mfma_f32_16x16x32_bf16 v[80:83], v[40:43], v[44:47], v[80:83]
v_mfma_f32_16x16x32_bf16 v[108:111], v[40:43], v[48:51], v[108:111]
ds_read_b64_tr_b16 v[36:37], v21 offset:4096
v_mfma_f32_16x16x32_bf16 v[136:139], v[40:43], v[52:55], v[136:139]
v_mfma_f32_16x16x32_bf16 v[164:167], v[40:43], v[56:59], v[164:167]
ds_read_b64_tr_b16 v[38:39], v21 offset:6144
s_waitcnt lgkmcnt(4)
v_mfma_f32_16x16x32_bf16 v[84:87], v[28:31], v[44:47], v[84:87]
v_mfma_f32_16x16x32_bf16 v[112:115], v[28:31], v[48:51], v[112:115]
ds_read_b64_tr_b16 v[40:41], v22 offset:4096
v_mfma_f32_16x16x32_bf16 v[140:143], v[28:31], v[52:55], v[140:143]
v_mfma_f32_16x16x32_bf16 v[168:171], v[28:31], v[56:59], v[168:171]
ds_read_b64_tr_b16 v[42:43], v22 offset:6144
s_waitcnt lgkmcnt(4)
v_mfma_f32_16x16x32_bf16 v[88:91], v[32:35], v[44:47], v[88:91]
v_add_u32 v25, s20, v20
v_mfma_f32_16x16x32_bf16 v[116:119], v[32:35], v[48:51], v[116:119]
ds_read_b64_tr_b16 v[28:29], v25 offset:0
ds_read_b64_tr_b16 v[30:31], v25 offset:2048
v_mfma_f32_16x16x32_bf16 v[144:147], v[32:35], v[52:55], v[144:147]
s_add_u32 s20, s20, 25600
v_mfma_f32_16x16x32_bf16 v[172:175], v[32:35], v[56:59], v[172:175]
s_cmp_ge_u32 s20, 143360
s_cselect_b32 s20, 0, s20
s_waitcnt lgkmcnt(4)
v_mfma_f32_16x16x32_bf16 v[92:95], v[36:39], v[44:47], v[92:95]
s_barrier
v_mfma_f32_16x16x32_bf16 v[120:123], v[36:39], v[48:51], v[120:123]
v_add_u32 v27, s20, v26
ds_read_b128 v[60:63], v27 offset:0
v_mfma_f32_16x16x32_bf16 v[148:151], v[36:39], v[52:55], v[148:151]
ds_read_b128 v[64:67], v27 offset:1024
v_add_u32 v21, s20, v16
v_mfma_f32_16x16x32_bf16 v[176:179], v[36:39], v[56:59], v[176:179]
ds_read_b64_tr_b16 v[32:33], v21 offset:0
ds_read_b64_tr_b16 v[34:35], v21 offset:2048
s_waitcnt lgkmcnt(6)
v_mfma_f32_16x16x32_bf16 v[96:99], v[40:43], v[44:47], v[96:99]
ds_read_b128 v[68:71], v27 offset:2048
v_mfma_f32_16x16x32_bf16 v[124:127], v[40:43], v[48:51], v[124:127]
ds_read_b128 v[72:75], v27 offset:3072
v_mfma_f32_16x16x32_bf16 v[152:155], v[40:43], v[52:55], v[152:155]
v_add_u32 v22, s20, v17
v_mfma_f32_16x16x32_bf16 v[180:183], v[40:43], v[56:59], v[180:183]
ds_read_b64_tr_b16 v[36:37], v22 offset:0
ds_read_b64_tr_b16 v[38:39], v22 offset:2048
s_waitcnt lgkmcnt(8)
v_mfma_f32_16x16x32_bf16 v[100:103], v[28:31], v[44:47], v[100:103]
v_mfma_f32_16x16x32_bf16 v[128:131], v[28:31], v[48:51], v[128:131]
v_add_u32 v23, s20, v18
v_mfma_f32_16x16x32_bf16 v[156:159], v[28:31], v[52:55], v[156:159]
ds_read_b64_tr_b16 v[40:41], v23 offset:0
v_mfma_f32_16x16x32_bf16 v[184:187], v[28:31], v[56:59], v[184:187]
ds_read_b64_tr_b16 v[42:43], v23 offset:2048
s_waitcnt lgkmcnt(6)
v_mfma_f32_16x16x32_bf16 v[76:79], v[32:35], v[60:63], v[76:79]
v_mfma_f32_16x16x32_bf16 v[104:107], v[32:35], v[64:67], v[104:107]
v_add_u32 v24, s20, v19
s_waitcnt lgkmcnt(5)
v_mfma_f32_16x16x32_bf16 v[132:135], v[32:35], v[68:71], v[132:135]
ds_read_b64_tr_b16 v[28:29], v24 offset:0
s_waitcnt lgkmcnt(5)
v_mfma_f32_16x16x32_bf16 v[160:163], v[32:35], v[72:75], v[160:163]
ds_read_b64_tr_b16 v[30:31], v24 offset:2048
s_waitcnt lgkmcnt(4)
v_mfma_f32_16x16x32_bf16 v[80:83], v[36:39], v[60:63], v[80:83]
v_mfma_f32_16x16x32_bf16 v[108:111], v[36:39], v[64:67], v[108:111]
ds_read_b64_tr_b16 v[32:33], v21 offset:4096
v_mfma_f32_16x16x32_bf16 v[136:139], v[36:39], v[68:71], v[136:139]
v_mfma_f32_16x16x32_bf16 v[164:167], v[36:39], v[72:75], v[164:167]
ds_read_b64_tr_b16 v[34:35], v21 offset:6144
s_waitcnt lgkmcnt(4)
v_mfma_f32_16x16x32_bf16 v[84:87], v[40:43], v[60:63], v[84:87]
v_mfma_f32_16x16x32_bf16 v[112:115], v[40:43], v[64:67], v[112:115]
ds_read_b64_tr_b16 v[36:37], v22 offset:4096
v_mfma_f32_16x16x32_bf16 v[140:143], v[40:43], v[68:71], v[140:143]
v_mfma_f32_16x16x32_bf16 v[168:171], v[40:43], v[72:75], v[168:171]
ds_read_b64_tr_b16 v[38:39], v22 offset:6144
s_waitcnt lgkmcnt(4)
v_mfma_f32_16x16x32_bf16 v[88:91], v[28:31], v[60:63], v[88:91]
v_add_u32 v25, s20, v20
v_mfma_f32_16x16x32_bf16 v[116:119], v[28:31], v[64:67], v[116:119]
ds_read_b64_tr_b16 v[40:41], v25 offset:0
ds_read_b64_tr_b16 v[42:43], v25 offset:2048
v_mfma_f32_16x16x32_bf16 v[144:147], v[28:31], v[68:71], v[144:147]
s_add_u32 s20, s20, 25600
v_mfma_f32_16x16x32_bf16 v[172:175], v[28:31], v[72:75], v[172:175]
s_cmp_ge_u32 s20, 143360
s_cselect_b32 s20, 0, s20
s_waitcnt lgkmcnt(4)
v_mfma_f32_16x16x32_bf16 v[92:95], v[32:35], v[60:63], v[92:95]
v_mfma_f32_16x16x32_bf16 v[120:123], v[32:35], v[64:67], v[120:123]
v_mfma_f32_16x16x32_bf16 v[148:151], v[32:35], v[68:71], v[148:151]
v_mfma_f32_16x16x32_bf16 v[176:179], v[32:35], v[72:75], v[176:179]
s_waitcnt lgkmcnt(2)
v_mfma_f32_16x16x32_bf16 v[96:99], v[36:39], v[60:63], v[96:99]
v_mfma_f32_16x16x32_bf16 v[124:127], v[36:39], v[64:67], v[124:127]
v_mfma_f32_16x16x32_bf16 v[152:155], v[36:39], v[68:71], v[152:155]
v_mfma_f32_16x16x32_bf16 v[180:183], v[36:39], v[72:75], v[180:183]
s_waitcnt lgkmcnt(0)
v_mfma_f32_16x16x32_bf16 v[100:103], v[40:43], v[60:63], v[100:103]
v_mfma_f32_16x16x32_bf16 v[128:131], v[40:43], v[64:67], v[128:131]
v_mfma_f32_16x16x32_bf16 v[156:159], v[40:43], v[68:71], v[156:159]
v_mfma_f32_16x16x32_bf16 v[184:187], v[40:43], v[72:75], v[184:187]
ds_read_b64 v[248:249], v5 offset:0
ds_read_b64 v[250:251], v5 offset:128
ds_read_b64 v[252:253], v5 offset:256
ds_read_b64 v[254:255], v5 offset:384
ds_read_b128 v[220:223], v3 offset:0
ds_read_b128 v[224:227], v3 offset:64
ds_read_b128 v[228:231], v3 offset:128
ds_read_b128 v[232:235], v3 offset:192
ds_read_b128 v[236:239], v3 offset:256
ds_read_b128 v[240:243], v3 offset:320
ds_read_b128 v[244:247], v4
s_lshl_b32 s21, s16, 1
v_lshrrev_b32 v2, 2, v0
v_lshlrev_b32 v3, 7, v2
v_and_b32 v4, 3, v0
v_lshl_add_u32 v3, v4, 3, v3
v_bfe_u32 v2, v0, 3, 2
s_and_b32 s19, 0, 3
v_xor_b32 v4, s19, v2
v_lshl_add_u32 v4, v4, 5, v3
s_lshr_b32 s19, 0, 2
s_mul_i32 s19, s19, 8192
v_add_u32 v16, s19, v4
s_and_b32 s19, 1, 3
v_xor_b32 v4, s19, v2
v_lshl_add_u32 v4, v4, 5, v3
s_lshr_b32 s19, 1, 2
s_mul_i32 s19, s19, 8192
v_add_u32 v17, s19, v4
s_and_b32 s19, 2, 3
v_xor_b32 v4, s19, v2
v_lshl_add_u32 v4, v4, 5, v3
s_lshr_b32 s19, 2, 2
s_mul_i32 s19, s19, 8192
v_add_u32 v18, s19, v4
s_and_b32 s19, 3, 3
v_xor_b32 v4, s19, v2
v_lshl_add_u32 v4, v4, 5, v3
s_lshr_b32 s19, 3, 2
s_mul_i32 s19, s19, 8192
v_add_u32 v19, s19, v4
s_lshl_b32 s19, s21, 10
s_add_u32 s19, s19, 8192
v_lshl_add_u32 v6, v0, 4, s19
s_waitcnt lgkmcnt(0)
v_pk_fma_f32 v[76:77], v[220:221], v[248:249], v[76:77] op_sel_hi:[1,0,1]
v_pk_fma_f32 v[78:79], v[222:223], v[248:249], v[78:79] op_sel_hi:[1,0,1]
v_pk_fma_f32 v[80:81], v[224:225], v[248:249], v[80:81] op_sel_hi:[1,0,1]
v_pk_fma_f32 v[82:83], v[226:227], v[248:249], v[82:83] op_sel_hi:[1,0,1]
v_pk_fma_f32 v[84:85], v[228:229], v[248:249], v[84:85] op_sel_hi:[1,0,1]
v_pk_fma_f32 v[86:87], v[230:231], v[248:249], v[86:87] op_sel_hi:[1,0,1]
v_pk_fma_f32 v[88:89], v[232:233], v[248:249], v[88:89] op_sel_hi:[1,0,1]
v_pk_fma_f32 v[90:91], v[234:235], v[248:249], v[90:91] op_sel_hi:[1,0,1]
v_pk_fma_f32 v[92:93], v[236:237], v[248:249], v[92:93] op_sel_hi:[1,0,1]
v_pk_fma_f32 v[94:95], v[238:239], v[248:249], v[94:95] op_sel_hi:[1,0,1]
v_pk_fma_f32 v[96:97], v[240:241], v[248:249], v[96:97] op_sel_hi:[1,0,1]
v_pk_fma_f32 v[98:99], v[242:243], v[248:249], v[98:99] op_sel_hi:[1,0,1]
v_pk_fma_f32 v[100:101], v[244:245], v[248:249], v[100:101] op_sel_hi:[1,0,1]
v_pk_fma_f32 v[102:103], v[246:247], v[248:249], v[102:103] op_sel_hi:[1,0,1]
v_pk_mul_f32 v[76:77], v[76:77], v[248:249] op_sel:[0,1] op_sel_hi:[1,1]
v_pk_mul_f32 v[78:79], v[78:79], v[248:249] op_sel:[0,1] op_sel_hi:[1,1]
v_pk_mul_f32 v[80:81], v[80:81], v[248:249] op_sel:[0,1] op_sel_hi:[1,1]
v_pk_mul_f32 v[82:83], v[82:83], v[248:249] op_sel:[0,1] op_sel_hi:[1,1]
v_pk_mul_f32 v[84:85], v[84:85], v[248:249] op_sel:[0,1] op_sel_hi:[1,1]
v_pk_mul_f32 v[86:87], v[86:87], v[248:249] op_sel:[0,1] op_sel_hi:[1,1]
v_pk_mul_f32 v[88:89], v[88:89], v[248:249] op_sel:[0,1] op_sel_hi:[1,1]
v_pk_mul_f32 v[90:91], v[90:91], v[248:249] op_sel:[0,1] op_sel_hi:[1,1]
v_pk_mul_f32 v[92:93], v[92:93], v[248:249] op_sel:[0,1] op_sel_hi:[1,1]
v_pk_mul_f32 v[94:95], v[94:95], v[248:249] op_sel:[0,1] op_sel_hi:[1,1]
v_pk_mul_f32 v[96:97], v[96:97], v[248:249] op_sel:[0,1] op_sel_hi:[1,1]
v_pk_mul_f32 v[98:99], v[98:99], v[248:249] op_sel:[0,1] op_sel_hi:[1,1]
v_pk_mul_f32 v[100:101], v[100:101], v[248:249] op_sel:[0,1] op_sel_hi:[1,1]
v_pk_mul_f32 v[102:103], v[102:103], v[248:249] op_sel:[0,1] op_sel_hi:[1,1]
v_pk_mul_f32 v[28:29], v[76:77], v[76:77]
v_pk_mul_f32 v[30:31], v[78:79], v[78:79]
v_pk_mul_f32 v[32:33], v[80:81], v[80:81]
v_pk_mul_f32 v[34:35], v[82:83], v[82:83]
v_pk_mul_f32 v[36:37], v[84:85], v[84:85]
v_pk_mul_f32 v[38:39], v[86:87], v[86:87]
v_pk_mul_f32 v[40:41], v[88:89], v[88:89]
v_pk_mul_f32 v[42:43], v[90:91], v[90:91]
v_pk_mul_f32 v[44:45], v[92:93], v[92:93]
v_pk_mul_f32 v[46:47], v[94:95], v[94:95]
v_pk_mul_f32 v[48:49], v[96:97], v[96:97]
v_pk_mul_f32 v[50:51], v[98:99], v[98:99]
v_pk_mul_f32 v[52:53], v[100:101], v[100:101]
v_pk_mul_f32 v[54:55], v[102:103], v[102:103]
v_pk_fma_f32 v[28:29], v[28:29], s[42:43], v[14:15]
v_pk_fma_f32 v[30:31], v[30:31], s[42:43], v[14:15]
v_pk_fma_f32 v[32:33], v[32:33], s[42:43], v[14:15]
v_pk_fma_f32 v[34:35], v[34:35], s[42:43], v[14:15]
v_pk_fma_f32 v[36:37], v[36:37], s[42:43], v[14:15]
v_pk_fma_f32 v[38:39], v[38:39], s[42:43], v[14:15]
v_pk_fma_f32 v[40:41], v[40:41], s[42:43], v[14:15]
v_pk_fma_f32 v[42:43], v[42:43], s[42:43], v[14:15]
v_pk_fma_f32 v[44:45], v[44:45], s[42:43], v[14:15]
v_pk_fma_f32 v[46:47], v[46:47], s[42:43], v[14:15]
v_pk_fma_f32 v[48:49], v[48:49], s[42:43], v[14:15]
v_pk_fma_f32 v[50:51], v[50:51], s[42:43], v[14:15]
v_pk_fma_f32 v[52:53], v[52:53], s[42:43], v[14:15]
v_pk_fma_f32 v[54:55], v[54:55], s[42:43], v[14:15]
v_pk_mul_f32 v[28:29], v[28:29], v[76:77]
v_pk_mul_f32 v[30:31], v[30:31], v[78:79]
v_pk_mul_f32 v[32:33], v[32:33], v[80:81]
v_pk_mul_f32 v[34:35], v[34:35], v[82:83]
v_pk_mul_f32 v[36:37], v[36:37], v[84:85]
v_pk_mul_f32 v[38:39], v[38:39], v[86:87]
v_pk_mul_f32 v[40:41], v[40:41], v[88:89]
v_pk_mul_f32 v[42:43], v[42:43], v[90:91]
v_pk_mul_f32 v[44:45], v[44:45], v[92:93]
v_pk_mul_f32 v[46:47], v[46:47], v[94:95]
v_pk_mul_f32 v[48:49], v[48:49], v[96:97]
v_pk_mul_f32 v[50:51], v[50:51], v[98:99]
v_pk_mul_f32 v[52:53], v[52:53], v[100:101]
v_pk_mul_f32 v[54:55], v[54:55], v[102:103]
v_exp_f32 v28, v28
v_exp_f32 v29, v29
v_exp_f32 v30, v30
v_exp_f32 v31, v31
v_exp_f32 v32, v32
v_exp_f32 v33, v33
v_exp_f32 v34, v34
v_exp_f32 v35, v35
v_exp_f32 v36, v36
v_exp_f32 v37, v37
v_exp_f32 v38, v38
v_exp_f32 v39, v39
v_exp_f32 v40, v40
v_exp_f32 v41, v41
v_exp_f32 v42, v42
v_exp_f32 v43, v43
v_exp_f32 v44, v44
v_exp_f32 v45, v45
v_exp_f32 v46, v46
v_exp_f32 v47, v47
v_exp_f32 v48, v48
v_exp_f32 v49, v49
v_exp_f32 v50, v50
v_exp_f32 v51, v51
v_exp_f32 v52, v52
v_exp_f32 v53, v53
v_exp_f32 v54, v54
v_exp_f32 v55, v55
v_pk_add_f32 v[28:29], v[28:29], 1.0 op_sel_hi:[1,0]
v_pk_add_f32 v[30:31], v[30:31], 1.0 op_sel_hi:[1,0]
v_pk_add_f32 v[32:33], v[32:33], 1.0 op_sel_hi:[1,0]
v_pk_add_f32 v[34:35], v[34:35], 1.0 op_sel_hi:[1,0]
v_pk_add_f32 v[36:37], v[36:37], 1.0 op_sel_hi:[1,0]
v_pk_add_f32 v[38:39], v[38:39], 1.0 op_sel_hi:[1,0]
v_pk_add_f32 v[40:41], v[40:41], 1.0 op_sel_hi:[1,0]
v_pk_add_f32 v[42:43], v[42:43], 1.0 op_sel_hi:[1,0]
v_pk_add_f32 v[44:45], v[44:45], 1.0 op_sel_hi:[1,0]
v_pk_add_f32 v[46:47], v[46:47], 1.0 op_sel_hi:[1,0]
v_pk_add_f32 v[48:49], v[48:49], 1.0 op_sel_hi:[1,0]
v_pk_add_f32 v[50:51], v[50:51], 1.0 op_sel_hi:[1,0]
v_pk_add_f32 v[52:53], v[52:53], 1.0 op_sel_hi:[1,0]
v_pk_add_f32 v[54:55], v[54:55], 1.0 op_sel_hi:[1,0]
v_rcp_f32 v28, v28
v_rcp_f32 v29, v29
v_rcp_f32 v30, v30
v_rcp_f32 v31, v31
v_rcp_f32 v32, v32
v_rcp_f32 v33, v33
v_rcp_f32 v34, v34
v_rcp_f32 v35, v35
v_rcp_f32 v36, v36
v_rcp_f32 v37, v37
v_rcp_f32 v38, v38
v_rcp_f32 v39, v39
v_rcp_f32 v40, v40
v_rcp_f32 v41, v41
v_rcp_f32 v42, v42
v_rcp_f32 v43, v43
v_rcp_f32 v44, v44
v_rcp_f32 v45, v45
v_rcp_f32 v46, v46
v_rcp_f32 v47, v47
v_rcp_f32 v48, v48
v_rcp_f32 v49, v49
v_rcp_f32 v50, v50
v_rcp_f32 v51, v51
v_rcp_f32 v52, v52
v_rcp_f32 v53, v53
v_rcp_f32 v54, v54
v_rcp_f32 v55, v55
v_pk_mul_f32 v[76:77], v[76:77], v[28:29]
v_pk_mul_f32 v[78:79], v[78:79], v[30:31]
v_pk_mul_f32 v[80:81], v[80:81], v[32:33]
v_pk_mul_f32 v[82:83], v[82:83], v[34:35]
v_pk_mul_f32 v[84:85], v[84:85], v[36:37]
v_pk_mul_f32 v[86:87], v[86:87], v[38:39]
v_pk_mul_f32 v[88:89], v[88:89], v[40:41]
v_pk_mul_f32 v[90:91], v[90:91], v[42:43]
v_pk_mul_f32 v[92:93], v[92:93], v[44:45]
v_pk_mul_f32 v[94:95], v[94:95], v[46:47]
v_pk_mul_f32 v[96:97], v[96:97], v[48:49]
v_pk_mul_f32 v[98:99], v[98:99], v[50:51]
v_pk_mul_f32 v[100:101], v[100:101], v[52:53]
v_pk_mul_f32 v[102:103], v[102:103], v[54:55]
v_cvt_pk_bf16_f32 v76, v76, v77
v_cvt_pk_bf16_f32 v77, v78, v79
v_cvt_pk_bf16_f32 v78, v80, v81
v_cvt_pk_bf16_f32 v79, v82, v83
v_cvt_pk_bf16_f32 v80, v84, v85
v_cvt_pk_bf16_f32 v81, v86, v87
v_cvt_pk_bf16_f32 v82, v88, v89
v_cvt_pk_bf16_f32 v83, v90, v91
v_cvt_pk_bf16_f32 v84, v92, v93
v_cvt_pk_bf16_f32 v85, v94, v95
v_cvt_pk_bf16_f32 v86, v96, v97
v_cvt_pk_bf16_f32 v87, v98, v99
v_cvt_pk_bf16_f32 v88, v100, v101
v_cvt_pk_bf16_f32 v89, v102, v103
buffer_store_dwordx4 v[76:79], v12, s[4:7], s34 offen offset:0 sc1
buffer_store_dwordx4 v[80:83], v12, s[4:7], s35 offen offset:0 sc1
buffer_store_dwordx4 v[84:87], v12, s[4:7], s36 offen offset:0 sc1
buffer_store_dwordx2 v[88:89], v12, s[4:7], s38 offen offset:0 sc1
v_pk_fma_f32 v[104:105], v[220:221], v[250:251], v[104:105] op_sel_hi:[1,0,1]
v_pk_fma_f32 v[106:107], v[222:223], v[250:251], v[106:107] op_sel_hi:[1,0,1]
v_pk_fma_f32 v[108:109], v[224:225], v[250:251], v[108:109] op_sel_hi:[1,0,1]
v_pk_fma_f32 v[110:111], v[226:227], v[250:251], v[110:111] op_sel_hi:[1,0,1]
v_pk_fma_f32 v[112:113], v[228:229], v[250:251], v[112:113] op_sel_hi:[1,0,1]
v_pk_fma_f32 v[114:115], v[230:231], v[250:251], v[114:115] op_sel_hi:[1,0,1]
v_pk_fma_f32 v[116:117], v[232:233], v[250:251], v[116:117] op_sel_hi:[1,0,1]
v_pk_fma_f32 v[118:119], v[234:235], v[250:251], v[118:119] op_sel_hi:[1,0,1]
v_pk_fma_f32 v[120:121], v[236:237], v[250:251], v[120:121] op_sel_hi:[1,0,1]
v_pk_fma_f32 v[122:123], v[238:239], v[250:251], v[122:123] op_sel_hi:[1,0,1]
v_pk_fma_f32 v[124:125], v[240:241], v[250:251], v[124:125] op_sel_hi:[1,0,1]
v_pk_fma_f32 v[126:127], v[242:243], v[250:251], v[126:127] op_sel_hi:[1,0,1]
v_pk_fma_f32 v[128:129], v[244:245], v[250:251], v[128:129] op_sel_hi:[1,0,1]
v_pk_fma_f32 v[130:131], v[246:247], v[250:251], v[130:131] op_sel_hi:[1,0,1]
v_pk_mul_f32 v[104:105], v[104:105], v[250:251] op_sel:[0,1] op_sel_hi:[1,1]
v_pk_mul_f32 v[106:107], v[106:107], v[250:251] op_sel:[0,1] op_sel_hi:[1,1]
v_pk_mul_f32 v[108:109], v[108:109], v[250:251] op_sel:[0,1] op_sel_hi:[1,1]
v_pk_mul_f32 v[110:111], v[110:111], v[250:251] op_sel:[0,1] op_sel_hi:[1,1]
v_pk_mul_f32 v[112:113], v[112:113], v[250:251] op_sel:[0,1] op_sel_hi:[1,1]
v_pk_mul_f32 v[114:115], v[114:115], v[250:251] op_sel:[0,1] op_sel_hi:[1,1]
v_pk_mul_f32 v[116:117], v[116:117], v[250:251] op_sel:[0,1] op_sel_hi:[1,1]
v_pk_mul_f32 v[118:119], v[118:119], v[250:251] op_sel:[0,1] op_sel_hi:[1,1]
v_pk_mul_f32 v[120:121], v[120:121], v[250:251] op_sel:[0,1] op_sel_hi:[1,1]
v_pk_mul_f32 v[122:123], v[122:123], v[250:251] op_sel:[0,1] op_sel_hi:[1,1]
v_pk_mul_f32 v[124:125], v[124:125], v[250:251] op_sel:[0,1] op_sel_hi:[1,1]
v_pk_mul_f32 v[126:127], v[126:127], v[250:251] op_sel:[0,1] op_sel_hi:[1,1]
v_pk_mul_f32 v[128:129], v[128:129], v[250:251] op_sel:[0,1] op_sel_hi:[1,1]
v_pk_mul_f32 v[130:131], v[130:131], v[250:251] op_sel:[0,1] op_sel_hi:[1,1]
v_pk_mul_f32 v[28:29], v[104:105], v[104:105]
v_pk_mul_f32 v[30:31], v[106:107], v[106:107]
v_pk_mul_f32 v[32:33], v[108:109], v[108:109]
v_pk_mul_f32 v[34:35], v[110:111], v[110:111]
v_pk_mul_f32 v[36:37], v[112:113], v[112:113]
v_pk_mul_f32 v[38:39], v[114:115], v[114:115]
v_pk_mul_f32 v[40:41], v[116:117], v[116:117]
v_pk_mul_f32 v[42:43], v[118:119], v[118:119]
v_pk_mul_f32 v[44:45], v[120:121], v[120:121]
v_pk_mul_f32 v[46:47], v[122:123], v[122:123]
v_pk_mul_f32 v[48:49], v[124:125], v[124:125]
v_pk_mul_f32 v[50:51], v[126:127], v[126:127]
v_pk_mul_f32 v[52:53], v[128:129], v[128:129]
v_pk_mul_f32 v[54:55], v[130:131], v[130:131]
v_pk_fma_f32 v[28:29], v[28:29], s[42:43], v[14:15]
v_pk_fma_f32 v[30:31], v[30:31], s[42:43], v[14:15]
v_pk_fma_f32 v[32:33], v[32:33], s[42:43], v[14:15]
v_pk_fma_f32 v[34:35], v[34:35], s[42:43], v[14:15]
v_pk_fma_f32 v[36:37], v[36:37], s[42:43], v[14:15]
v_pk_fma_f32 v[38:39], v[38:39], s[42:43], v[14:15]
v_pk_fma_f32 v[40:41], v[40:41], s[42:43], v[14:15]
v_pk_fma_f32 v[42:43], v[42:43], s[42:43], v[14:15]
v_pk_fma_f32 v[44:45], v[44:45], s[42:43], v[14:15]
v_pk_fma_f32 v[46:47], v[46:47], s[42:43], v[14:15]
v_pk_fma_f32 v[48:49], v[48:49], s[42:43], v[14:15]
v_pk_fma_f32 v[50:51], v[50:51], s[42:43], v[14:15]
v_pk_fma_f32 v[52:53], v[52:53], s[42:43], v[14:15]
v_pk_fma_f32 v[54:55], v[54:55], s[42:43], v[14:15]
v_pk_mul_f32 v[28:29], v[28:29], v[104:105]
v_pk_mul_f32 v[30:31], v[30:31], v[106:107]
v_pk_mul_f32 v[32:33], v[32:33], v[108:109]
v_pk_mul_f32 v[34:35], v[34:35], v[110:111]
v_pk_mul_f32 v[36:37], v[36:37], v[112:113]
v_pk_mul_f32 v[38:39], v[38:39], v[114:115]
v_pk_mul_f32 v[40:41], v[40:41], v[116:117]
v_pk_mul_f32 v[42:43], v[42:43], v[118:119]
v_pk_mul_f32 v[44:45], v[44:45], v[120:121]
v_pk_mul_f32 v[46:47], v[46:47], v[122:123]
v_pk_mul_f32 v[48:49], v[48:49], v[124:125]
v_pk_mul_f32 v[50:51], v[50:51], v[126:127]
v_pk_mul_f32 v[52:53], v[52:53], v[128:129]
v_pk_mul_f32 v[54:55], v[54:55], v[130:131]
v_exp_f32 v28, v28
v_exp_f32 v29, v29
v_exp_f32 v30, v30
v_exp_f32 v31, v31
v_exp_f32 v32, v32
v_exp_f32 v33, v33
v_exp_f32 v34, v34
v_exp_f32 v35, v35
v_exp_f32 v36, v36
v_exp_f32 v37, v37
v_exp_f32 v38, v38
v_exp_f32 v39, v39
v_exp_f32 v40, v40
v_exp_f32 v41, v41
v_exp_f32 v42, v42
v_exp_f32 v43, v43
v_exp_f32 v44, v44
v_exp_f32 v45, v45
v_exp_f32 v46, v46
v_exp_f32 v47, v47
v_exp_f32 v48, v48
v_exp_f32 v49, v49
v_exp_f32 v50, v50
v_exp_f32 v51, v51
v_exp_f32 v52, v52
v_exp_f32 v53, v53
v_exp_f32 v54, v54
v_exp_f32 v55, v55
v_pk_add_f32 v[28:29], v[28:29], 1.0 op_sel_hi:[1,0]
v_pk_add_f32 v[30:31], v[30:31], 1.0 op_sel_hi:[1,0]
v_pk_add_f32 v[32:33], v[32:33], 1.0 op_sel_hi:[1,0]
v_pk_add_f32 v[34:35], v[34:35], 1.0 op_sel_hi:[1,0]
v_pk_add_f32 v[36:37], v[36:37], 1.0 op_sel_hi:[1,0]
v_pk_add_f32 v[38:39], v[38:39], 1.0 op_sel_hi:[1,0]
v_pk_add_f32 v[40:41], v[40:41], 1.0 op_sel_hi:[1,0]
v_pk_add_f32 v[42:43], v[42:43], 1.0 op_sel_hi:[1,0]
v_pk_add_f32 v[44:45], v[44:45], 1.0 op_sel_hi:[1,0]
v_pk_add_f32 v[46:47], v[46:47], 1.0 op_sel_hi:[1,0]
v_pk_add_f32 v[48:49], v[48:49], 1.0 op_sel_hi:[1,0]
v_pk_add_f32 v[50:51], v[50:51], 1.0 op_sel_hi:[1,0]
v_pk_add_f32 v[52:53], v[52:53], 1.0 op_sel_hi:[1,0]
v_pk_add_f32 v[54:55], v[54:55], 1.0 op_sel_hi:[1,0]
v_rcp_f32 v28, v28
v_rcp_f32 v29, v29
v_rcp_f32 v30, v30
v_rcp_f32 v31, v31
v_rcp_f32 v32, v32
v_rcp_f32 v33, v33
v_rcp_f32 v34, v34
v_rcp_f32 v35, v35
v_rcp_f32 v36, v36
v_rcp_f32 v37, v37
v_rcp_f32 v38, v38
v_rcp_f32 v39, v39
v_rcp_f32 v40, v40
v_rcp_f32 v41, v41
v_rcp_f32 v42, v42
v_rcp_f32 v43, v43
v_rcp_f32 v44, v44
v_rcp_f32 v45, v45
v_rcp_f32 v46, v46
v_rcp_f32 v47, v47
v_rcp_f32 v48, v48
v_rcp_f32 v49, v49
v_rcp_f32 v50, v50
v_rcp_f32 v51, v51
v_rcp_f32 v52, v52
v_rcp_f32 v53, v53
v_rcp_f32 v54, v54
v_rcp_f32 v55, v55
v_pk_mul_f32 v[104:105], v[104:105], v[28:29]
v_pk_mul_f32 v[106:107], v[106:107], v[30:31]
v_pk_mul_f32 v[108:109], v[108:109], v[32:33]
v_pk_mul_f32 v[110:111], v[110:111], v[34:35]
v_pk_mul_f32 v[112:113], v[112:113], v[36:37]
v_pk_mul_f32 v[114:115], v[114:115], v[38:39]
v_pk_mul_f32 v[116:117], v[116:117], v[40:41]
v_pk_mul_f32 v[118:119], v[118:119], v[42:43]
v_pk_mul_f32 v[120:121], v[120:121], v[44:45]
v_pk_mul_f32 v[122:123], v[122:123], v[46:47]
v_pk_mul_f32 v[124:125], v[124:125], v[48:49]
v_pk_mul_f32 v[126:127], v[126:127], v[50:51]
v_pk_mul_f32 v[128:129], v[128:129], v[52:53]
v_pk_mul_f32 v[130:131], v[130:131], v[54:55]
v_cvt_pk_bf16_f32 v104, v104, v105
v_cvt_pk_bf16_f32 v105, v106, v107
v_cvt_pk_bf16_f32 v106, v108, v109
v_cvt_pk_bf16_f32 v107, v110, v111
v_cvt_pk_bf16_f32 v108, v112, v113
v_cvt_pk_bf16_f32 v109, v114, v115
v_cvt_pk_bf16_f32 v110, v116, v117
v_cvt_pk_bf16_f32 v111, v118, v119
v_cvt_pk_bf16_f32 v112, v120, v121
v_cvt_pk_bf16_f32 v113, v122, v123
v_cvt_pk_bf16_f32 v114, v124, v125
v_cvt_pk_bf16_f32 v115, v126, v127
v_cvt_pk_bf16_f32 v116, v128, v129
v_cvt_pk_bf16_f32 v117, v130, v131
buffer_store_dwordx4 v[104:107], v12, s[4:7], s34 offen offset:1024 sc1
buffer_store_dwordx4 v[108:111], v12, s[4:7], s35 offen offset:1024 sc1
buffer_store_dwordx4 v[112:115], v12, s[4:7], s36 offen offset:1024 sc1
buffer_store_dwordx2 v[116:117], v12, s[4:7], s38 offen offset:1024 sc1
v_pk_fma_f32 v[132:133], v[220:221], v[252:253], v[132:133] op_sel_hi:[1,0,1]
v_pk_fma_f32 v[134:135], v[222:223], v[252:253], v[134:135] op_sel_hi:[1,0,1]
v_pk_fma_f32 v[136:137], v[224:225], v[252:253], v[136:137] op_sel_hi:[1,0,1]
v_pk_fma_f32 v[138:139], v[226:227], v[252:253], v[138:139] op_sel_hi:[1,0,1]
v_pk_fma_f32 v[140:141], v[228:229], v[252:253], v[140:141] op_sel_hi:[1,0,1]
v_pk_fma_f32 v[142:143], v[230:231], v[252:253], v[142:143] op_sel_hi:[1,0,1]
v_pk_fma_f32 v[144:145], v[232:233], v[252:253], v[144:145] op_sel_hi:[1,0,1]
v_pk_fma_f32 v[146:147], v[234:235], v[252:253], v[146:147] op_sel_hi:[1,0,1]
v_pk_fma_f32 v[148:149], v[236:237], v[252:253], v[148:149] op_sel_hi:[1,0,1]
v_pk_fma_f32 v[150:151], v[238:239], v[252:253], v[150:151] op_sel_hi:[1,0,1]
v_pk_fma_f32 v[152:153], v[240:241], v[252:253], v[152:153] op_sel_hi:[1,0,1]
v_pk_fma_f32 v[154:155], v[242:243], v[252:253], v[154:155] op_sel_hi:[1,0,1]
v_pk_fma_f32 v[156:157], v[244:245], v[252:253], v[156:157] op_sel_hi:[1,0,1]
v_pk_fma_f32 v[158:159], v[246:247], v[252:253], v[158:159] op_sel_hi:[1,0,1]
v_pk_mul_f32 v[132:133], v[132:133], v[252:253] op_sel:[0,1] op_sel_hi:[1,1]
v_pk_mul_f32 v[134:135], v[134:135], v[252:253] op_sel:[0,1] op_sel_hi:[1,1]
v_pk_mul_f32 v[136:137], v[136:137], v[252:253] op_sel:[0,1] op_sel_hi:[1,1]
v_pk_mul_f32 v[138:139], v[138:139], v[252:253] op_sel:[0,1] op_sel_hi:[1,1]
v_pk_mul_f32 v[140:141], v[140:141], v[252:253] op_sel:[0,1] op_sel_hi:[1,1]
v_pk_mul_f32 v[142:143], v[142:143], v[252:253] op_sel:[0,1] op_sel_hi:[1,1]
v_pk_mul_f32 v[144:145], v[144:145], v[252:253] op_sel:[0,1] op_sel_hi:[1,1]
v_pk_mul_f32 v[146:147], v[146:147], v[252:253] op_sel:[0,1] op_sel_hi:[1,1]
v_pk_mul_f32 v[148:149], v[148:149], v[252:253] op_sel:[0,1] op_sel_hi:[1,1]
v_pk_mul_f32 v[150:151], v[150:151], v[252:253] op_sel:[0,1] op_sel_hi:[1,1]
v_pk_mul_f32 v[152:153], v[152:153], v[252:253] op_sel:[0,1] op_sel_hi:[1,1]
v_pk_mul_f32 v[154:155], v[154:155], v[252:253] op_sel:[0,1] op_sel_hi:[1,1]
v_pk_mul_f32 v[156:157], v[156:157], v[252:253] op_sel:[0,1] op_sel_hi:[1,1]
v_pk_mul_f32 v[158:159], v[158:159], v[252:253] op_sel:[0,1] op_sel_hi:[1,1]
v_pk_mul_f32 v[28:29], v[132:133], v[132:133]
v_pk_mul_f32 v[30:31], v[134:135], v[134:135]
v_pk_mul_f32 v[32:33], v[136:137], v[136:137]
v_pk_mul_f32 v[34:35], v[138:139], v[138:139]
v_pk_mul_f32 v[36:37], v[140:141], v[140:141]
v_pk_mul_f32 v[38:39], v[142:143], v[142:143]
v_pk_mul_f32 v[40:41], v[144:145], v[144:145]
v_pk_mul_f32 v[42:43], v[146:147], v[146:147]
v_pk_mul_f32 v[44:45], v[148:149], v[148:149]
v_pk_mul_f32 v[46:47], v[150:151], v[150:151]
v_pk_mul_f32 v[48:49], v[152:153], v[152:153]
v_pk_mul_f32 v[50:51], v[154:155], v[154:155]
v_pk_mul_f32 v[52:53], v[156:157], v[156:157]
v_pk_mul_f32 v[54:55], v[158:159], v[158:159]
v_pk_fma_f32 v[28:29], v[28:29], s[42:43], v[14:15]
v_pk_fma_f32 v[30:31], v[30:31], s[42:43], v[14:15]
v_pk_fma_f32 v[32:33], v[32:33], s[42:43], v[14:15]
v_pk_fma_f32 v[34:35], v[34:35], s[42:43], v[14:15]
v_pk_fma_f32 v[36:37], v[36:37], s[42:43], v[14:15]
v_pk_fma_f32 v[38:39], v[38:39], s[42:43], v[14:15]
v_pk_fma_f32 v[40:41], v[40:41], s[42:43], v[14:15]
v_pk_fma_f32 v[42:43], v[42:43], s[42:43], v[14:15]
v_pk_fma_f32 v[44:45], v[44:45], s[42:43], v[14:15]
v_pk_fma_f32 v[46:47], v[46:47], s[42:43], v[14:15]
v_pk_fma_f32 v[48:49], v[48:49], s[42:43], v[14:15]
v_pk_fma_f32 v[50:51], v[50:51], s[42:43], v[14:15]
v_pk_fma_f32 v[52:53], v[52:53], s[42:43], v[14:15]
v_pk_fma_f32 v[54:55], v[54:55], s[42:43], v[14:15]
v_pk_mul_f32 v[28:29], v[28:29], v[132:133]
v_pk_mul_f32 v[30:31], v[30:31], v[134:135]
v_pk_mul_f32 v[32:33], v[32:33], v[136:137]
v_pk_mul_f32 v[34:35], v[34:35], v[138:139]
v_pk_mul_f32 v[36:37], v[36:37], v[140:141]
v_pk_mul_f32 v[38:39], v[38:39], v[142:143]
v_pk_mul_f32 v[40:41], v[40:41], v[144:145]
v_pk_mul_f32 v[42:43], v[42:43], v[146:147]
v_pk_mul_f32 v[44:45], v[44:45], v[148:149]
v_pk_mul_f32 v[46:47], v[46:47], v[150:151]
v_pk_mul_f32 v[48:49], v[48:49], v[152:153]
v_pk_mul_f32 v[50:51], v[50:51], v[154:155]
v_pk_mul_f32 v[52:53], v[52:53], v[156:157]
v_pk_mul_f32 v[54:55], v[54:55], v[158:159]
v_exp_f32 v28, v28
v_exp_f32 v29, v29
v_exp_f32 v30, v30
v_exp_f32 v31, v31
v_exp_f32 v32, v32
v_exp_f32 v33, v33
v_exp_f32 v34, v34
v_exp_f32 v35, v35
v_exp_f32 v36, v36
v_exp_f32 v37, v37
v_exp_f32 v38, v38
v_exp_f32 v39, v39
v_exp_f32 v40, v40
v_exp_f32 v41, v41
v_exp_f32 v42, v42
v_exp_f32 v43, v43
v_exp_f32 v44, v44
v_exp_f32 v45, v45
v_exp_f32 v46, v46
v_exp_f32 v47, v47
v_exp_f32 v48, v48
v_exp_f32 v49, v49
v_exp_f32 v50, v50
v_exp_f32 v51, v51
v_exp_f32 v52, v52
v_exp_f32 v53, v53
v_exp_f32 v54, v54
v_exp_f32 v55, v55
v_pk_add_f32 v[28:29], v[28:29], 1.0 op_sel_hi:[1,0]
v_pk_add_f32 v[30:31], v[30:31], 1.0 op_sel_hi:[1,0]
v_pk_add_f32 v[32:33], v[32:33], 1.0 op_sel_hi:[1,0]
v_pk_add_f32 v[34:35], v[34:35], 1.0 op_sel_hi:[1,0]
v_pk_add_f32 v[36:37], v[36:37], 1.0 op_sel_hi:[1,0]
v_pk_add_f32 v[38:39], v[38:39], 1.0 op_sel_hi:[1,0]
v_pk_add_f32 v[40:41], v[40:41], 1.0 op_sel_hi:[1,0]
v_pk_add_f32 v[42:43], v[42:43], 1.0 op_sel_hi:[1,0]
v_pk_add_f32 v[44:45], v[44:45], 1.0 op_sel_hi:[1,0]
v_pk_add_f32 v[46:47], v[46:47], 1.0 op_sel_hi:[1,0]
v_pk_add_f32 v[48:49], v[48:49], 1.0 op_sel_hi:[1,0]
v_pk_add_f32 v[50:51], v[50:51], 1.0 op_sel_hi:[1,0]
v_pk_add_f32 v[52:53], v[52:53], 1.0 op_sel_hi:[1,0]
v_pk_add_f32 v[54:55], v[54:55], 1.0 op_sel_hi:[1,0]
v_rcp_f32 v28, v28
v_rcp_f32 v29, v29
v_rcp_f32 v30, v30
v_rcp_f32 v31, v31
v_rcp_f32 v32, v32
v_rcp_f32 v33, v33
v_rcp_f32 v34, v34
v_rcp_f32 v35, v35
v_rcp_f32 v36, v36
v_rcp_f32 v37, v37
v_rcp_f32 v38, v38
v_rcp_f32 v39, v39
v_rcp_f32 v40, v40
v_rcp_f32 v41, v41
v_rcp_f32 v42, v42
v_rcp_f32 v43, v43
v_rcp_f32 v44, v44
v_rcp_f32 v45, v45
v_rcp_f32 v46, v46
v_rcp_f32 v47, v47
v_rcp_f32 v48, v48
v_rcp_f32 v49, v49
v_rcp_f32 v50, v50
v_rcp_f32 v51, v51
v_rcp_f32 v52, v52
v_rcp_f32 v53, v53
v_rcp_f32 v54, v54
v_rcp_f32 v55, v55
v_pk_mul_f32 v[132:133], v[132:133], v[28:29]
v_pk_mul_f32 v[134:135], v[134:135], v[30:31]
v_pk_mul_f32 v[136:137], v[136:137], v[32:33]
v_pk_mul_f32 v[138:139], v[138:139], v[34:35]
v_pk_mul_f32 v[140:141], v[140:141], v[36:37]
v_pk_mul_f32 v[142:143], v[142:143], v[38:39]
v_pk_mul_f32 v[144:145], v[144:145], v[40:41]
v_pk_mul_f32 v[146:147], v[146:147], v[42:43]
v_pk_mul_f32 v[148:149], v[148:149], v[44:45]
v_pk_mul_f32 v[150:151], v[150:151], v[46:47]
v_pk_mul_f32 v[152:153], v[152:153], v[48:49]
v_pk_mul_f32 v[154:155], v[154:155], v[50:51]
v_pk_mul_f32 v[156:157], v[156:157], v[52:53]
v_pk_mul_f32 v[158:159], v[158:159], v[54:55]
v_cvt_pk_bf16_f32 v132, v132, v133
v_cvt_pk_bf16_f32 v133, v134, v135
v_cvt_pk_bf16_f32 v134, v136, v137
v_cvt_pk_bf16_f32 v135, v138, v139
v_cvt_pk_bf16_f32 v136, v140, v141
v_cvt_pk_bf16_f32 v137, v142, v143
v_cvt_pk_bf16_f32 v138, v144, v145
v_cvt_pk_bf16_f32 v139, v146, v147
v_cvt_pk_bf16_f32 v140, v148, v149
v_cvt_pk_bf16_f32 v141, v150, v151
v_cvt_pk_bf16_f32 v142, v152, v153
v_cvt_pk_bf16_f32 v143, v154, v155
v_cvt_pk_bf16_f32 v144, v156, v157
v_cvt_pk_bf16_f32 v145, v158, v159
buffer_store_dwordx4 v[132:135], v12, s[4:7], s34 offen offset:2048 sc1
buffer_store_dwordx4 v[136:139], v12, s[4:7], s35 offen offset:2048 sc1
buffer_store_dwordx4 v[140:143], v12, s[4:7], s36 offen offset:2048 sc1
buffer_store_dwordx2 v[144:145], v12, s[4:7], s38 offen offset:2048 sc1
v_pk_fma_f32 v[160:161], v[220:221], v[254:255], v[160:161] op_sel_hi:[1,0,1]
v_pk_fma_f32 v[162:163], v[222:223], v[254:255], v[162:163] op_sel_hi:[1,0,1]
v_pk_fma_f32 v[164:165], v[224:225], v[254:255], v[164:165] op_sel_hi:[1,0,1]
v_pk_fma_f32 v[166:167], v[226:227], v[254:255], v[166:167] op_sel_hi:[1,0,1]
v_pk_fma_f32 v[168:169], v[228:229], v[254:255], v[168:169] op_sel_hi:[1,0,1]
v_pk_fma_f32 v[170:171], v[230:231], v[254:255], v[170:171] op_sel_hi:[1,0,1]
v_pk_fma_f32 v[172:173], v[232:233], v[254:255], v[172:173] op_sel_hi:[1,0,1]
v_pk_fma_f32 v[174:175], v[234:235], v[254:255], v[174:175] op_sel_hi:[1,0,1]
v_pk_fma_f32 v[176:177], v[236:237], v[254:255], v[176:177] op_sel_hi:[1,0,1]
v_pk_fma_f32 v[178:179], v[238:239], v[254:255], v[178:179] op_sel_hi:[1,0,1]
v_pk_fma_f32 v[180:181], v[240:241], v[254:255], v[180:181] op_sel_hi:[1,0,1]
v_pk_fma_f32 v[182:183], v[242:243], v[254:255], v[182:183] op_sel_hi:[1,0,1]
v_pk_fma_f32 v[184:185], v[244:245], v[254:255], v[184:185] op_sel_hi:[1,0,1]
v_pk_fma_f32 v[186:187], v[246:247], v[254:255], v[186:187] op_sel_hi:[1,0,1]
v_pk_mul_f32 v[160:161], v[160:161], v[254:255] op_sel:[0,1] op_sel_hi:[1,1]
v_pk_mul_f32 v[162:163], v[162:163], v[254:255] op_sel:[0,1] op_sel_hi:[1,1]
v_pk_mul_f32 v[164:165], v[164:165], v[254:255] op_sel:[0,1] op_sel_hi:[1,1]
v_pk_mul_f32 v[166:167], v[166:167], v[254:255] op_sel:[0,1] op_sel_hi:[1,1]
v_pk_mul_f32 v[168:169], v[168:169], v[254:255] op_sel:[0,1] op_sel_hi:[1,1]
v_pk_mul_f32 v[170:171], v[170:171], v[254:255] op_sel:[0,1] op_sel_hi:[1,1]
v_pk_mul_f32 v[172:173], v[172:173], v[254:255] op_sel:[0,1] op_sel_hi:[1,1]
v_pk_mul_f32 v[174:175], v[174:175], v[254:255] op_sel:[0,1] op_sel_hi:[1,1]
v_pk_mul_f32 v[176:177], v[176:177], v[254:255] op_sel:[0,1] op_sel_hi:[1,1]
v_pk_mul_f32 v[178:179], v[178:179], v[254:255] op_sel:[0,1] op_sel_hi:[1,1]
v_pk_mul_f32 v[180:181], v[180:181], v[254:255] op_sel:[0,1] op_sel_hi:[1,1]
v_pk_mul_f32 v[182:183], v[182:183], v[254:255] op_sel:[0,1] op_sel_hi:[1,1]
v_pk_mul_f32 v[184:185], v[184:185], v[254:255] op_sel:[0,1] op_sel_hi:[1,1]
v_pk_mul_f32 v[186:187], v[186:187], v[254:255] op_sel:[0,1] op_sel_hi:[1,1]
v_pk_mul_f32 v[28:29], v[160:161], v[160:161]
v_pk_mul_f32 v[30:31], v[162:163], v[162:163]
v_pk_mul_f32 v[32:33], v[164:165], v[164:165]
v_pk_mul_f32 v[34:35], v[166:167], v[166:167]
v_pk_mul_f32 v[36:37], v[168:169], v[168:169]
v_pk_mul_f32 v[38:39], v[170:171], v[170:171]
v_pk_mul_f32 v[40:41], v[172:173], v[172:173]
v_pk_mul_f32 v[42:43], v[174:175], v[174:175]
v_pk_mul_f32 v[44:45], v[176:177], v[176:177]
v_pk_mul_f32 v[46:47], v[178:179], v[178:179]
v_pk_mul_f32 v[48:49], v[180:181], v[180:181]
v_pk_mul_f32 v[50:51], v[182:183], v[182:183]
v_pk_mul_f32 v[52:53], v[184:185], v[184:185]
v_pk_mul_f32 v[54:55], v[186:187], v[186:187]
v_pk_fma_f32 v[28:29], v[28:29], s[42:43], v[14:15]
v_pk_fma_f32 v[30:31], v[30:31], s[42:43], v[14:15]
v_pk_fma_f32 v[32:33], v[32:33], s[42:43], v[14:15]
v_pk_fma_f32 v[34:35], v[34:35], s[42:43], v[14:15]
v_pk_fma_f32 v[36:37], v[36:37], s[42:43], v[14:15]
v_pk_fma_f32 v[38:39], v[38:39], s[42:43], v[14:15]
v_pk_fma_f32 v[40:41], v[40:41], s[42:43], v[14:15]
v_pk_fma_f32 v[42:43], v[42:43], s[42:43], v[14:15]
v_pk_fma_f32 v[44:45], v[44:45], s[42:43], v[14:15]
v_pk_fma_f32 v[46:47], v[46:47], s[42:43], v[14:15]
v_pk_fma_f32 v[48:49], v[48:49], s[42:43], v[14:15]
v_pk_fma_f32 v[50:51], v[50:51], s[42:43], v[14:15]
v_pk_fma_f32 v[52:53], v[52:53], s[42:43], v[14:15]
v_pk_fma_f32 v[54:55], v[54:55], s[42:43], v[14:15]
v_pk_mul_f32 v[28:29], v[28:29], v[160:161]
v_pk_mul_f32 v[30:31], v[30:31], v[162:163]
v_pk_mul_f32 v[32:33], v[32:33], v[164:165]
v_pk_mul_f32 v[34:35], v[34:35], v[166:167]
v_pk_mul_f32 v[36:37], v[36:37], v[168:169]
v_pk_mul_f32 v[38:39], v[38:39], v[170:171]
v_pk_mul_f32 v[40:41], v[40:41], v[172:173]
v_pk_mul_f32 v[42:43], v[42:43], v[174:175]
v_pk_mul_f32 v[44:45], v[44:45], v[176:177]
v_pk_mul_f32 v[46:47], v[46:47], v[178:179]
v_pk_mul_f32 v[48:49], v[48:49], v[180:181]
v_pk_mul_f32 v[50:51], v[50:51], v[182:183]
v_pk_mul_f32 v[52:53], v[52:53], v[184:185]
v_pk_mul_f32 v[54:55], v[54:55], v[186:187]
v_exp_f32 v28, v28
v_exp_f32 v29, v29
v_exp_f32 v30, v30
v_exp_f32 v31, v31
v_exp_f32 v32, v32
v_exp_f32 v33, v33
v_exp_f32 v34, v34
v_exp_f32 v35, v35
v_exp_f32 v36, v36
v_exp_f32 v37, v37
v_exp_f32 v38, v38
v_exp_f32 v39, v39
v_exp_f32 v40, v40
v_exp_f32 v41, v41
v_exp_f32 v42, v42
v_exp_f32 v43, v43
v_exp_f32 v44, v44
v_exp_f32 v45, v45
v_exp_f32 v46, v46
v_exp_f32 v47, v47
v_exp_f32 v48, v48
v_exp_f32 v49, v49
v_exp_f32 v50, v50
v_exp_f32 v51, v51
v_exp_f32 v52, v52
v_exp_f32 v53, v53
v_exp_f32 v54, v54
v_exp_f32 v55, v55
v_pk_add_f32 v[28:29], v[28:29], 1.0 op_sel_hi:[1,0]
v_pk_add_f32 v[30:31], v[30:31], 1.0 op_sel_hi:[1,0]
v_pk_add_f32 v[32:33], v[32:33], 1.0 op_sel_hi:[1,0]
v_pk_add_f32 v[34:35], v[34:35], 1.0 op_sel_hi:[1,0]
v_pk_add_f32 v[36:37], v[36:37], 1.0 op_sel_hi:[1,0]
v_pk_add_f32 v[38:39], v[38:39], 1.0 op_sel_hi:[1,0]
v_pk_add_f32 v[40:41], v[40:41], 1.0 op_sel_hi:[1,0]
v_pk_add_f32 v[42:43], v[42:43], 1.0 op_sel_hi:[1,0]
v_pk_add_f32 v[44:45], v[44:45], 1.0 op_sel_hi:[1,0]
v_pk_add_f32 v[46:47], v[46:47], 1.0 op_sel_hi:[1,0]
v_pk_add_f32 v[48:49], v[48:49], 1.0 op_sel_hi:[1,0]
v_pk_add_f32 v[50:51], v[50:51], 1.0 op_sel_hi:[1,0]
v_pk_add_f32 v[52:53], v[52:53], 1.0 op_sel_hi:[1,0]
v_pk_add_f32 v[54:55], v[54:55], 1.0 op_sel_hi:[1,0]
v_rcp_f32 v28, v28
v_rcp_f32 v29, v29
v_rcp_f32 v30, v30
v_rcp_f32 v31, v31
v_rcp_f32 v32, v32
v_rcp_f32 v33, v33
v_rcp_f32 v34, v34
v_rcp_f32 v35, v35
v_rcp_f32 v36, v36
v_rcp_f32 v37, v37
v_rcp_f32 v38, v38
v_rcp_f32 v39, v39
v_rcp_f32 v40, v40
v_rcp_f32 v41, v41
v_rcp_f32 v42, v42
v_rcp_f32 v43, v43
v_rcp_f32 v44, v44
v_rcp_f32 v45, v45
v_rcp_f32 v46, v46
v_rcp_f32 v47, v47
v_rcp_f32 v48, v48
v_rcp_f32 v49, v49
v_rcp_f32 v50, v50
v_rcp_f32 v51, v51
v_rcp_f32 v52, v52
v_rcp_f32 v53, v53
v_rcp_f32 v54, v54
v_rcp_f32 v55, v55
v_pk_mul_f32 v[160:161], v[160:161], v[28:29]
v_pk_mul_f32 v[162:163], v[162:163], v[30:31]
v_pk_mul_f32 v[164:165], v[164:165], v[32:33]
v_pk_mul_f32 v[166:167], v[166:167], v[34:35]
v_pk_mul_f32 v[168:169], v[168:169], v[36:37]
v_pk_mul_f32 v[170:171], v[170:171], v[38:39]
v_pk_mul_f32 v[172:173], v[172:173], v[40:41]
v_pk_mul_f32 v[174:175], v[174:175], v[42:43]
v_pk_mul_f32 v[176:177], v[176:177], v[44:45]
v_pk_mul_f32 v[178:179], v[178:179], v[46:47]
v_pk_mul_f32 v[180:181], v[180:181], v[48:49]
v_pk_mul_f32 v[182:183], v[182:183], v[50:51]
v_pk_mul_f32 v[184:185], v[184:185], v[52:53]
v_pk_mul_f32 v[186:187], v[186:187], v[54:55]
v_cvt_pk_bf16_f32 v160, v160, v161
v_cvt_pk_bf16_f32 v161, v162, v163
v_cvt_pk_bf16_f32 v162, v164, v165
v_cvt_pk_bf16_f32 v163, v166, v167
v_cvt_pk_bf16_f32 v164, v168, v169
v_cvt_pk_bf16_f32 v165, v170, v171
v_cvt_pk_bf16_f32 v166, v172, v173
v_cvt_pk_bf16_f32 v167, v174, v175
v_cvt_pk_bf16_f32 v168, v176, v177
v_cvt_pk_bf16_f32 v169, v178, v179
v_cvt_pk_bf16_f32 v170, v180, v181
v_cvt_pk_bf16_f32 v171, v182, v183
v_cvt_pk_bf16_f32 v172, v184, v185
v_cvt_pk_bf16_f32 v173, v186, v187
buffer_store_dwordx4 v[160:163], v12, s[4:7], s34 offen offset:3072 sc1
buffer_store_dwordx4 v[164:167], v12, s[4:7], s35 offen offset:3072 sc1
buffer_store_dwordx4 v[168:171], v12, s[4:7], s36 offen offset:3072 sc1
buffer_store_dwordx2 v[172:173], v12, s[4:7], s38 offen offset:3072 sc1
v_mov_b32 v220, 0
v_mov_b32 v221, 0
v_mov_b32 v222, 0
v_mov_b32 v223, 0
v_mov_b32 v224, 0
v_mov_b32 v225, 0
v_mov_b32 v226, 0
v_mov_b32 v227, 0
v_mov_b32 v228, 0
v_mov_b32 v229, 0
v_mov_b32 v230, 0
v_mov_b32 v231, 0
v_mov_b32 v232, 0
v_mov_b32 v233, 0
v_mov_b32 v234, 0
v_mov_b32 v235, 0
v_mov_b32 v236, 0
v_mov_b32 v237, 0
v_mov_b32 v238, 0
v_mov_b32 v239, 0
v_mov_b32 v240, 0
v_mov_b32 v241, 0
v_mov_b32 v242, 0
v_mov_b32 v243, 0
v_mov_b32 v244, 0
v_mov_b32 v245, 0
v_mov_b32 v246, 0
v_mov_b32 v247, 0
v_mov_b32 v248, 0
v_mov_b32 v249, 0
v_mov_b32 v250, 0
v_mov_b32 v251, 0
s_waitcnt lgkmcnt(0)
s_barrier
v_add_u32 v7, s20, v6
ds_read_b128 v[60:63], v7 offset:0
v_add_u32 v20, s20, v16
ds_read_b64_tr_b16 v[44:45], v20 offset:0
ds_read_b64_tr_b16 v[46:47], v20 offset:2048
ds_read_b128 v[64:67], v7 offset:1024
v_add_u32 v21, s20, v17
ds_read_b64_tr_b16 v[48:49], v21 offset:0
ds_read_b64_tr_b16 v[50:51], v21 offset:2048
v_add_u32 v22, s20, v18
ds_read_b64_tr_b16 v[52:53], v22 offset:0
ds_read_b64_tr_b16 v[54:55], v22 offset:2048
s_waitcnt lgkmcnt(5)
v_mfma_f32_16x16x32_bf16 v[188:191], v[44:47], v[60:63], v[188:191]
v_add_u32 v23, s20, v19
s_waitcnt lgkmcnt(4)
v_mfma_f32_16x16x32_bf16 v[204:207], v[44:47], v[64:67], v[204:207]
ds_read_b64_tr_b16 v[56:57], v23 offset:0
ds_read_b64_tr_b16 v[58:59], v23 offset:2048
s_waitcnt lgkmcnt(4)
v_mfma_f32_16x16x32_bf16 v[192:195], v[48:51], v[60:63], v[192:195]
ds_read_b128 v[68:71], v7 offset:8192
v_mfma_f32_16x16x32_bf16 v[208:211], v[48:51], v[64:67], v[208:211]
ds_read_b64_tr_b16 v[44:45], v20 offset:4096
ds_read_b64_tr_b16 v[46:47], v20 offset:6144
s_waitcnt lgkmcnt(5)
v_mfma_f32_16x16x32_bf16 v[196:199], v[52:55], v[60:63], v[196:199]
ds_read_b128 v[72:75], v7 offset:9216
v_mfma_f32_16x16x32_bf16 v[212:215], v[52:55], v[64:67], v[212:215]
ds_read_b64_tr_b16 v[48:49], v21 offset:4096
ds_read_b64_tr_b16 v[50:51], v21 offset:6144
s_waitcnt lgkmcnt(6)
v_mfma_f32_16x16x32_bf16 v[200:203], v[56:59], v[60:63], v[200:203]
ds_read_b64_tr_b16 v[52:53], v22 offset:4096
v_mfma_f32_16x16x32_bf16 v[216:219], v[56:59], v[64:67], v[216:219]
ds_read_b64_tr_b16 v[54:55], v22 offset:6144
s_waitcnt lgkmcnt(5)
v_mfma_f32_16x16x32_bf16 v[188:191], v[44:47], v[68:71], v[188:191]
ds_read_b64_tr_b16 v[56:57], v23 offset:4096
ds_read_b64_tr_b16 v[58:59], v23 offset:6144
s_waitcnt lgkmcnt(6)
v_mfma_f32_16x16x32_bf16 v[204:207], v[44:47], v[72:75], v[204:207]
s_add_u32 s20, s20, 25600
s_cmp_ge_u32 s20, 143360
s_cselect_b32 s20, 0, s20
s_waitcnt lgkmcnt(4)
v_mfma_f32_16x16x32_bf16 v[192:195], v[48:51], v[68:71], v[192:195]
s_waitcnt lgkmcnt(0)
s_barrier
v_add_u32 v7, s20, v6
v_mfma_f32_16x16x32_bf16 v[208:211], v[48:51], v[72:75], v[208:211]
ds_read_b128 v[60:63], v7 offset:0
v_add_u32 v20, s20, v16
ds_read_b64_tr_b16 v[44:45], v20 offset:0
ds_read_b64_tr_b16 v[46:47], v20 offset:2048
s_waitcnt lgkmcnt(5)
v_mfma_f32_16x16x32_bf16 v[196:199], v[52:55], v[68:71], v[196:199]
ds_read_b128 v[64:67], v7 offset:1024
v_add_u32 v21, s20, v17
v_mfma_f32_16x16x32_bf16 v[212:215], v[52:55], v[72:75], v[212:215]
ds_read_b64_tr_b16 v[48:49], v21 offset:0
ds_read_b64_tr_b16 v[50:51], v21 offset:2048
s_waitcnt lgkmcnt(6)
v_mfma_f32_16x16x32_bf16 v[200:203], v[56:59], v[68:71], v[200:203]
v_add_u32 v22, s20, v18
v_mfma_f32_16x16x32_bf16 v[216:219], v[56:59], v[72:75], v[216:219]
ds_read_b64_tr_b16 v[52:53], v22 offset:0
ds_read_b64_tr_b16 v[54:55], v22 offset:2048
s_waitcnt lgkmcnt(5)
v_mfma_f32_16x16x32_bf16 v[188:191], v[44:47], v[60:63], v[188:191]
v_add_u32 v23, s20, v19
s_waitcnt lgkmcnt(4)
v_mfma_f32_16x16x32_bf16 v[204:207], v[44:47], v[64:67], v[204:207]
ds_read_b64_tr_b16 v[56:57], v23 offset:0
ds_read_b64_tr_b16 v[58:59], v23 offset:2048
s_waitcnt lgkmcnt(4)
v_mfma_f32_16x16x32_bf16 v[192:195], v[48:51], v[60:63], v[192:195]
ds_read_b128 v[68:71], v7 offset:8192
v_mfma_f32_16x16x32_bf16 v[208:211], v[48:51], v[64:67], v[208:211]
ds_read_b64_tr_b16 v[44:45], v20 offset:4096
ds_read_b64_tr_b16 v[46:47], v20 offset:6144
s_waitcnt lgkmcnt(5)
v_mfma_f32_16x16x32_bf16 v[196:199], v[52:55], v[60:63], v[196:199]
ds_read_b128 v[72:75], v7 offset:9216
v_mfma_f32_16x16x32_bf16 v[212:215], v[52:55], v[64:67], v[212:215]
ds_read_b64_tr_b16 v[48:49], v21 offset:4096
ds_read_b64_tr_b16 v[50:51], v21 offset:6144
s_waitcnt lgkmcnt(6)
v_mfma_f32_16x16x32_bf16 v[200:203], v[56:59], v[60:63], v[200:203]
ds_read_b64_tr_b16 v[52:53], v22 offset:4096
v_mfma_f32_16x16x32_bf16 v[216:219], v[56:59], v[64:67], v[216:219]
ds_read_b64_tr_b16 v[54:55], v22 offset:6144
s_waitcnt lgkmcnt(5)
v_mfma_f32_16x16x32_bf16 v[188:191], v[44:47], v[68:71], v[188:191]
ds_read_b64_tr_b16 v[56:57], v23 offset:4096
ds_read_b64_tr_b16 v[58:59], v23 offset:6144
s_waitcnt lgkmcnt(6)
v_mfma_f32_16x16x32_bf16 v[204:207], v[44:47], v[72:75], v[204:207]
s_add_u32 s20, s20, 25600
s_cmp_ge_u32 s20, 143360
s_cselect_b32 s20, 0, s20
s_waitcnt lgkmcnt(4)
v_mfma_f32_16x16x32_bf16 v[192:195], v[48:51], v[68:71], v[192:195]
s_waitcnt lgkmcnt(0)
s_barrier
v_add_u32 v7, s20, v6
v_mfma_f32_16x16x32_bf16 v[208:211], v[48:51], v[72:75], v[208:211]
ds_read_b128 v[60:63], v7 offset:0
v_add_u32 v20, s20, v16
ds_read_b64_tr_b16 v[44:45], v20 offset:0
ds_read_b64_tr_b16 v[46:47], v20 offset:2048
s_waitcnt lgkmcnt(5)
v_mfma_f32_16x16x32_bf16 v[196:199], v[52:55], v[68:71], v[196:199]
ds_read_b128 v[64:67], v7 offset:1024
v_add_u32 v21, s20, v17
v_mfma_f32_16x16x32_bf16 v[212:215], v[52:55], v[72:75], v[212:215]
ds_read_b64_tr_b16 v[48:49], v21 offset:0
ds_read_b64_tr_b16 v[50:51], v21 offset:2048
s_waitcnt lgkmcnt(6)
v_mfma_f32_16x16x32_bf16 v[200:203], v[56:59], v[68:71], v[200:203]
v_add_u32 v22, s20, v18
v_mfma_f32_16x16x32_bf16 v[216:219], v[56:59], v[72:75], v[216:219]
ds_read_b64_tr_b16 v[52:53], v22 offset:0
ds_read_b64_tr_b16 v[54:55], v22 offset:2048
s_waitcnt vmcnt(0)
s_mov_b32 s24, 2
.p2align 3
CL_p2c_1:
s_waitcnt lgkmcnt(5)
v_mfma_f32_16x16x32_bf16 v[188:191], v[44:47], v[60:63], v[188:191]
v_add_u32 v23, s20, v19
s_waitcnt lgkmcnt(4)
v_mfma_f32_16x16x32_bf16 v[204:207], v[44:47], v[64:67], v[204:207]
ds_read_b64_tr_b16 v[56:57], v23 offset:0
ds_read_b64_tr_b16 v[58:59], v23 offset:2048
s_waitcnt lgkmcnt(4)
v_mfma_f32_16x16x32_bf16 v[192:195], v[48:51], v[60:63], v[192:195]
ds_read_b128 v[68:71], v7 offset:8192
v_mfma_f32_16x16x32_bf16 v[208:211], v[48:51], v[64:67], v[208:211]
ds_read_b64_tr_b16 v[44:45], v20 offset:4096
ds_read_b64_tr_b16 v[46:47], v20 offset:6144
s_waitcnt lgkmcnt(5)
v_mfma_f32_16x16x32_bf16 v[196:199], v[52:55], v[60:63], v[196:199]
ds_read_b128 v[72:75], v7 offset:9216
v_mfma_f32_16x16x32_bf16 v[212:215], v[52:55], v[64:67], v[212:215]
ds_read_b64_tr_b16 v[48:49], v21 offset:4096
ds_read_b64_tr_b16 v[50:51], v21 offset:6144
s_waitcnt lgkmcnt(6)
v_mfma_f32_16x16x32_bf16 v[200:203], v[56:59], v[60:63], v[200:203]
ds_read_b64_tr_b16 v[52:53], v22 offset:4096
v_mfma_f32_16x16x32_bf16 v[216:219], v[56:59], v[64:67], v[216:219]
ds_read_b64_tr_b16 v[54:55], v22 offset:6144
s_waitcnt lgkmcnt(5)
v_mfma_f32_16x16x32_bf16 v[188:191], v[44:47], v[68:71], v[188:191]
ds_read_b64_tr_b16 v[56:57], v23 offset:4096
ds_read_b64_tr_b16 v[58:59], v23 offset:6144
s_waitcnt lgkmcnt(6)
v_mfma_f32_16x16x32_bf16 v[204:207], v[44:47], v[72:75], v[204:207]
s_add_u32 s20, s20, 25600
s_cmp_ge_u32 s20, 143360
s_cselect_b32 s20, 0, s20
s_waitcnt lgkmcnt(4)
v_mfma_f32_16x16x32_bf16 v[192:195], v[48:51], v[68:71], v[192:195]
s_waitcnt lgkmcnt(0)
s_barrier
v_add_u32 v7, s20, v6
v_mfma_f32_16x16x32_bf16 v[208:211], v[48:51], v[72:75], v[208:211]
ds_read_b128 v[60:63], v7 offset:0
v_add_u32 v20, s20, v16
ds_read_b64_tr_b16 v[44:45], v20 offset:0
ds_read_b64_tr_b16 v[46:47], v20 offset:2048
s_waitcnt lgkmcnt(5)
v_mfma_f32_16x16x32_bf16 v[196:199], v[52:55], v[68:71], v[196:199]
ds_read_b128 v[64:67], v7 offset:1024
v_add_u32 v21, s20, v17
v_mfma_f32_16x16x32_bf16 v[212:215], v[52:55], v[72:75], v[212:215]
ds_read_b64_tr_b16 v[48:49], v21 offset:0
ds_read_b64_tr_b16 v[50:51], v21 offset:2048
s_waitcnt lgkmcnt(6)
v_mfma_f32_16x16x32_bf16 v[200:203], v[56:59], v[68:71], v[200:203]
v_add_u32 v22, s20, v18
v_mfma_f32_16x16x32_bf16 v[216:219], v[56:59], v[72:75], v[216:219]
ds_read_b64_tr_b16 v[52:53], v22 offset:0
ds_read_b64_tr_b16 v[54:55], v22 offset:2048
s_waitcnt lgkmcnt(5)
v_mfma_f32_16x16x32_bf16 v[188:191], v[44:47], v[60:63], v[188:191]
v_add_u32 v23, s20, v19
s_waitcnt lgkmcnt(4)
v_mfma_f32_16x16x32_bf16 v[204:207], v[44:47], v[64:67], v[204:207]
ds_read_b64_tr_b16 v[56:57], v23 offset:0
ds_read_b64_tr_b16 v[58:59], v23 offset:2048
s_waitcnt lgkmcnt(4)
v_mfma_f32_16x16x32_bf16 v[192:195], v[48:51], v[60:63], v[192:195]
ds_read_b128 v[68:71], v7 offset:8192
v_mfma_f32_16x16x32_bf16 v[208:211], v[48:51], v[64:67], v[208:211]
ds_read_b64_tr_b16 v[44:45], v20 offset:4096
ds_read_b64_tr_b16 v[46:47], v20 offset:6144
s_waitcnt lgkmcnt(5)
v_mfma_f32_16x16x32_bf16 v[196:199], v[52:55], v[60:63], v[196:199]
ds_read_b128 v[72:75], v7 offset:9216
v_mfma_f32_16x16x32_bf16 v[212:215], v[52:55], v[64:67], v[212:215]
ds_read_b64_tr_b16 v[48:49], v21 offset:4096
ds_read_b64_tr_b16 v[50:51], v21 offset:6144
s_waitcnt lgkmcnt(6)
v_mfma_f32_16x16x32_bf16 v[200:203], v[56:59], v[60:63], v[200:203]
ds_read_b64_tr_b16 v[52:53], v22 offset:4096
v_mfma_f32_16x16x32_bf16 v[216:219], v[56:59], v[64:67], v[216:219]
ds_read_b64_tr_b16 v[54:55], v22 offset:6144
s_waitcnt lgkmcnt(5)
v_mfma_f32_16x16x32_bf16 v[188:191], v[44:47], v[68:71], v[188:191]
ds_read_b64_tr_b16 v[56:57], v23 offset:4096
ds_read_b64_tr_b16 v[58:59], v23 offset:6144
s_waitcnt lgkmcnt(6)
v_mfma_f32_16x16x32_bf16 v[204:207], v[44:47], v[72:75], v[204:207]
s_add_u32 s20, s20, 25600
s_cmp_ge_u32 s20, 143360
s_cselect_b32 s20, 0, s20
s_waitcnt lgkmcnt(4)
v_mfma_f32_16x16x32_bf16 v[192:195], v[48:51], v[68:71], v[192:195]
s_waitcnt lgkmcnt(0)
s_barrier
v_add_u32 v7, s20, v6
v_mfma_f32_16x16x32_bf16 v[208:211], v[48:51], v[72:75], v[208:211]
ds_read_b128 v[60:63], v7 offset:0
v_add_u32 v20, s20, v16
ds_read_b64_tr_b16 v[44:45], v20 offset:0
ds_read_b64_tr_b16 v[46:47], v20 offset:2048
s_waitcnt lgkmcnt(5)
v_mfma_f32_16x16x32_bf16 v[196:199], v[52:55], v[68:71], v[196:199]
ds_read_b128 v[64:67], v7 offset:1024
v_add_u32 v21, s20, v17
v_mfma_f32_16x16x32_bf16 v[212:215], v[52:55], v[72:75], v[212:215]
ds_read_b64_tr_b16 v[48:49], v21 offset:0
ds_read_b64_tr_b16 v[50:51], v21 offset:2048
s_waitcnt lgkmcnt(6)
v_mfma_f32_16x16x32_bf16 v[200:203], v[56:59], v[68:71], v[200:203]
v_add_u32 v22, s20, v18
ds_read_b64_tr_b16 v[52:53], v22 offset:0
v_mfma_f32_16x16x32_bf16 v[216:219], v[56:59], v[72:75], v[216:219]
ds_read_b64_tr_b16 v[54:55], v22 offset:2048
s_sub_u32 s24, s24, 1
s_cmp_lg_u32 s24, 0
s_cbranch_scc1 CL_p2c_1
s_waitcnt lgkmcnt(5)
v_mfma_f32_16x16x32_bf16 v[188:191], v[44:47], v[60:63], v[188:191]
v_add_u32 v23, s20, v19
s_waitcnt lgkmcnt(4)
v_mfma_f32_16x16x32_bf16 v[204:207], v[44:47], v[64:67], v[204:207]
ds_read_b64_tr_b16 v[56:57], v23 offset:0
ds_read_b64_tr_b16 v[58:59], v23 offset:2048
s_waitcnt lgkmcnt(4)
v_mfma_f32_16x16x32_bf16 v[192:195], v[48:51], v[60:63], v[192:195]
ds_read_b128 v[68:71], v7 offset:8192
v_mfma_f32_16x16x32_bf16 v[208:211], v[48:51], v[64:67], v[208:211]
ds_read_b64_tr_b16 v[44:45], v20 offset:4096
ds_read_b64_tr_b16 v[46:47], v20 offset:6144
s_waitcnt lgkmcnt(5)
v_mfma_f32_16x16x32_bf16 v[196:199], v[52:55], v[60:63], v[196:199]
ds_read_b128 v[72:75], v7 offset:9216
v_mfma_f32_16x16x32_bf16 v[212:215], v[52:55], v[64:67], v[212:215]
ds_read_b64_tr_b16 v[48:49], v21 offset:4096
ds_read_b64_tr_b16 v[50:51], v21 offset:6144
s_waitcnt lgkmcnt(6)
v_mfma_f32_16x16x32_bf16 v[200:203], v[56:59], v[60:63], v[200:203]
ds_read_b64_tr_b16 v[52:53], v22 offset:4096
v_mfma_f32_16x16x32_bf16 v[216:219], v[56:59], v[64:67], v[216:219]
ds_read_b64_tr_b16 v[54:55], v22 offset:6144
s_waitcnt lgkmcnt(5)
v_mfma_f32_16x16x32_bf16 v[188:191], v[44:47], v[68:71], v[188:191]
ds_read_b64_tr_b16 v[56:57], v23 offset:4096
ds_read_b64_tr_b16 v[58:59], v23 offset:6144
s_waitcnt lgkmcnt(6)
v_mfma_f32_16x16x32_bf16 v[204:207], v[44:47], v[72:75], v[204:207]
s_add_u32 s20, s20, 25600
s_cmp_ge_u32 s20, 143360
s_cselect_b32 s20, 0, s20
s_waitcnt lgkmcnt(4)
v_mfma_f32_16x16x32_bf16 v[192:195], v[48:51], v[68:71], v[192:195]
s_waitcnt lgkmcnt(0)
s_barrier
v_add_u32 v7, s20, v6
v_mfma_f32_16x16x32_bf16 v[208:211], v[48:51], v[72:75], v[208:211]
ds_read_b128 v[60:63], v7 offset:0
v_add_u32 v20, s20, v16
ds_read_b64_tr_b16 v[44:45], v20 offset:0
ds_read_b64_tr_b16 v[46:47], v20 offset:2048
s_waitcnt lgkmcnt(5)
v_mfma_f32_16x16x32_bf16 v[196:199], v[52:55], v[68:71], v[196:199]
ds_read_b128 v[64:67], v7 offset:1024
v_add_u32 v21, s20, v17
v_mfma_f32_16x16x32_bf16 v[212:215], v[52:55], v[72:75], v[212:215]
ds_read_b64_tr_b16 v[48:49], v21 offset:0
ds_read_b64_tr_b16 v[50:51], v21 offset:2048
s_waitcnt lgkmcnt(6)
v_mfma_f32_16x16x32_bf16 v[200:203], v[56:59], v[68:71], v[200:203]
v_add_u32 v22, s20, v18
v_mfma_f32_16x16x32_bf16 v[216:219], v[56:59], v[72:75], v[216:219]
ds_read_b64_tr_b16 v[52:53], v22 offset:0
ds_read_b64_tr_b16 v[54:55], v22 offset:2048
s_waitcnt lgkmcnt(5)
v_mfma_f32_16x16x32_bf16 v[188:191], v[44:47], v[60:63], v[188:191]
v_add_u32 v23, s20, v19
s_waitcnt lgkmcnt(4)
v_mfma_f32_16x16x32_bf16 v[204:207], v[44:47], v[64:67], v[204:207]
ds_read_b64_tr_b16 v[56:57], v23 offset:0
ds_read_b64_tr_b16 v[58:59], v23 offset:2048
s_waitcnt lgkmcnt(4)
v_mfma_f32_16x16x32_bf16 v[192:195], v[48:51], v[60:63], v[192:195]
ds_read_b128 v[68:71], v7 offset:8192
v_mfma_f32_16x16x32_bf16 v[208:211], v[48:51], v[64:67], v[208:211]
ds_read_b64_tr_b16 v[44:45], v20 offset:4096
ds_read_b64_tr_b16 v[46:47], v20 offset:6144
s_waitcnt lgkmcnt(5)
v_mfma_f32_16x16x32_bf16 v[196:199], v[52:55], v[60:63], v[196:199]
ds_read_b128 v[72:75], v7 offset:9216
v_mfma_f32_16x16x32_bf16 v[212:215], v[52:55], v[64:67], v[212:215]
ds_read_b64_tr_b16 v[48:49], v21 offset:4096
ds_read_b64_tr_b16 v[50:51], v21 offset:6144
s_waitcnt lgkmcnt(6)
v_mfma_f32_16x16x32_bf16 v[200:203], v[56:59], v[60:63], v[200:203]
ds_read_b64_tr_b16 v[52:53], v22 offset:4096
v_mfma_f32_16x16x32_bf16 v[216:219], v[56:59], v[64:67], v[216:219]
ds_read_b64_tr_b16 v[54:55], v22 offset:6144
s_waitcnt lgkmcnt(5)
v_mfma_f32_16x16x32_bf16 v[188:191], v[44:47], v[68:71], v[188:191]
ds_read_b64_tr_b16 v[56:57], v23 offset:4096
ds_read_b64_tr_b16 v[58:59], v23 offset:6144
s_waitcnt lgkmcnt(6)
v_mfma_f32_16x16x32_bf16 v[204:207], v[44:47], v[72:75], v[204:207]
s_add_u32 s20, s20, 25600
s_cmp_ge_u32 s20, 143360
s_cselect_b32 s20, 0, s20
s_waitcnt lgkmcnt(4)
v_mfma_f32_16x16x32_bf16 v[192:195], v[48:51], v[68:71], v[192:195]
v_mfma_f32_16x16x32_bf16 v[208:211], v[48:51], v[72:75], v[208:211]
s_waitcnt lgkmcnt(2)
v_mfma_f32_16x16x32_bf16 v[196:199], v[52:55], v[68:71], v[196:199]
v_mfma_f32_16x16x32_bf16 v[212:215], v[52:55], v[72:75], v[212:215]
s_waitcnt lgkmcnt(0)
v_mfma_f32_16x16x32_bf16 v[200:203], v[56:59], v[68:71], v[200:203]
v_mfma_f32_16x16x32_bf16 v[216:219], v[56:59], v[72:75], v[216:219]
s_barrier
v_add_u32 v7, s20, v6
ds_read_b128 v[108:111], v7 offset:0
v_add_u32 v20, s20, v16
ds_read_b64_tr_b16 v[76:77], v20 offset:0
ds_read_b64_tr_b16 v[78:79], v20 offset:2048
v_add_u32 v21, s20, v17
ds_read_b64_tr_b16 v[80:81], v21 offset:0
ds_read_b64_tr_b16 v[82:83], v21 offset:2048
v_add_u32 v22, s20, v18
ds_read_b64_tr_b16 v[84:85], v22 offset:0
ds_read_b64_tr_b16 v[86:87], v22 offset:2048
ds_read_b128 v[112:115], v7 offset:1024
v_add_u32 v23, s20, v19
ds_read_b64_tr_b16 v[88:89], v23 offset:0
ds_read_b64_tr_b16 v[90:91], v23 offset:2048
ds_read_b64_tr_b16 v[92:93], v20 offset:4096
ds_read_b64_tr_b16 v[94:95], v20 offset:6144
ds_read_b64_tr_b16 v[96:97], v21 offset:4096
ds_read_b64_tr_b16 v[98:99], v21 offset:6144
ds_read_b64_tr_b16 v[100:101], v22 offset:4096
ds_read_b64_tr_b16 v[102:103], v22 offset:6144
s_mov_b32 s24, 11
.p2align 3
CL_p4s_0:
s_waitcnt lgkmcnt(13)
v_mfma_f32_16x16x32_bf16 v[188:191], v[76:79], v[108:111], v[188:191]
ds_read_b64_tr_b16 v[104:105], v23 offset:4096
ds_read_b64_tr_b16 v[106:107], v23 offset:6144
s_waitcnt lgkmcnt(10)
v_mfma_f32_16x16x32_bf16 v[204:207], v[76:79], v[112:115], v[204:207]
s_add_u32 s20, s20, 16384
s_cmp_ge_u32 s20, 143360
s_cselect_b32 s20, 0, s20
v_mfma_f32_16x16x32_bf16 v[192:195], v[80:83], v[108:111], v[192:195]
s_barrier
v_add_u32 v7, s20, v6
ds_read_b128 v[116:119], v7 offset:0
v_mfma_f32_16x16x32_bf16 v[208:211], v[80:83], v[112:115], v[208:211]
v_add_u32 v20, s20, v16
ds_read_b64_tr_b16 v[76:77], v20 offset:0
ds_read_b64_tr_b16 v[78:79], v20 offset:2048
v_mfma_f32_16x16x32_bf16 v[196:199], v[84:87], v[108:111], v[196:199]
v_add_u32 v21, s20, v17
v_mfma_f32_16x16x32_bf16 v[212:215], v[84:87], v[112:115], v[212:215]
ds_read_b64_tr_b16 v[80:81], v21 offset:0
ds_read_b64_tr_b16 v[82:83], v21 offset:2048
s_waitcnt lgkmcnt(13)
v_mfma_f32_16x16x32_bf16 v[200:203], v[88:91], v[108:111], v[200:203]
v_add_u32 v22, s20, v18
v_mfma_f32_16x16x32_bf16 v[216:219], v[88:91], v[112:115], v[216:219]
ds_read_b64_tr_b16 v[84:85], v22 offset:0
ds_read_b64_tr_b16 v[86:87], v22 offset:2048
s_waitcnt lgkmcnt(13)
v_mfma_f32_16x16x32_bf16 v[220:223], v[92:95], v[108:111], v[220:223]
ds_read_b128 v[120:123], v7 offset:1024
v_add_u32 v23, s20, v19
v_mfma_f32_16x16x32_bf16 v[236:239], v[92:95], v[112:115], v[236:239]
ds_read_b64_tr_b16 v[88:89], v23 offset:0
ds_read_b64_tr_b16 v[90:91], v23 offset:2048
s_waitcnt lgkmcnt(14)
v_mfma_f32_16x16x32_bf16 v[224:227], v[96:99], v[108:111], v[224:227]
ds_read_b64_tr_b16 v[92:93], v20 offset:4096
v_mfma_f32_16x16x32_bf16 v[240:243], v[96:99], v[112:115], v[240:243]
ds_read_b64_tr_b16 v[94:95], v20 offset:6144
s_waitcnt lgkmcnt(14)
v_mfma_f32_16x16x32_bf16 v[228:231], v[100:103], v[108:111], v[228:231]
ds_read_b64_tr_b16 v[96:97], v21 offset:4096
v_mfma_f32_16x16x32_bf16 v[244:247], v[100:103], v[112:115], v[244:247]
ds_read_b64_tr_b16 v[98:99], v21 offset:6144
s_waitcnt lgkmcnt(14)
v_mfma_f32_16x16x32_bf16 v[232:235], v[104:107], v[108:111], v[232:235]
ds_read_b64_tr_b16 v[100:101], v22 offset:4096
v_mfma_f32_16x16x32_bf16 v[248:251], v[104:107], v[112:115], v[248:251]
ds_read_b64_tr_b16 v[102:103], v22 offset:6144
s_waitcnt lgkmcnt(13)
v_mfma_f32_16x16x32_bf16 v[188:191], v[76:79], v[116:119], v[188:191]
ds_read_b64_tr_b16 v[104:105], v23 offset:4096
ds_read_b64_tr_b16 v[106:107], v23 offset:6144
s_waitcnt lgkmcnt(10)
v_mfma_f32_16x16x32_bf16 v[204:207], v[76:79], v[120:123], v[204:207]
s_add_u32 s20, s20, 16384
s_cmp_ge_u32 s20, 143360
s_cselect_b32 s20, 0, s20
v_mfma_f32_16x16x32_bf16 v[192:195], v[80:83], v[116:119], v[192:195]
s_barrier
v_add_u32 v7, s20, v6
ds_read_b128 v[108:111], v7 offset:0
v_mfma_f32_16x16x32_bf16 v[208:211], v[80:83], v[120:123], v[208:211]
v_add_u32 v20, s20, v16
ds_read_b64_tr_b16 v[76:77], v20 offset:0
ds_read_b64_tr_b16 v[78:79], v20 offset:2048
v_mfma_f32_16x16x32_bf16 v[196:199], v[84:87], v[116:119], v[196:199]
v_add_u32 v21, s20, v17
v_mfma_f32_16x16x32_bf16 v[212:215], v[84:87], v[120:123], v[212:215]
ds_read_b64_tr_b16 v[80:81], v21 offset:0
ds_read_b64_tr_b16 v[82:83], v21 offset:2048
s_waitcnt lgkmcnt(13)
v_mfma_f32_16x16x32_bf16 v[200:203], v[88:91], v[116:119], v[200:203]
v_add_u32 v22, s20, v18
v_mfma_f32_16x16x32_bf16 v[216:219], v[88:91], v[120:123], v[216:219]
ds_read_b64_tr_b16 v[84:85], v22 offset:0
ds_read_b64_tr_b16 v[86:87], v22 offset:2048
s_waitcnt lgkmcnt(13)
v_mfma_f32_16x16x32_bf16 v[220:223], v[92:95], v[116:119], v[220:223]
ds_read_b128 v[112:115], v7 offset:1024
v_add_u32 v23, s20, v19
v_mfma_f32_16x16x32_bf16 v[236:239], v[92:95], v[120:123], v[236:239]
ds_read_b64_tr_b16 v[88:89], v23 offset:0
ds_read_b64_tr_b16 v[90:91], v23 offset:2048
s_waitcnt lgkmcnt(14)
v_mfma_f32_16x16x32_bf16 v[224:227], v[96:99], v[116:119], v[224:227]
ds_read_b64_tr_b16 v[92:93], v20 offset:4096
v_mfma_f32_16x16x32_bf16 v[240:243], v[96:99], v[120:123], v[240:243]
ds_read_b64_tr_b16 v[94:95], v20 offset:6144
s_waitcnt lgkmcnt(14)
v_mfma_f32_16x16x32_bf16 v[228:231], v[100:103], v[116:119], v[228:231]
ds_read_b64_tr_b16 v[96:97], v21 offset:4096
v_mfma_f32_16x16x32_bf16 v[244:247], v[100:103], v[120:123], v[244:247]
ds_read_b64_tr_b16 v[98:99], v21 offset:6144
s_waitcnt lgkmcnt(14)
v_mfma_f32_16x16x32_bf16 v[232:235], v[104:107], v[116:119], v[232:235]
ds_read_b64_tr_b16 v[100:101], v22 offset:4096
v_mfma_f32_16x16x32_bf16 v[248:251], v[104:107], v[120:123], v[248:251]
ds_read_b64_tr_b16 v[102:103], v22 offset:6144
s_waitcnt lgkmcnt(13)
v_mfma_f32_16x16x32_bf16 v[188:191], v[76:79], v[108:111], v[188:191]
ds_read_b64_tr_b16 v[104:105], v23 offset:4096
ds_read_b64_tr_b16 v[106:107], v23 offset:6144
s_waitcnt lgkmcnt(10)
v_mfma_f32_16x16x32_bf16 v[204:207], v[76:79], v[112:115], v[204:207]
s_add_u32 s20, s20, 16384
s_cmp_ge_u32 s20, 143360
s_cselect_b32 s20, 0, s20
v_mfma_f32_16x16x32_bf16 v[192:195], v[80:83], v[108:111], v[192:195]
s_barrier
v_add_u32 v7, s20, v6
ds_read_b128 v[116:119], v7 offset:0
v_mfma_f32_16x16x32_bf16 v[208:211], v[80:83], v[112:115], v[208:211]
v_add_u32 v20, s20, v16
ds_read_b64_tr_b16 v[76:77], v20 offset:0
ds_read_b64_tr_b16 v[78:79], v20 offset:2048
v_mfma_f32_16x16x32_bf16 v[196:199], v[84:87], v[108:111], v[196:199]
v_add_u32 v21, s20, v17
v_mfma_f32_16x16x32_bf16 v[212:215], v[84:87], v[112:115], v[212:215]
ds_read_b64_tr_b16 v[80:81], v21 offset:0
ds_read_b64_tr_b16 v[82:83], v21 offset:2048
s_waitcnt lgkmcnt(13)
v_mfma_f32_16x16x32_bf16 v[200:203], v[88:91], v[108:111], v[200:203]
v_add_u32 v22, s20, v18
v_mfma_f32_16x16x32_bf16 v[216:219], v[88:91], v[112:115], v[216:219]
ds_read_b64_tr_b16 v[84:85], v22 offset:0
ds_read_b64_tr_b16 v[86:87], v22 offset:2048
s_waitcnt lgkmcnt(13)
v_mfma_f32_16x16x32_bf16 v[220:223], v[92:95], v[108:111], v[220:223]
ds_read_b128 v[120:123], v7 offset:1024
v_add_u32 v23, s20, v19
v_mfma_f32_16x16x32_bf16 v[236:239], v[92:95], v[112:115], v[236:239]
ds_read_b64_tr_b16 v[88:89], v23 offset:0
ds_read_b64_tr_b16 v[90:91], v23 offset:2048
s_waitcnt lgkmcnt(14)
v_mfma_f32_16x16x32_bf16 v[224:227], v[96:99], v[108:111], v[224:227]
ds_read_b64_tr_b16 v[92:93], v20 offset:4096
v_mfma_f32_16x16x32_bf16 v[240:243], v[96:99], v[112:115], v[240:243]
ds_read_b64_tr_b16 v[94:95], v20 offset:6144
s_waitcnt lgkmcnt(14)
v_mfma_f32_16x16x32_bf16 v[228:231], v[100:103], v[108:111], v[228:231]
ds_read_b64_tr_b16 v[96:97], v21 offset:4096
v_mfma_f32_16x16x32_bf16 v[244:247], v[100:103], v[112:115], v[244:247]
ds_read_b64_tr_b16 v[98:99], v21 offset:6144
s_waitcnt lgkmcnt(14)
v_mfma_f32_16x16x32_bf16 v[232:235], v[104:107], v[108:111], v[232:235]
ds_read_b64_tr_b16 v[100:101], v22 offset:4096
v_mfma_f32_16x16x32_bf16 v[248:251], v[104:107], v[112:115], v[248:251]
ds_read_b64_tr_b16 v[102:103], v22 offset:6144
s_waitcnt lgkmcnt(13)
v_mfma_f32_16x16x32_bf16 v[188:191], v[76:79], v[116:119], v[188:191]
ds_read_b64_tr_b16 v[104:105], v23 offset:4096
ds_read_b64_tr_b16 v[106:107], v23 offset:6144
s_waitcnt lgkmcnt(10)
v_mfma_f32_16x16x32_bf16 v[204:207], v[76:79], v[120:123], v[204:207]
s_add_u32 s20, s20, 16384
s_cmp_ge_u32 s20, 143360
s_cselect_b32 s20, 0, s20
v_mfma_f32_16x16x32_bf16 v[192:195], v[80:83], v[116:119], v[192:195]
s_barrier
v_add_u32 v7, s20, v6
ds_read_b128 v[108:111], v7 offset:0
v_mfma_f32_16x16x32_bf16 v[208:211], v[80:83], v[120:123], v[208:211]
v_add_u32 v20, s20, v16
ds_read_b64_tr_b16 v[76:77], v20 offset:0
ds_read_b64_tr_b16 v[78:79], v20 offset:2048
v_mfma_f32_16x16x32_bf16 v[196:199], v[84:87], v[116:119], v[196:199]
v_add_u32 v21, s20, v17
v_mfma_f32_16x16x32_bf16 v[212:215], v[84:87], v[120:123], v[212:215]
ds_read_b64_tr_b16 v[80:81], v21 offset:0
ds_read_b64_tr_b16 v[82:83], v21 offset:2048
s_waitcnt lgkmcnt(13)
v_mfma_f32_16x16x32_bf16 v[200:203], v[88:91], v[116:119], v[200:203]
v_add_u32 v22, s20, v18
v_mfma_f32_16x16x32_bf16 v[216:219], v[88:91], v[120:123], v[216:219]
ds_read_b64_tr_b16 v[84:85], v22 offset:0
ds_read_b64_tr_b16 v[86:87], v22 offset:2048
s_waitcnt lgkmcnt(13)
v_mfma_f32_16x16x32_bf16 v[220:223], v[92:95], v[116:119], v[220:223]
ds_read_b128 v[112:115], v7 offset:1024
v_add_u32 v23, s20, v19
v_mfma_f32_16x16x32_bf16 v[236:239], v[92:95], v[120:123], v[236:239]
ds_read_b64_tr_b16 v[88:89], v23 offset:0
ds_read_b64_tr_b16 v[90:91], v23 offset:2048
s_waitcnt lgkmcnt(14)
v_mfma_f32_16x16x32_bf16 v[224:227], v[96:99], v[116:119], v[224:227]
ds_read_b64_tr_b16 v[92:93], v20 offset:4096
v_mfma_f32_16x16x32_bf16 v[240:243], v[96:99], v[120:123], v[240:243]
ds_read_b64_tr_b16 v[94:95], v20 offset:6144
s_waitcnt lgkmcnt(14)
v_mfma_f32_16x16x32_bf16 v[228:231], v[100:103], v[116:119], v[228:231]
ds_read_b64_tr_b16 v[96:97], v21 offset:4096
v_mfma_f32_16x16x32_bf16 v[244:247], v[100:103], v[120:123], v[244:247]
ds_read_b64_tr_b16 v[98:99], v21 offset:6144
s_waitcnt lgkmcnt(14)
v_mfma_f32_16x16x32_bf16 v[232:235], v[104:107], v[116:119], v[232:235]
ds_read_b64_tr_b16 v[100:101], v22 offset:4096
ds_read_b64_tr_b16 v[102:103], v22 offset:6144
v_mfma_f32_16x16x32_bf16 v[248:251], v[104:107], v[120:123], v[248:251]
s_sub_u32 s24, s24, 1
s_cmp_lg_u32 s24, 0
s_cbranch_scc1 CL_p4s_0
s_waitcnt lgkmcnt(13)
v_mfma_f32_16x16x32_bf16 v[188:191], v[76:79], v[108:111], v[188:191]
ds_read_b64_tr_b16 v[104:105], v23 offset:4096
ds_read_b64_tr_b16 v[106:107], v23 offset:6144
s_waitcnt lgkmcnt(10)
v_mfma_f32_16x16x32_bf16 v[204:207], v[76:79], v[112:115], v[204:207]
s_add_u32 s20, s20, 16384
s_cmp_ge_u32 s20, 143360
s_cselect_b32 s20, 0, s20
v_mfma_f32_16x16x32_bf16 v[192:195], v[80:83], v[108:111], v[192:195]
s_barrier
v_add_u32 v7, s20, v6
ds_read_b128 v[116:119], v7 offset:0
v_mfma_f32_16x16x32_bf16 v[208:211], v[80:83], v[112:115], v[208:211]
v_add_u32 v20, s20, v16
ds_read_b64_tr_b16 v[76:77], v20 offset:0
ds_read_b64_tr_b16 v[78:79], v20 offset:2048
v_mfma_f32_16x16x32_bf16 v[196:199], v[84:87], v[108:111], v[196:199]
v_add_u32 v21, s20, v17
v_mfma_f32_16x16x32_bf16 v[212:215], v[84:87], v[112:115], v[212:215]
ds_read_b64_tr_b16 v[80:81], v21 offset:0
ds_read_b64_tr_b16 v[82:83], v21 offset:2048
s_waitcnt lgkmcnt(13)
v_mfma_f32_16x16x32_bf16 v[200:203], v[88:91], v[108:111], v[200:203]
v_add_u32 v22, s20, v18
v_mfma_f32_16x16x32_bf16 v[216:219], v[88:91], v[112:115], v[216:219]
ds_read_b64_tr_b16 v[84:85], v22 offset:0
ds_read_b64_tr_b16 v[86:87], v22 offset:2048
s_waitcnt lgkmcnt(13)
v_mfma_f32_16x16x32_bf16 v[220:223], v[92:95], v[108:111], v[220:223]
ds_read_b128 v[120:123], v7 offset:1024
v_add_u32 v23, s20, v19
v_mfma_f32_16x16x32_bf16 v[236:239], v[92:95], v[112:115], v[236:239]
ds_read_b64_tr_b16 v[88:89], v23 offset:0
ds_read_b64_tr_b16 v[90:91], v23 offset:2048
s_waitcnt lgkmcnt(14)
v_mfma_f32_16x16x32_bf16 v[224:227], v[96:99], v[108:111], v[224:227]
ds_read_b64_tr_b16 v[92:93], v20 offset:4096
v_mfma_f32_16x16x32_bf16 v[240:243], v[96:99], v[112:115], v[240:243]
ds_read_b64_tr_b16 v[94:95], v20 offset:6144
s_waitcnt lgkmcnt(14)
v_mfma_f32_16x16x32_bf16 v[228:231], v[100:103], v[108:111], v[228:231]
ds_read_b64_tr_b16 v[96:97], v21 offset:4096
v_mfma_f32_16x16x32_bf16 v[244:247], v[100:103], v[112:115], v[244:247]
ds_read_b64_tr_b16 v[98:99], v21 offset:6144
s_waitcnt lgkmcnt(14)
v_mfma_f32_16x16x32_bf16 v[232:235], v[104:107], v[108:111], v[232:235]
ds_read_b64_tr_b16 v[100:101], v22 offset:4096
v_mfma_f32_16x16x32_bf16 v[248:251], v[104:107], v[112:115], v[248:251]
ds_read_b64_tr_b16 v[102:103], v22 offset:6144
s_waitcnt lgkmcnt(13)
v_mfma_f32_16x16x32_bf16 v[188:191], v[76:79], v[116:119], v[188:191]
ds_read_b64_tr_b16 v[104:105], v23 offset:4096
ds_read_b64_tr_b16 v[106:107], v23 offset:6144
s_waitcnt lgkmcnt(10)
v_mfma_f32_16x16x32_bf16 v[204:207], v[76:79], v[120:123], v[204:207]
s_add_u32 s20, s20, 16384
s_cmp_ge_u32 s20, 143360
s_cselect_b32 s20, 0, s20
v_mfma_f32_16x16x32_bf16 v[192:195], v[80:83], v[116:119], v[192:195]
s_barrier
v_add_u32 v7, s20, v6
ds_read_b128 v[108:111], v7 offset:0
v_mfma_f32_16x16x32_bf16 v[208:211], v[80:83], v[120:123], v[208:211]
v_add_u32 v20, s20, v16
ds_read_b64_tr_b16 v[76:77], v20 offset:0
ds_read_b64_tr_b16 v[78:79], v20 offset:2048
v_mfma_f32_16x16x32_bf16 v[196:199], v[84:87], v[116:119], v[196:199]
v_add_u32 v21, s20, v17
v_mfma_f32_16x16x32_bf16 v[212:215], v[84:87], v[120:123], v[212:215]
ds_read_b64_tr_b16 v[80:81], v21 offset:0
ds_read_b64_tr_b16 v[82:83], v21 offset:2048
s_waitcnt lgkmcnt(13)
v_mfma_f32_16x16x32_bf16 v[200:203], v[88:91], v[116:119], v[200:203]
v_add_u32 v22, s20, v18
v_mfma_f32_16x16x32_bf16 v[216:219], v[88:91], v[120:123], v[216:219]
ds_read_b64_tr_b16 v[84:85], v22 offset:0
ds_read_b64_tr_b16 v[86:87], v22 offset:2048
s_waitcnt lgkmcnt(13)
v_mfma_f32_16x16x32_bf16 v[220:223], v[92:95], v[116:119], v[220:223]
ds_read_b128 v[112:115], v7 offset:1024
v_add_u32 v23, s20, v19
v_mfma_f32_16x16x32_bf16 v[236:239], v[92:95], v[120:123], v[236:239]
ds_read_b64_tr_b16 v[88:89], v23 offset:0
ds_read_b64_tr_b16 v[90:91], v23 offset:2048
s_waitcnt lgkmcnt(14)
v_mfma_f32_16x16x32_bf16 v[224:227], v[96:99], v[116:119], v[224:227]
ds_read_b64_tr_b16 v[92:93], v20 offset:4096
v_mfma_f32_16x16x32_bf16 v[240:243], v[96:99], v[120:123], v[240:243]
ds_read_b64_tr_b16 v[94:95], v20 offset:6144
s_waitcnt lgkmcnt(14)
v_mfma_f32_16x16x32_bf16 v[228:231], v[100:103], v[116:119], v[228:231]
ds_read_b64_tr_b16 v[96:97], v21 offset:4096
v_mfma_f32_16x16x32_bf16 v[244:247], v[100:103], v[120:123], v[244:247]
ds_read_b64_tr_b16 v[98:99], v21 offset:6144
s_waitcnt lgkmcnt(14)
v_mfma_f32_16x16x32_bf16 v[232:235], v[104:107], v[116:119], v[232:235]
ds_read_b64_tr_b16 v[100:101], v22 offset:4096
v_mfma_f32_16x16x32_bf16 v[248:251], v[104:107], v[120:123], v[248:251]
ds_read_b64_tr_b16 v[102:103], v22 offset:6144
s_waitcnt lgkmcnt(13)
v_mfma_f32_16x16x32_bf16 v[188:191], v[76:79], v[108:111], v[188:191]
ds_read_b64_tr_b16 v[104:105], v23 offset:4096
ds_read_b64_tr_b16 v[106:107], v23 offset:6144
s_waitcnt lgkmcnt(10)
v_mfma_f32_16x16x32_bf16 v[204:207], v[76:79], v[112:115], v[204:207]
s_add_u32 s20, s20, 16384
s_cmp_ge_u32 s20, 143360
s_cselect_b32 s20, 0, s20
v_mfma_f32_16x16x32_bf16 v[192:195], v[80:83], v[108:111], v[192:195]
s_barrier
v_add_u32 v7, s20, v6
ds_read_b128 v[116:119], v7 offset:0
v_mfma_f32_16x16x32_bf16 v[208:211], v[80:83], v[112:115], v[208:211]
v_add_u32 v20, s20, v16
ds_read_b64_tr_b16 v[76:77], v20 offset:0
ds_read_b64_tr_b16 v[78:79], v20 offset:2048
v_mfma_f32_16x16x32_bf16 v[196:199], v[84:87], v[108:111], v[196:199]
v_add_u32 v21, s20, v17
v_mfma_f32_16x16x32_bf16 v[212:215], v[84:87], v[112:115], v[212:215]
ds_read_b64_tr_b16 v[80:81], v21 offset:0
ds_read_b64_tr_b16 v[82:83], v21 offset:2048
s_waitcnt lgkmcnt(13)
v_mfma_f32_16x16x32_bf16 v[200:203], v[88:91], v[108:111], v[200:203]
v_add_u32 v22, s20, v18
v_mfma_f32_16x16x32_bf16 v[216:219], v[88:91], v[112:115], v[216:219]
ds_read_b64_tr_b16 v[84:85], v22 offset:0
ds_read_b64_tr_b16 v[86:87], v22 offset:2048
s_waitcnt lgkmcnt(13)
v_mfma_f32_16x16x32_bf16 v[220:223], v[92:95], v[108:111], v[220:223]
ds_read_b128 v[120:123], v7 offset:1024
v_add_u32 v23, s20, v19
v_mfma_f32_16x16x32_bf16 v[236:239], v[92:95], v[112:115], v[236:239]
ds_read_b64_tr_b16 v[88:89], v23 offset:0
ds_read_b64_tr_b16 v[90:91], v23 offset:2048
s_waitcnt lgkmcnt(14)
v_mfma_f32_16x16x32_bf16 v[224:227], v[96:99], v[108:111], v[224:227]
ds_read_b64_tr_b16 v[92:93], v20 offset:4096
v_mfma_f32_16x16x32_bf16 v[240:243], v[96:99], v[112:115], v[240:243]
ds_read_b64_tr_b16 v[94:95], v20 offset:6144
s_waitcnt lgkmcnt(14)
v_mfma_f32_16x16x32_bf16 v[228:231], v[100:103], v[108:111], v[228:231]
ds_read_b64_tr_b16 v[96:97], v21 offset:4096
v_mfma_f32_16x16x32_bf16 v[244:247], v[100:103], v[112:115], v[244:247]
ds_read_b64_tr_b16 v[98:99], v21 offset:6144
s_waitcnt lgkmcnt(14)
v_mfma_f32_16x16x32_bf16 v[232:235], v[104:107], v[108:111], v[232:235]
ds_read_b64_tr_b16 v[100:101], v22 offset:4096
v_mfma_f32_16x16x32_bf16 v[248:251], v[104:107], v[112:115], v[248:251]
ds_read_b64_tr_b16 v[102:103], v22 offset:6144
s_waitcnt lgkmcnt(13)
v_mfma_f32_16x16x32_bf16 v[188:191], v[76:79], v[116:119], v[188:191]
ds_read_b64_tr_b16 v[104:105], v23 offset:4096
ds_read_b64_tr_b16 v[106:107], v23 offset:6144
s_waitcnt lgkmcnt(10)
v_mfma_f32_16x16x32_bf16 v[204:207], v[76:79], v[120:123], v[204:207]
s_add_u32 s20, s20, 16384
s_cmp_ge_u32 s20, 143360
s_cselect_b32 s20, 0, s20
v_mfma_f32_16x16x32_bf16 v[192:195], v[80:83], v[116:119], v[192:195]
v_mfma_f32_16x16x32_bf16 v[208:211], v[80:83], v[120:123], v[208:211]
v_mfma_f32_16x16x32_bf16 v[196:199], v[84:87], v[116:119], v[196:199]
v_mfma_f32_16x16x32_bf16 v[212:215], v[84:87], v[120:123], v[212:215]
s_waitcnt lgkmcnt(8)
v_mfma_f32_16x16x32_bf16 v[200:203], v[88:91], v[116:119], v[200:203]
v_mfma_f32_16x16x32_bf16 v[216:219], v[88:91], v[120:123], v[216:219]
s_waitcnt lgkmcnt(6)
v_mfma_f32_16x16x32_bf16 v[220:223], v[92:95], v[116:119], v[220:223]
v_mfma_f32_16x16x32_bf16 v[236:239], v[92:95], v[120:123], v[236:239]
s_waitcnt lgkmcnt(4)
v_mfma_f32_16x16x32_bf16 v[224:227], v[96:99], v[116:119], v[224:227]
v_mfma_f32_16x16x32_bf16 v[240:243], v[96:99], v[120:123], v[240:243]
s_waitcnt lgkmcnt(2)
v_mfma_f32_16x16x32_bf16 v[228:231], v[100:103], v[116:119], v[228:231]
v_mfma_f32_16x16x32_bf16 v[244:247], v[100:103], v[120:123], v[244:247]
s_waitcnt lgkmcnt(0)
v_mfma_f32_16x16x32_bf16 v[232:235], v[104:107], v[116:119], v[232:235]
v_mfma_f32_16x16x32_bf16 v[248:251], v[104:107], v[120:123], v[248:251]
s_lshl_b32 s34, s3, 15
s_lshl_b32 s35, s16, 13
s_add_u32 s34, s34, s35
s_add_u32 s34, s34, 47185920
s_add_u32 s36, s34, 4096
s_add_u32 s35, s35, 0
v_add_u32 v5, s35, v12
v_cvt_pk_bf16_f32 v220, v220, v221
v_cvt_pk_bf16_f32 v221, v222, v223
v_cvt_pk_bf16_f32 v222, v224, v225
v_cvt_pk_bf16_f32 v223, v226, v227
v_cvt_pk_bf16_f32 v224, v228, v229
v_cvt_pk_bf16_f32 v225, v230, v231
v_cvt_pk_bf16_f32 v226, v232, v233
v_cvt_pk_bf16_f32 v227, v234, v235
v_cvt_pk_bf16_f32 v228, v236, v237
v_cvt_pk_bf16_f32 v229, v238, v239
v_cvt_pk_bf16_f32 v230, v240, v241
v_cvt_pk_bf16_f32 v231, v242, v243
v_cvt_pk_bf16_f32 v232, v244, v245
v_cvt_pk_bf16_f32 v233, v246, v247
v_cvt_pk_bf16_f32 v234, v248, v249
v_cvt_pk_bf16_f32 v235, v250, v251
buffer_store_dwordx4 v[220:223], v12, s[4:7], s34 offen offset:0 sc1
buffer_store_dwordx4 v[224:227], v12, s[4:7], s34 offen offset:1024 sc1
buffer_store_dwordx4 v[228:231], v12, s[4:7], s34 offen offset:2048 sc1
buffer_store_dwordx4 v[232:235], v12, s[4:7], s34 offen offset:3072 sc1
s_waitcnt lgkmcnt(0)
s_barrier
v_add_u32 v7, s20, v6
ds_read_b128 v[60:63], v7 offset:0
v_add_u32 v20, s20, v16
ds_read_b64_tr_b16 v[44:45], v20 offset:0
ds_read_b64_tr_b16 v[46:47], v20 offset:2048
ds_read_b128 v[64:67], v7 offset:1024
v_add_u32 v21, s20, v17
ds_read_b64_tr_b16 v[48:49], v21 offset:0
ds_read_b64_tr_b16 v[50:51], v21 offset:2048
v_add_u32 v22, s20, v18
ds_read_b64_tr_b16 v[52:53], v22 offset:0
ds_read_b64_tr_b16 v[54:55], v22 offset:2048
s_waitcnt lgkmcnt(5)
v_mfma_f32_16x16x32_bf16 v[188:191], v[44:47], v[60:63], v[188:191]
v_add_u32 v23, s20, v19
s_waitcnt lgkmcnt(4)
v_mfma_f32_16x16x32_bf16 v[204:207], v[44:47], v[64:67], v[204:207]
ds_read_b64_tr_b16 v[56:57], v23 offset:0
ds_read_b64_tr_b16 v[58:59], v23 offset:2048
s_waitcnt lgkmcnt(4)
v_mfma_f32_16x16x32_bf16 v[192:195], v[48:51], v[60:63], v[192:195]
ds_read_b128 v[68:71], v7 offset:8192
v_mfma_f32_16x16x32_bf16 v[208:211], v[48:51], v[64:67], v[208:211]
ds_read_b64_tr_b16 v[44:45], v20 offset:4096
ds_read_b64_tr_b16 v[46:47], v20 offset:6144
s_waitcnt lgkmcnt(5)
v_mfma_f32_16x16x32_bf16 v[196:199], v[52:55], v[60:63], v[196:199]
ds_read_b128 v[72:75], v7 offset:9216
v_mfma_f32_16x16x32_bf16 v[212:215], v[52:55], v[64:67], v[212:215]
ds_read_b64_tr_b16 v[48:49], v21 offset:4096
ds_read_b64_tr_b16 v[50:51], v21 offset:6144
s_waitcnt lgkmcnt(6)
v_mfma_f32_16x16x32_bf16 v[200:203], v[56:59], v[60:63], v[200:203]
ds_read_b64_tr_b16 v[52:53], v22 offset:4096
v_mfma_f32_16x16x32_bf16 v[216:219], v[56:59], v[64:67], v[216:219]
ds_read_b64_tr_b16 v[54:55], v22 offset:6144
s_waitcnt lgkmcnt(5)
v_mfma_f32_16x16x32_bf16 v[188:191], v[44:47], v[68:71], v[188:191]
ds_read_b64_tr_b16 v[56:57], v23 offset:4096
ds_read_b64_tr_b16 v[58:59], v23 offset:6144
s_waitcnt lgkmcnt(6)
v_mfma_f32_16x16x32_bf16 v[204:207], v[44:47], v[72:75], v[204:207]
s_add_u32 s20, s20, 25600
s_cmp_ge_u32 s20, 143360
s_cselect_b32 s20, 0, s20
s_waitcnt lgkmcnt(4)
v_mfma_f32_16x16x32_bf16 v[192:195], v[48:51], v[68:71], v[192:195]
s_waitcnt lgkmcnt(0)
s_barrier
v_add_u32 v7, s20, v6
v_mfma_f32_16x16x32_bf16 v[208:211], v[48:51], v[72:75], v[208:211]
ds_read_b128 v[60:63], v7 offset:0
v_add_u32 v20, s20, v16
ds_read_b64_tr_b16 v[44:45], v20 offset:0
ds_read_b64_tr_b16 v[46:47], v20 offset:2048
s_waitcnt lgkmcnt(5)
v_mfma_f32_16x16x32_bf16 v[196:199], v[52:55], v[68:71], v[196:199]
ds_read_b128 v[64:67], v7 offset:1024
v_add_u32 v21, s20, v17
v_mfma_f32_16x16x32_bf16 v[212:215], v[52:55], v[72:75], v[212:215]
ds_read_b64_tr_b16 v[48:49], v21 offset:0
ds_read_b64_tr_b16 v[50:51], v21 offset:2048
s_waitcnt lgkmcnt(6)
v_mfma_f32_16x16x32_bf16 v[200:203], v[56:59], v[68:71], v[200:203]
v_add_u32 v22, s20, v18
v_mfma_f32_16x16x32_bf16 v[216:219], v[56:59], v[72:75], v[216:219]
ds_read_b64_tr_b16 v[52:53], v22 offset:0
ds_read_b64_tr_b16 v[54:55], v22 offset:2048
s_waitcnt lgkmcnt(5)
v_mfma_f32_16x16x32_bf16 v[188:191], v[44:47], v[60:63], v[188:191]
v_add_u32 v23, s20, v19
s_waitcnt lgkmcnt(4)
v_mfma_f32_16x16x32_bf16 v[204:207], v[44:47], v[64:67], v[204:207]
ds_read_b64_tr_b16 v[56:57], v23 offset:0
ds_read_b64_tr_b16 v[58:59], v23 offset:2048
s_waitcnt lgkmcnt(4)
v_mfma_f32_16x16x32_bf16 v[192:195], v[48:51], v[60:63], v[192:195]
ds_read_b128 v[68:71], v7 offset:8192
v_mfma_f32_16x16x32_bf16 v[208:211], v[48:51], v[64:67], v[208:211]
ds_read_b64_tr_b16 v[44:45], v20 offset:4096
ds_read_b64_tr_b16 v[46:47], v20 offset:6144
s_waitcnt lgkmcnt(5)
v_mfma_f32_16x16x32_bf16 v[196:199], v[52:55], v[60:63], v[196:199]
ds_read_b128 v[72:75], v7 offset:9216
v_mfma_f32_16x16x32_bf16 v[212:215], v[52:55], v[64:67], v[212:215]
ds_read_b64_tr_b16 v[48:49], v21 offset:4096
ds_read_b64_tr_b16 v[50:51], v21 offset:6144
s_waitcnt lgkmcnt(6)
v_mfma_f32_16x16x32_bf16 v[200:203], v[56:59], v[60:63], v[200:203]
ds_read_b64_tr_b16 v[52:53], v22 offset:4096
v_mfma_f32_16x16x32_bf16 v[216:219], v[56:59], v[64:67], v[216:219]
ds_read_b64_tr_b16 v[54:55], v22 offset:6144
s_waitcnt lgkmcnt(5)
v_mfma_f32_16x16x32_bf16 v[188:191], v[44:47], v[68:71], v[188:191]
ds_read_b64_tr_b16 v[56:57], v23 offset:4096
ds_read_b64_tr_b16 v[58:59], v23 offset:6144
s_waitcnt lgkmcnt(6)
v_mfma_f32_16x16x32_bf16 v[204:207], v[44:47], v[72:75], v[204:207]
s_add_u32 s20, s20, 25600
s_cmp_ge_u32 s20, 143360
s_cselect_b32 s20, 0, s20
s_waitcnt lgkmcnt(4)
v_mfma_f32_16x16x32_bf16 v[192:195], v[48:51], v[68:71], v[192:195]
s_waitcnt lgkmcnt(0)
s_barrier
v_add_u32 v7, s20, v6
v_mfma_f32_16x16x32_bf16 v[208:211], v[48:51], v[72:75], v[208:211]
ds_read_b128 v[60:63], v7 offset:0
v_add_u32 v20, s20, v16
ds_read_b64_tr_b16 v[44:45], v20 offset:0
ds_read_b64_tr_b16 v[46:47], v20 offset:2048
s_waitcnt lgkmcnt(5)
v_mfma_f32_16x16x32_bf16 v[196:199], v[52:55], v[68:71], v[196:199]
ds_read_b128 v[64:67], v7 offset:1024
v_add_u32 v21, s20, v17
v_mfma_f32_16x16x32_bf16 v[212:215], v[52:55], v[72:75], v[212:215]
ds_read_b64_tr_b16 v[48:49], v21 offset:0
ds_read_b64_tr_b16 v[50:51], v21 offset:2048
s_waitcnt lgkmcnt(6)
v_mfma_f32_16x16x32_bf16 v[200:203], v[56:59], v[68:71], v[200:203]
v_add_u32 v22, s20, v18
v_mfma_f32_16x16x32_bf16 v[216:219], v[56:59], v[72:75], v[216:219]
ds_read_b64_tr_b16 v[52:53], v22 offset:0
ds_read_b64_tr_b16 v[54:55], v22 offset:2048
s_waitcnt vmcnt(0)
s_mov_b32 s24, 2
.p2align 3
CL_p4_1:
s_waitcnt lgkmcnt(5)
v_mfma_f32_16x16x32_bf16 v[188:191], v[44:47], v[60:63], v[188:191]
v_add_u32 v23, s20, v19
s_waitcnt lgkmcnt(4)
v_mfma_f32_16x16x32_bf16 v[204:207], v[44:47], v[64:67], v[204:207]
ds_read_b64_tr_b16 v[56:57], v23 offset:0
ds_read_b64_tr_b16 v[58:59], v23 offset:2048
s_waitcnt lgkmcnt(4)
v_mfma_f32_16x16x32_bf16 v[192:195], v[48:51], v[60:63], v[192:195]
ds_read_b128 v[68:71], v7 offset:8192
v_mfma_f32_16x16x32_bf16 v[208:211], v[48:51], v[64:67], v[208:211]
ds_read_b64_tr_b16 v[44:45], v20 offset:4096
ds_read_b64_tr_b16 v[46:47], v20 offset:6144
s_waitcnt lgkmcnt(5)
v_mfma_f32_16x16x32_bf16 v[196:199], v[52:55], v[60:63], v[196:199]
ds_read_b128 v[72:75], v7 offset:9216
v_mfma_f32_16x16x32_bf16 v[212:215], v[52:55], v[64:67], v[212:215]
ds_read_b64_tr_b16 v[48:49], v21 offset:4096
ds_read_b64_tr_b16 v[50:51], v21 offset:6144
s_waitcnt lgkmcnt(6)
v_mfma_f32_16x16x32_bf16 v[200:203], v[56:59], v[60:63], v[200:203]
ds_read_b64_tr_b16 v[52:53], v22 offset:4096
v_mfma_f32_16x16x32_bf16 v[216:219], v[56:59], v[64:67], v[216:219]
ds_read_b64_tr_b16 v[54:55], v22 offset:6144
s_waitcnt lgkmcnt(5)
v_mfma_f32_16x16x32_bf16 v[188:191], v[44:47], v[68:71], v[188:191]
ds_read_b64_tr_b16 v[56:57], v23 offset:4096
ds_read_b64_tr_b16 v[58:59], v23 offset:6144
s_waitcnt lgkmcnt(6)
v_mfma_f32_16x16x32_bf16 v[204:207], v[44:47], v[72:75], v[204:207]
s_add_u32 s20, s20, 25600
s_cmp_ge_u32 s20, 143360
s_cselect_b32 s20, 0, s20
s_waitcnt lgkmcnt(4)
v_mfma_f32_16x16x32_bf16 v[192:195], v[48:51], v[68:71], v[192:195]
s_waitcnt lgkmcnt(0)
s_barrier
v_add_u32 v7, s20, v6
v_mfma_f32_16x16x32_bf16 v[208:211], v[48:51], v[72:75], v[208:211]
ds_read_b128 v[60:63], v7 offset:0
v_add_u32 v20, s20, v16
ds_read_b64_tr_b16 v[44:45], v20 offset:0
ds_read_b64_tr_b16 v[46:47], v20 offset:2048
s_waitcnt lgkmcnt(5)
v_mfma_f32_16x16x32_bf16 v[196:199], v[52:55], v[68:71], v[196:199]
ds_read_b128 v[64:67], v7 offset:1024
v_add_u32 v21, s20, v17
v_mfma_f32_16x16x32_bf16 v[212:215], v[52:55], v[72:75], v[212:215]
ds_read_b64_tr_b16 v[48:49], v21 offset:0
ds_read_b64_tr_b16 v[50:51], v21 offset:2048
s_waitcnt lgkmcnt(6)
v_mfma_f32_16x16x32_bf16 v[200:203], v[56:59], v[68:71], v[200:203]
v_add_u32 v22, s20, v18
v_mfma_f32_16x16x32_bf16 v[216:219], v[56:59], v[72:75], v[216:219]
ds_read_b64_tr_b16 v[52:53], v22 offset:0
ds_read_b64_tr_b16 v[54:55], v22 offset:2048
s_waitcnt lgkmcnt(5)
v_mfma_f32_16x16x32_bf16 v[188:191], v[44:47], v[60:63], v[188:191]
v_add_u32 v23, s20, v19
s_waitcnt lgkmcnt(4)
v_mfma_f32_16x16x32_bf16 v[204:207], v[44:47], v[64:67], v[204:207]
ds_read_b64_tr_b16 v[56:57], v23 offset:0
ds_read_b64_tr_b16 v[58:59], v23 offset:2048
s_waitcnt lgkmcnt(4)
v_mfma_f32_16x16x32_bf16 v[192:195], v[48:51], v[60:63], v[192:195]
ds_read_b128 v[68:71], v7 offset:8192
v_mfma_f32_16x16x32_bf16 v[208:211], v[48:51], v[64:67], v[208:211]
ds_read_b64_tr_b16 v[44:45], v20 offset:4096
ds_read_b64_tr_b16 v[46:47], v20 offset:6144
s_waitcnt lgkmcnt(5)
v_mfma_f32_16x16x32_bf16 v[196:199], v[52:55], v[60:63], v[196:199]
ds_read_b128 v[72:75], v7 offset:9216
v_mfma_f32_16x16x32_bf16 v[212:215], v[52:55], v[64:67], v[212:215]
ds_read_b64_tr_b16 v[48:49], v21 offset:4096
ds_read_b64_tr_b16 v[50:51], v21 offset:6144
s_waitcnt lgkmcnt(6)
v_mfma_f32_16x16x32_bf16 v[200:203], v[56:59], v[60:63], v[200:203]
ds_read_b64_tr_b16 v[52:53], v22 offset:4096
v_mfma_f32_16x16x32_bf16 v[216:219], v[56:59], v[64:67], v[216:219]
ds_read_b64_tr_b16 v[54:55], v22 offset:6144
s_waitcnt lgkmcnt(5)
v_mfma_f32_16x16x32_bf16 v[188:191], v[44:47], v[68:71], v[188:191]
ds_read_b64_tr_b16 v[56:57], v23 offset:4096
ds_read_b64_tr_b16 v[58:59], v23 offset:6144
s_waitcnt lgkmcnt(6)
v_mfma_f32_16x16x32_bf16 v[204:207], v[44:47], v[72:75], v[204:207]
s_add_u32 s20, s20, 25600
s_cmp_ge_u32 s20, 143360
s_cselect_b32 s20, 0, s20
s_waitcnt lgkmcnt(4)
v_mfma_f32_16x16x32_bf16 v[192:195], v[48:51], v[68:71], v[192:195]
s_waitcnt lgkmcnt(0)
s_barrier
v_add_u32 v7, s20, v6
v_mfma_f32_16x16x32_bf16 v[208:211], v[48:51], v[72:75], v[208:211]
ds_read_b128 v[60:63], v7 offset:0
v_add_u32 v20, s20, v16
ds_read_b64_tr_b16 v[44:45], v20 offset:0
ds_read_b64_tr_b16 v[46:47], v20 offset:2048
s_waitcnt lgkmcnt(5)
v_mfma_f32_16x16x32_bf16 v[196:199], v[52:55], v[68:71], v[196:199]
ds_read_b128 v[64:67], v7 offset:1024
v_add_u32 v21, s20, v17
v_mfma_f32_16x16x32_bf16 v[212:215], v[52:55], v[72:75], v[212:215]
ds_read_b64_tr_b16 v[48:49], v21 offset:0
ds_read_b64_tr_b16 v[50:51], v21 offset:2048
s_waitcnt lgkmcnt(6)
v_mfma_f32_16x16x32_bf16 v[200:203], v[56:59], v[68:71], v[200:203]
v_add_u32 v22, s20, v18
ds_read_b64_tr_b16 v[52:53], v22 offset:0
v_mfma_f32_16x16x32_bf16 v[216:219], v[56:59], v[72:75], v[216:219]
ds_read_b64_tr_b16 v[54:55], v22 offset:2048
s_sub_u32 s24, s24, 1
s_cmp_lg_u32 s24, 0
s_cbranch_scc1 CL_p4_1
s_waitcnt lgkmcnt(5)
v_mfma_f32_16x16x32_bf16 v[188:191], v[44:47], v[60:63], v[188:191]
v_add_u32 v23, s20, v19
s_waitcnt lgkmcnt(4)
v_mfma_f32_16x16x32_bf16 v[204:207], v[44:47], v[64:67], v[204:207]
ds_read_b64_tr_b16 v[56:57], v23 offset:0
ds_read_b64_tr_b16 v[58:59], v23 offset:2048
s_waitcnt lgkmcnt(4)
v_mfma_f32_16x16x32_bf16 v[192:195], v[48:51], v[60:63], v[192:195]
ds_read_b128 v[68:71], v7 offset:8192
v_mfma_f32_16x16x32_bf16 v[208:211], v[48:51], v[64:67], v[208:211]
ds_read_b64_tr_b16 v[44:45], v20 offset:4096
ds_read_b64_tr_b16 v[46:47], v20 offset:6144
s_waitcnt lgkmcnt(5)
v_mfma_f32_16x16x32_bf16 v[196:199], v[52:55], v[60:63], v[196:199]
ds_read_b128 v[72:75], v7 offset:9216
v_mfma_f32_16x16x32_bf16 v[212:215], v[52:55], v[64:67], v[212:215]
ds_read_b64_tr_b16 v[48:49], v21 offset:4096
ds_read_b64_tr_b16 v[50:51], v21 offset:6144
s_waitcnt lgkmcnt(6)
v_mfma_f32_16x16x32_bf16 v[200:203], v[56:59], v[60:63], v[200:203]
ds_read_b64_tr_b16 v[52:53], v22 offset:4096
v_mfma_f32_16x16x32_bf16 v[216:219], v[56:59], v[64:67], v[216:219]
ds_read_b64_tr_b16 v[54:55], v22 offset:6144
s_waitcnt lgkmcnt(5)
v_mfma_f32_16x16x32_bf16 v[188:191], v[44:47], v[68:71], v[188:191]
ds_read_b64_tr_b16 v[56:57], v23 offset:4096
ds_read_b64_tr_b16 v[58:59], v23 offset:6144
s_waitcnt lgkmcnt(6)
v_mfma_f32_16x16x32_bf16 v[204:207], v[44:47], v[72:75], v[204:207]
s_add_u32 s20, s20, 25600
s_cmp_ge_u32 s20, 143360
s_cselect_b32 s20, 0, s20
s_waitcnt lgkmcnt(4)
v_mfma_f32_16x16x32_bf16 v[192:195], v[48:51], v[68:71], v[192:195]
s_waitcnt lgkmcnt(0)
s_barrier
v_add_u32 v7, s20, v6
v_mfma_f32_16x16x32_bf16 v[208:211], v[48:51], v[72:75], v[208:211]
ds_read_b128 v[60:63], v7 offset:0
v_add_u32 v20, s20, v16
ds_read_b64_tr_b16 v[44:45], v20 offset:0
ds_read_b64_tr_b16 v[46:47], v20 offset:2048
s_waitcnt lgkmcnt(5)
v_mfma_f32_16x16x32_bf16 v[196:199], v[52:55], v[68:71], v[196:199]
ds_read_b128 v[64:67], v7 offset:1024
v_add_u32 v21, s20, v17
v_mfma_f32_16x16x32_bf16 v[212:215], v[52:55], v[72:75], v[212:215]
ds_read_b64_tr_b16 v[48:49], v21 offset:0
ds_read_b64_tr_b16 v[50:51], v21 offset:2048
s_waitcnt lgkmcnt(6)
v_mfma_f32_16x16x32_bf16 v[200:203], v[56:59], v[68:71], v[200:203]
v_add_u32 v22, s20, v18
v_mfma_f32_16x16x32_bf16 v[216:219], v[56:59], v[72:75], v[216:219]
ds_read_b64_tr_b16 v[52:53], v22 offset:0
ds_read_b64_tr_b16 v[54:55], v22 offset:2048
s_waitcnt lgkmcnt(5)
v_mfma_f32_16x16x32_bf16 v[188:191], v[44:47], v[60:63], v[188:191]
v_add_u32 v23, s20, v19
s_waitcnt lgkmcnt(4)
v_mfma_f32_16x16x32_bf16 v[204:207], v[44:47], v[64:67], v[204:207]
ds_read_b64_tr_b16 v[56:57], v23 offset:0
ds_read_b64_tr_b16 v[58:59], v23 offset:2048
s_waitcnt lgkmcnt(4)
v_mfma_f32_16x16x32_bf16 v[192:195], v[48:51], v[60:63], v[192:195]
ds_read_b128 v[68:71], v7 offset:8192
v_mfma_f32_16x16x32_bf16 v[208:211], v[48:51], v[64:67], v[208:211]
ds_read_b64_tr_b16 v[44:45], v20 offset:4096
ds_read_b64_tr_b16 v[46:47], v20 offset:6144
s_waitcnt lgkmcnt(5)
v_mfma_f32_16x16x32_bf16 v[196:199], v[52:55], v[60:63], v[196:199]
ds_read_b128 v[72:75], v7 offset:9216
v_mfma_f32_16x16x32_bf16 v[212:215], v[52:55], v[64:67], v[212:215]
ds_read_b64_tr_b16 v[48:49], v21 offset:4096
ds_read_b64_tr_b16 v[50:51], v21 offset:6144
s_waitcnt lgkmcnt(6)
v_mfma_f32_16x16x32_bf16 v[200:203], v[56:59], v[60:63], v[200:203]
ds_read_b64_tr_b16 v[52:53], v22 offset:4096
v_mfma_f32_16x16x32_bf16 v[216:219], v[56:59], v[64:67], v[216:219]
ds_read_b64_tr_b16 v[54:55], v22 offset:6144
s_waitcnt lgkmcnt(5)
v_mfma_f32_16x16x32_bf16 v[188:191], v[44:47], v[68:71], v[188:191]
ds_read_b64_tr_b16 v[56:57], v23 offset:4096
ds_read_b64_tr_b16 v[58:59], v23 offset:6144
s_waitcnt lgkmcnt(6)
v_mfma_f32_16x16x32_bf16 v[204:207], v[44:47], v[72:75], v[204:207]
s_add_u32 s20, s20, 25600
s_cmp_ge_u32 s20, 143360
s_cselect_b32 s20, 0, s20
s_waitcnt lgkmcnt(4)
v_mfma_f32_16x16x32_bf16 v[192:195], v[48:51], v[68:71], v[192:195]
v_mfma_f32_16x16x32_bf16 v[208:211], v[48:51], v[72:75], v[208:211]
s_waitcnt lgkmcnt(2)
v_mfma_f32_16x16x32_bf16 v[196:199], v[52:55], v[68:71], v[196:199]
v_mfma_f32_16x16x32_bf16 v[212:215], v[52:55], v[72:75], v[212:215]
s_waitcnt lgkmcnt(0)
v_mfma_f32_16x16x32_bf16 v[200:203], v[56:59], v[68:71], v[200:203]
v_mfma_f32_16x16x32_bf16 v[216:219], v[56:59], v[72:75], v[216:219]
s_barrier
ds_read_b128 v[220:223], v5 offset:0
ds_read_b128 v[224:227], v5 offset:1024
ds_read_b128 v[228:231], v5 offset:2048
ds_read_b128 v[232:235], v5 offset:3072
s_waitcnt lgkmcnt(3)
v_and_b32 v77, 0xffff0000, v220
v_lshlrev_b32 v76, 16, v220
v_and_b32 v79, 0xffff0000, v221
v_lshlrev_b32 v78, 16, v221
v_and_b32 v81, 0xffff0000, v222
v_lshlrev_b32 v80, 16, v222
v_and_b32 v83, 0xffff0000, v223
v_lshlrev_b32 v82, 16, v223
v_pk_add_f32 v[188:189], v[188:189], v[76:77]
v_pk_add_f32 v[190:191], v[190:191], v[78:79]
v_pk_add_f32 v[192:193], v[192:193], v[80:81]
v_pk_add_f32 v[194:195], v[194:195], v[82:83]
s_waitcnt lgkmcnt(2)
v_and_b32 v85, 0xffff0000, v224
v_lshlrev_b32 v84, 16, v224
v_and_b32 v87, 0xffff0000, v225
v_lshlrev_b32 v86, 16, v225
v_and_b32 v89, 0xffff0000, v226
v_lshlrev_b32 v88, 16, v226
v_and_b32 v91, 0xffff0000, v227
v_lshlrev_b32 v90, 16, v227
v_pk_add_f32 v[196:197], v[196:197], v[84:85]
v_pk_add_f32 v[198:199], v[198:199], v[86:87]
v_pk_add_f32 v[200:201], v[200:201], v[88:89]
v_pk_add_f32 v[202:203], v[202:203], v[90:91]
s_waitcnt lgkmcnt(1)
v_and_b32 v93, 0xffff0000, v228
v_lshlrev_b32 v92, 16, v228
v_and_b32 v95, 0xffff0000, v229
v_lshlrev_b32 v94, 16, v229
v_and_b32 v97, 0xffff0000, v230
v_lshlrev_b32 v96, 16, v230
v_and_b32 v99, 0xffff0000, v231
v_lshlrev_b32 v98, 16, v231
v_pk_add_f32 v[204:205], v[204:205], v[92:93]
v_pk_add_f32 v[206:207], v[206:207], v[94:95]
v_pk_add_f32 v[208:209], v[208:209], v[96:97]
v_pk_add_f32 v[210:211], v[210:211], v[98:99]
s_waitcnt lgkmcnt(0)
v_and_b32 v101, 0xffff0000, v232
v_lshlrev_b32 v100, 16, v232
v_and_b32 v103, 0xffff0000, v233
v_lshlrev_b32 v102, 16, v233
v_and_b32 v105, 0xffff0000, v234
v_lshlrev_b32 v104, 16, v234
v_and_b32 v107, 0xffff0000, v235
v_lshlrev_b32 v106, 16, v235
v_pk_add_f32 v[212:213], v[212:213], v[100:101]
v_pk_add_f32 v[214:215], v[214:215], v[102:103]
v_pk_add_f32 v[216:217], v[216:217], v[104:105]
v_pk_add_f32 v[218:219], v[218:219], v[106:107]
s_mov_b32 s12, s56
s_mov_b32 s13, s57
s_mov_b32 s14, 4194304
s_mov_b32 s15, 0x20000
v_cvt_pk_bf16_f32 v188, v188, v189
v_cvt_pk_bf16_f32 v189, v190, v191
v_cvt_pk_bf16_f32 v190, v192, v193
v_cvt_pk_bf16_f32 v191, v194, v195
s_nop 0
v_permlane16_swap_b32 v188, v190
v_permlane16_swap_b32 v189, v191
buffer_store_dwordx4 v[188:191], v13, s[12:15], s48 offen offset:0
v_cvt_pk_bf16_f32 v196, v196, v197
v_cvt_pk_bf16_f32 v197, v198, v199
v_cvt_pk_bf16_f32 v198, v200, v201
v_cvt_pk_bf16_f32 v199, v202, v203
s_nop 0
v_permlane16_swap_b32 v196, v198
v_permlane16_swap_b32 v197, v199
buffer_store_dwordx4 v[196:199], v13, s[12:15], s48 offen offset:64
v_cvt_pk_bf16_f32 v204, v204, v205
v_cvt_pk_bf16_f32 v205, v206, v207
v_cvt_pk_bf16_f32 v206, v208, v209
v_cvt_pk_bf16_f32 v207, v210, v211
s_nop 0
v_permlane16_swap_b32 v204, v206
v_permlane16_swap_b32 v205, v207
buffer_store_dwordx4 v[204:207], v13, s[12:15], s49 offen offset:0
v_cvt_pk_bf16_f32 v212, v212, v213
v_cvt_pk_bf16_f32 v213, v214, v215
v_cvt_pk_bf16_f32 v214, v216, v217
v_cvt_pk_bf16_f32 v215, v218, v219
s_nop 0
v_permlane16_swap_b32 v212, v214
v_permlane16_swap_b32 v213, v215
buffer_store_dwordx4 v[212:215], v13, s[12:15], s49 offen offset:64
END:
s_endpgm
.section .rodata,"a"
.p2align 6
.amdhsa_kernel parallel_sum__sliding_local_dilated__mixer_s_mlp__prompt_kernel
  .amdhsa_next_free_vgpr 256
  .amdhsa_next_free_sgpr 102
  .amdhsa_accum_offset 256
  .amdhsa_group_segment_fixed_size 0
  .amdhsa_kernarg_size 88
  .amdhsa_user_sgpr_count 2
  .amdhsa_user_sgpr_kernarg_segment_ptr 1
  .amdhsa_system_sgpr_workgroup_id_x 1
.end_amdhsa_kernel
```
